```python
import torch

def _softmax(x, axis=-1):
    return torch.softmax(x, dim=axis)

def _gelu(x):
    return torch.nn.functional.gelu(x, approximate='tanh')

def _silu(x):
    return torch.nn.functional.silu(x)

def _sigmoid(x):
    return torch.sigmoid(x)

def _layernorm(x, axis=-1, eps=1e-05):
    m = x.mean(dim=axis, keepdim=True)
    v = x.var(dim=axis, keepdim=True, unbiased=False)
    return (x - m) / torch.sqrt(v + eps)

def _scatter_add(tgt, idx, src, axis=0):
    return tgt.clone().index_add_(axis, idx, src)

def _segment_sum(src, seg, n):
    out = torch.zeros((n,) + src.shape[1:], dtype=src.dtype)
    return out.index_add_(0, seg, src)

def _pad(x, pw):
    flat = tuple((v for pair in reversed(pw) for v in pair))
    return torch.nn.functional.pad(x, flat)
kernel_name = 'concat_heads__spectral_gfnet__memory_aug_recurrent_mem_tr__prompt'

def setup_inputs():

    _w = lambda a: (lambda t: t.to(torch.bfloat16) if t.is_floating_point() else t)(torch.as_tensor(a))

    def _A_setup():
        B, S, D = (1, 2048, 448)
        Df = D // 2 + 1
        return {'x': _w((lambda *s: torch.randn(*s, dtype=torch.bfloat16) * 0.05)(B, S, D)), 'w_r': _w((lambda *s: torch.randn(*s, dtype=torch.bfloat16) * 3.2)(S, Df) * 0.02), 'w_i': _w((lambda *s: torch.randn(*s, dtype=torch.bfloat16) * 3.2)(S, Df) * 0.02)}
    _A_in = _A_setup()

    def _B_setup():
        B, S, Dm = (1, 2048, 448)
        H, Dh = (16, 256)
        M, seg = (8, 32)
        seg = min(seg, S)
        S = S // seg * seg
        return {'x': _w((lambda *s: torch.randn(*s, dtype=torch.bfloat16) * 0.05)(B, S, Dm)), 'mem0': _w((lambda *s: torch.randn(*s, dtype=torch.bfloat16) * 0.4)(B, M, Dm)), 'Wq': _w((lambda *s: torch.randn(*s, dtype=torch.bfloat16) * 6.4)(Dm, H, Dh) * Dm ** (-0.5)), 'Wk': _w((lambda *s: torch.randn(*s, dtype=torch.bfloat16) * 6.4)(Dm, H, Dh) * Dm ** (-0.5)), 'Wv': _w((lambda *s: torch.randn(*s, dtype=torch.bfloat16) * 0.4)(Dm, H, Dh) * Dm ** (-0.5)), 'Wo': _w((lambda *s: torch.randn(*s, dtype=torch.bfloat16) * 0.4)(H, Dh, Dm) * (H * Dh) ** (-0.5)), 'seg_len': seg}
    _B_in = _B_setup()
    return {'A_x': _A_in['x'], 'A_w_r': _A_in['w_r'], 'A_w_i': _A_in['w_i'], 'B_x': _B_in['x'], 'B_mem0': _B_in['mem0'], 'B_Wq': _B_in['Wq'], 'B_Wk': _B_in['Wk'], 'B_Wv': _B_in['Wv'], 'B_Wo': _B_in['Wo'], 'B_seg_len': _B_in['seg_len']}

def reference(A_x, A_w_r, A_w_i, B_x, B_mem0, B_Wq, B_Wk, B_Wv, B_Wo, B_seg_len):

    def _A_ref(x, w_r, w_i):
        B, S, D = x.shape
        X = (lambda x, axes=(-2, -1): torch.fft.rfft2(x.float(), dim=axes))(x, axes=(-2, -1))
        W = w_r + 1j * w_i
        X = X * W
        y = (lambda x, s, axes=(-2, -1): torch.fft.irfft2(x, s=s, dim=axes).to(torch.bfloat16))(X, (S, D), axes=(-2, -1))
        return y

    def _B_ref(x, mem0, Wq, Wk, Wv, Wo, seg_len):
        B, S, Dm = x.shape
        H, Dh = (Wq.shape[1], Wq.shape[2])
        M = mem0.shape[1]
        scale = Dh ** (-0.5)
        n_seg = S // seg_len
        L = M + seg_len
        idx = torch.arange(L)
        mask = (idx[:, None] < M) | (idx[:, None] >= idx[None, :])
        mem = mem0
        outs = []
        for s in range(n_seg):
            xs = x[:, s * seg_len:(s + 1) * seg_len, :].clone()
            h = torch.concatenate([mem, xs], axis=1)
            q = torch.einsum('btd,dhe->bhte', h, Wq)
            k = torch.einsum('btd,dhe->bhte', h, Wk)
            v = torch.einsum('btd,dhe->bhte', h, Wv)
            scores = torch.einsum('bhqe,bhke->bhqk', q, k) * scale
            scores = torch.where(mask[None, None], scores, -1000000000.0)
            p = _softmax(scores, axis=-1)
            o = torch.einsum('bhqk,bhke->bhqe', p, v)
            o = torch.einsum('bhte,hed->btd', o, Wo)
            mem = o[:, :M, :].clone()
            outs.append(o[:, M:, :])
        return torch.concatenate(outs, axis=1)
    a = _A_ref(A_x, A_w_r, A_w_i)
    b = _B_ref(B_x, B_mem0, B_Wq, B_Wk, B_Wv, B_Wo, B_seg_len)
    return torch.concatenate([a, b], axis=-1)
```

```asm
; @launch kernel=pre_kernel grid=(256,1,1) block=(256,1,1) lds=163840
; @launch kernel=main_kernel grid=(256,1,1) block=(256,1,1) lds=163840
.amdgcn_target "amdgcn-amd-amdhsa--gfx950"
.text
.globl pre_kernel
.p2align 8
.type pre_kernel,@function
pre_kernel:
    s_load_dwordx4 s[4:7], s[0:1], 40
    s_load_dwordx4 s[8:11], s[0:1], 56
    s_load_dwordx2 s[12:13], s[0:1], 96
    s_load_dwordx2 s[14:15], s[0:1], 32
    s_load_dwordx2 s[28:29], s[0:1], 24
    s_cmp_ge_u32 s2, 256
    s_cbranch_scc1 K1_end
    v_lshrrev_b32 v1, 6, v0
    v_and_b32 v0, 63, v0
    v_readfirstlane_b32 s3, v1
    s_getpc_b64 s[40:41]
K1_pc:
    s_and_b32 s42, s3, 1
    s_lshl_b32 s42, s42, 13
    v_lshl_add_u32 v250, v0, 7, s42
    v_min_u32 v250, K1_end-pre_kernel, v250
    s_sub_u32 s40, s40, K1_pc-pre_kernel
    s_subb_u32 s41, s41, 0
    v_mov_b32 v251, s41
    v_add_co_u32 v250, vcc, s40, v250
    v_addc_co_u32 v251, vcc, 0, v251, vcc
    global_load_dword v250, v[250:251], off
    s_and_b32 s16, s2, 7
    s_lshr_b32 s17, s2, 3
    s_cmp_ge_u32 s17, 28
    s_cbranch_scc1 K1_misc
    s_cmp_ge_u32 s17, 14
    s_cselect_b32 s18, 1, 0
    s_lshl_b32 s16, s16, 1
    s_add_u32 s16, s16, s18
    s_mul_i32 s18, s18, 14
    s_sub_u32 s17, s17, s18
    v_and_b32 v2, 15, v0
    v_lshrrev_b32 v3, 4, v0
    v_lshrrev_b32 v4, 2, v2
    v_and_b32 v5, 3, v2
    v_lshl_add_u32 v6, v4, 3, v5
    s_lshl_b32 s19, s16, 9
    s_cmp_ge_u32 s17, 7
    s_cbranch_scc1 K1_B
    v_lshrrev_b32 v24, 3, v0
    v_and_b32 v22, 7, v0
    v_xor_b32 v22, v22, v3
    v_lshlrev_b32 v22, 4, v22
    v_add_u32 v22, s19, v22
    v_xor_b32 v23, 64, v22
    v_lshrrev_b32 v25, 2, v24
    v_and_b32 v26, 3, v24
    v_lshl_add_u32 v27, v25, 3, v26
    v_lshrrev_b32 v20, 1, v2
    v_xor_b32 v20, v20, v3
    v_lshlrev_b32 v20, 4, v20
    v_lshl_add_u32 v20, v2, 7, v20
    v_xor_b32 v21, 64, v20
    s_lshl_b32 s20, s17, 19
    s_lshl_b32 s21, s3, 7
    s_add_u32 s20, s20, s21
    v_lshl_add_u32 v7, v27, 13, s20
    s_lshl_b32 s21, s3, 13
    s_waitcnt lgkmcnt(0)
    s_add_u32 m0, s21, 0
    v_add_u32 v8, 0, v7
    v_add_u32 v8, v8, v22
    global_load_lds_dwordx4 v8, s[4:5]
    s_add_u32 m0, s21, 1024
    v_add_u32 v8, 131072, v7
    v_add_u32 v8, v8, v23
    global_load_lds_dwordx4 v8, s[4:5]
    s_add_u32 m0, s21, 2048
    v_add_u32 v8, 32768, v7
    v_add_u32 v8, v8, v22
    global_load_lds_dwordx4 v8, s[4:5]
    s_add_u32 m0, s21, 3072
    v_add_u32 v8, 163840, v7
    v_add_u32 v8, v8, v23
    global_load_lds_dwordx4 v8, s[4:5]
    s_add_u32 m0, s21, 4096
    v_add_u32 v8, 262144, v7
    v_add_u32 v8, v8, v22
    global_load_lds_dwordx4 v8, s[4:5]
    s_add_u32 m0, s21, 5120
    v_add_u32 v8, 393216, v7
    v_add_u32 v8, v8, v23
    global_load_lds_dwordx4 v8, s[4:5]
    s_add_u32 m0, s21, 6144
    v_add_u32 v8, 294912, v7
    v_add_u32 v8, v8, v22
    global_load_lds_dwordx4 v8, s[4:5]
    s_add_u32 m0, s21, 7168
    v_add_u32 v8, 425984, v7
    v_add_u32 v8, v8, v23
    global_load_lds_dwordx4 v8, s[4:5]
    v_lshrrev_b32 v17, 1, v26
    v_and_b32 v18, 1, v26
    v_lshl_add_u32 v17, v17, 2, v18
    s_mul_i32 s22, s3, 112
    v_add_u32 v17, s22, v17
    v_lshl_add_u32 v8, v25, 4, v17
    v_lshl_add_u32 v9, v25, 3, v17
    v_add_u32 v200, 0, v8
    v_lshl_add_u32 v200, v200, 13, v22
    v_add_u32 v201, 32, v8
    v_lshl_add_u32 v201, v201, 13, v23
    v_add_u32 v202, 2, v8
    v_lshl_add_u32 v202, v202, 13, v22
    v_add_u32 v203, 34, v8
    v_lshl_add_u32 v203, v203, 13, v23
    v_add_u32 v204, 8, v8
    v_lshl_add_u32 v204, v204, 13, v22
    v_add_u32 v205, 40, v8
    v_lshl_add_u32 v205, v205, 13, v23
    v_add_u32 v206, 10, v8
    v_lshl_add_u32 v206, v206, 13, v22
    v_add_u32 v207, 42, v8
    v_lshl_add_u32 v207, v207, 13, v23
    v_add_u32 v208, 64, v8
    v_lshl_add_u32 v208, v208, 13, v22
    v_add_u32 v209, 96, v9
    v_lshl_add_u32 v209, v209, 13, v23
    v_add_u32 v210, 66, v8
    v_lshl_add_u32 v210, v210, 13, v22
    v_add_u32 v211, 98, v9
    v_lshl_add_u32 v211, v211, 13, v23
    v_add_u32 v212, 72, v8
    v_lshl_add_u32 v212, v212, 13, v22
    v_add_u32 v213, 74, v8
    v_lshl_add_u32 v213, v213, 13, v23
    s_add_u32 s32, s6, 128
    s_addc_u32 s33, s7, 0
    s_add_u32 s34, s6, 256
    s_addc_u32 s35, s7, 0
    s_add_u32 s36, s6, 384
    s_addc_u32 s37, s7, 0
    s_mul_i32 s24, s3, 28672
    s_add_u32 s24, s24, 32768
    v_add_u32 v28, s24, v20
    v_add_u32 v29, s24, v21
    s_add_u32 m0, s24, 0
    s_nop 0
    global_load_lds_dwordx4 v200, s[6:7]
    s_add_u32 m0, s24, 1024
    s_nop 0
    global_load_lds_dwordx4 v201, s[6:7]
    s_add_u32 m0, s24, 2048
    s_nop 0
    global_load_lds_dwordx4 v202, s[6:7]
    s_add_u32 m0, s24, 3072
    s_nop 0
    global_load_lds_dwordx4 v203, s[6:7]
    s_add_u32 m0, s24, 4096
    s_nop 0
    global_load_lds_dwordx4 v204, s[6:7]
    s_add_u32 m0, s24, 5120
    s_nop 0
    global_load_lds_dwordx4 v205, s[6:7]
    s_add_u32 m0, s24, 6144
    s_nop 0
    global_load_lds_dwordx4 v206, s[6:7]
    s_add_u32 m0, s24, 7168
    s_nop 0
    global_load_lds_dwordx4 v207, s[6:7]
    s_add_u32 m0, s24, 8192
    s_nop 0
    global_load_lds_dwordx4 v208, s[6:7]
    s_add_u32 m0, s24, 9216
    s_nop 0
    global_load_lds_dwordx4 v209, s[6:7]
    s_add_u32 m0, s24, 10240
    s_nop 0
    global_load_lds_dwordx4 v210, s[6:7]
    s_add_u32 m0, s24, 11264
    s_nop 0
    global_load_lds_dwordx4 v211, s[6:7]
    s_add_u32 m0, s24, 12288
    s_nop 0
    global_load_lds_dwordx4 v212, s[6:7]
    s_add_u32 m0, s24, 13312
    s_nop 0
    global_load_lds_dwordx4 v213, s[6:7]
    s_add_u32 m0, s24, 14336
    s_nop 0
    global_load_lds_dwordx4 v200, s[32:33]
    s_add_u32 m0, s24, 15360
    s_nop 0
    global_load_lds_dwordx4 v201, s[32:33]
    s_add_u32 m0, s24, 16384
    s_nop 0
    global_load_lds_dwordx4 v202, s[32:33]
    s_add_u32 m0, s24, 17408
    s_nop 0
    global_load_lds_dwordx4 v203, s[32:33]
    s_add_u32 m0, s24, 18432
    s_nop 0
    global_load_lds_dwordx4 v204, s[32:33]
    s_add_u32 m0, s24, 19456
    s_nop 0
    global_load_lds_dwordx4 v205, s[32:33]
    s_add_u32 m0, s24, 20480
    s_nop 0
    global_load_lds_dwordx4 v206, s[32:33]
    s_add_u32 m0, s24, 21504
    s_nop 0
    global_load_lds_dwordx4 v207, s[32:33]
    s_add_u32 m0, s24, 22528
    s_nop 0
    global_load_lds_dwordx4 v208, s[32:33]
    s_add_u32 m0, s24, 23552
    s_nop 0
    global_load_lds_dwordx4 v209, s[32:33]
    s_add_u32 m0, s24, 24576
    s_nop 0
    global_load_lds_dwordx4 v210, s[32:33]
    s_add_u32 m0, s24, 25600
    s_nop 0
    global_load_lds_dwordx4 v211, s[32:33]
    s_add_u32 m0, s24, 26624
    s_nop 0
    global_load_lds_dwordx4 v212, s[32:33]
    s_add_u32 m0, s24, 27648
    s_nop 0
    global_load_lds_dwordx4 v213, s[32:33]
    s_waitcnt vmcnt(14)
    s_barrier
    ds_read_b128 a[0:3], v28 offset:0
    ds_read_b128 a[8:11], v28 offset:2048
    ds_read_b128 a[16:19], v28 offset:4096
    ds_read_b128 a[24:27], v28 offset:6144
    ds_read_b128 a[32:35], v28 offset:8192
    ds_read_b128 a[40:43], v28 offset:10240
    ds_read_b128 a[48:51], v28 offset:12288
    ds_read_b128 a[4:7], v29 offset:0
    ds_read_b128 a[12:15], v29 offset:2048
    ds_read_b128 a[20:23], v29 offset:4096
    ds_read_b128 a[28:31], v29 offset:6144
    ds_read_b128 a[36:39], v29 offset:8192
    ds_read_b128 a[44:47], v29 offset:10240
    ds_read_b128 a[52:55], v29 offset:12288
    ds_read_b128 v[160:163], v20 offset:0
    ds_read_b128 v[164:167], v20 offset:2048
    ds_read_b128 v[168:171], v20 offset:4096
    ds_read_b128 v[172:175], v20 offset:6144
    s_waitcnt lgkmcnt(4)
    s_add_u32 m0, s24, 0
    s_nop 0
    global_load_lds_dwordx4 v200, s[34:35]
    s_add_u32 m0, s24, 1024
    s_nop 0
    global_load_lds_dwordx4 v201, s[34:35]
    s_add_u32 m0, s24, 2048
    s_nop 0
    global_load_lds_dwordx4 v202, s[34:35]
    s_add_u32 m0, s24, 3072
    s_nop 0
    global_load_lds_dwordx4 v203, s[34:35]
    s_add_u32 m0, s24, 4096
    s_nop 0
    global_load_lds_dwordx4 v204, s[34:35]
    s_add_u32 m0, s24, 5120
    s_nop 0
    global_load_lds_dwordx4 v205, s[34:35]
    s_add_u32 m0, s24, 6144
    s_nop 0
    global_load_lds_dwordx4 v206, s[34:35]
    s_add_u32 m0, s24, 7168
    s_nop 0
    global_load_lds_dwordx4 v207, s[34:35]
    s_add_u32 m0, s24, 8192
    s_nop 0
    global_load_lds_dwordx4 v208, s[34:35]
    s_add_u32 m0, s24, 9216
    s_nop 0
    global_load_lds_dwordx4 v209, s[34:35]
    s_add_u32 m0, s24, 10240
    s_nop 0
    global_load_lds_dwordx4 v210, s[34:35]
    s_add_u32 m0, s24, 11264
    s_nop 0
    global_load_lds_dwordx4 v211, s[34:35]
    s_add_u32 m0, s24, 12288
    s_nop 0
    global_load_lds_dwordx4 v212, s[34:35]
    s_add_u32 m0, s24, 13312
    s_nop 0
    global_load_lds_dwordx4 v213, s[34:35]
    ds_read_b128 v[176:179], v21 offset:0
    ds_read_b128 v[180:183], v21 offset:2048
    ds_read_b128 v[184:187], v21 offset:4096
    ds_read_b128 v[188:191], v21 offset:6144
    s_waitcnt lgkmcnt(4)
    v_mfma_f32_16x16x32_bf16 v[32:35], v[160:163], a[0:3], 0
    v_mfma_f32_16x16x32_bf16 v[36:39], v[164:167], a[0:3], 0
    v_mfma_f32_16x16x32_bf16 v[40:43], v[168:171], a[0:3], 0
    v_mfma_f32_16x16x32_bf16 v[44:47], v[172:175], a[0:3], 0
    v_mfma_f32_16x16x32_bf16 v[48:51], v[160:163], a[8:11], 0
    s_waitcnt vmcnt(14)
    v_mfma_f32_16x16x32_bf16 v[52:55], v[164:167], a[8:11], 0
    ds_read_b128 a[64:67], v28 offset:14336
    v_mfma_f32_16x16x32_bf16 v[56:59], v[168:171], a[8:11], 0
    ds_read_b128 a[72:75], v28 offset:16384
    v_mfma_f32_16x16x32_bf16 v[60:63], v[172:175], a[8:11], 0
    ds_read_b128 a[80:83], v28 offset:18432
    v_mfma_f32_16x16x32_bf16 v[64:67], v[160:163], a[16:19], 0
    ds_read_b128 a[88:91], v28 offset:20480
    v_mfma_f32_16x16x32_bf16 v[68:71], v[164:167], a[16:19], 0
    ds_read_b128 a[96:99], v28 offset:22528
    v_mfma_f32_16x16x32_bf16 v[72:75], v[168:171], a[16:19], 0
    ds_read_b128 a[104:107], v28 offset:24576
    v_mfma_f32_16x16x32_bf16 v[76:79], v[172:175], a[16:19], 0
    ds_read_b128 a[112:115], v28 offset:26624
    v_mfma_f32_16x16x32_bf16 v[80:83], v[160:163], a[24:27], 0
    ds_read_b128 a[68:71], v29 offset:14336
    v_mfma_f32_16x16x32_bf16 v[84:87], v[164:167], a[24:27], 0
    ds_read_b128 a[76:79], v29 offset:16384
    v_mfma_f32_16x16x32_bf16 v[88:91], v[168:171], a[24:27], 0
    ds_read_b128 a[84:87], v29 offset:18432
    v_mfma_f32_16x16x32_bf16 v[92:95], v[172:175], a[24:27], 0
    ds_read_b128 a[92:95], v29 offset:20480
    v_mfma_f32_16x16x32_bf16 v[96:99], v[160:163], a[32:35], 0
    ds_read_b128 a[100:103], v29 offset:22528
    v_mfma_f32_16x16x32_bf16 v[100:103], v[164:167], a[32:35], 0
    ds_read_b128 a[108:111], v29 offset:24576
    v_mfma_f32_16x16x32_bf16 v[104:107], v[168:171], a[32:35], 0
    ds_read_b128 a[116:119], v29 offset:26624
    v_mfma_f32_16x16x32_bf16 v[108:111], v[172:175], a[32:35], 0
    v_mfma_f32_16x16x32_bf16 v[112:115], v[160:163], a[40:43], 0
    v_mfma_f32_16x16x32_bf16 v[116:119], v[164:167], a[40:43], 0
    v_mfma_f32_16x16x32_bf16 v[120:123], v[168:171], a[40:43], 0
    v_mfma_f32_16x16x32_bf16 v[124:127], v[172:175], a[40:43], 0
    v_mfma_f32_16x16x32_bf16 v[128:131], v[160:163], a[48:51], 0
    v_mfma_f32_16x16x32_bf16 v[132:135], v[164:167], a[48:51], 0
    v_mfma_f32_16x16x32_bf16 v[136:139], v[168:171], a[48:51], 0
    v_mfma_f32_16x16x32_bf16 v[140:143], v[172:175], a[48:51], 0
    ds_read_b128 v[160:163], v20 offset:8192
    ds_read_b128 v[164:167], v20 offset:10240
    ds_read_b128 v[168:171], v20 offset:12288
    ds_read_b128 v[172:175], v20 offset:14336
    s_waitcnt lgkmcnt(4)
    s_add_u32 m0, s24, 14336
    s_nop 0
    global_load_lds_dwordx4 v200, s[36:37]
    s_add_u32 m0, s24, 15360
    s_nop 0
    global_load_lds_dwordx4 v201, s[36:37]
    s_add_u32 m0, s24, 16384
    s_nop 0
    global_load_lds_dwordx4 v202, s[36:37]
    s_add_u32 m0, s24, 17408
    s_nop 0
    global_load_lds_dwordx4 v203, s[36:37]
    s_add_u32 m0, s24, 18432
    s_nop 0
    global_load_lds_dwordx4 v204, s[36:37]
    s_add_u32 m0, s24, 19456
    s_nop 0
    global_load_lds_dwordx4 v205, s[36:37]
    s_add_u32 m0, s24, 20480
    s_nop 0
    global_load_lds_dwordx4 v206, s[36:37]
    s_add_u32 m0, s24, 21504
    s_nop 0
    global_load_lds_dwordx4 v207, s[36:37]
    s_add_u32 m0, s24, 22528
    s_nop 0
    global_load_lds_dwordx4 v208, s[36:37]
    s_add_u32 m0, s24, 23552
    s_nop 0
    global_load_lds_dwordx4 v209, s[36:37]
    s_add_u32 m0, s24, 24576
    s_nop 0
    global_load_lds_dwordx4 v210, s[36:37]
    s_add_u32 m0, s24, 25600
    s_nop 0
    global_load_lds_dwordx4 v211, s[36:37]
    s_add_u32 m0, s24, 26624
    s_nop 0
    global_load_lds_dwordx4 v212, s[36:37]
    s_add_u32 m0, s24, 27648
    s_nop 0
    global_load_lds_dwordx4 v213, s[36:37]
    v_mfma_f32_16x16x32_bf16 v[32:35], v[176:179], a[4:7], v[32:35]
    v_mfma_f32_16x16x32_bf16 v[36:39], v[180:183], a[4:7], v[36:39]
    v_mfma_f32_16x16x32_bf16 v[40:43], v[184:187], a[4:7], v[40:43]
    v_mfma_f32_16x16x32_bf16 v[44:47], v[188:191], a[4:7], v[44:47]
    v_mfma_f32_16x16x32_bf16 v[48:51], v[176:179], a[12:15], v[48:51]
    v_mfma_f32_16x16x32_bf16 v[52:55], v[180:183], a[12:15], v[52:55]
    v_mfma_f32_16x16x32_bf16 v[56:59], v[184:187], a[12:15], v[56:59]
    v_mfma_f32_16x16x32_bf16 v[60:63], v[188:191], a[12:15], v[60:63]
    v_mfma_f32_16x16x32_bf16 v[64:67], v[176:179], a[20:23], v[64:67]
    v_mfma_f32_16x16x32_bf16 v[68:71], v[180:183], a[20:23], v[68:71]
    v_mfma_f32_16x16x32_bf16 v[72:75], v[184:187], a[20:23], v[72:75]
    v_mfma_f32_16x16x32_bf16 v[76:79], v[188:191], a[20:23], v[76:79]
    v_mfma_f32_16x16x32_bf16 v[80:83], v[176:179], a[28:31], v[80:83]
    v_mfma_f32_16x16x32_bf16 v[84:87], v[180:183], a[28:31], v[84:87]
    v_mfma_f32_16x16x32_bf16 v[88:91], v[184:187], a[28:31], v[88:91]
    v_mfma_f32_16x16x32_bf16 v[92:95], v[188:191], a[28:31], v[92:95]
    v_mfma_f32_16x16x32_bf16 v[96:99], v[176:179], a[36:39], v[96:99]
    v_mfma_f32_16x16x32_bf16 v[100:103], v[180:183], a[36:39], v[100:103]
    v_mfma_f32_16x16x32_bf16 v[104:107], v[184:187], a[36:39], v[104:107]
    v_mfma_f32_16x16x32_bf16 v[108:111], v[188:191], a[36:39], v[108:111]
    v_mfma_f32_16x16x32_bf16 v[112:115], v[176:179], a[44:47], v[112:115]
    v_mfma_f32_16x16x32_bf16 v[116:119], v[180:183], a[44:47], v[116:119]
    v_mfma_f32_16x16x32_bf16 v[120:123], v[184:187], a[44:47], v[120:123]
    v_mfma_f32_16x16x32_bf16 v[124:127], v[188:191], a[44:47], v[124:127]
    v_mfma_f32_16x16x32_bf16 v[128:131], v[176:179], a[52:55], v[128:131]
    v_mfma_f32_16x16x32_bf16 v[132:135], v[180:183], a[52:55], v[132:135]
    v_mfma_f32_16x16x32_bf16 v[136:139], v[184:187], a[52:55], v[136:139]
    v_mfma_f32_16x16x32_bf16 v[140:143], v[188:191], a[52:55], v[140:143]
    ds_read_b128 v[176:179], v21 offset:8192
    ds_read_b128 v[180:183], v21 offset:10240
    ds_read_b128 v[184:187], v21 offset:12288
    ds_read_b128 v[188:191], v21 offset:14336
    s_waitcnt lgkmcnt(4)
    v_mfma_f32_16x16x32_bf16 v[32:35], v[160:163], a[64:67], v[32:35]
    v_mfma_f32_16x16x32_bf16 v[36:39], v[164:167], a[64:67], v[36:39]
    v_mfma_f32_16x16x32_bf16 v[40:43], v[168:171], a[64:67], v[40:43]
    v_mfma_f32_16x16x32_bf16 v[44:47], v[172:175], a[64:67], v[44:47]
    v_mfma_f32_16x16x32_bf16 v[48:51], v[160:163], a[72:75], v[48:51]
    s_waitcnt vmcnt(14)
    v_mfma_f32_16x16x32_bf16 v[52:55], v[164:167], a[72:75], v[52:55]
    ds_read_b128 a[0:3], v28 offset:0
    v_mfma_f32_16x16x32_bf16 v[56:59], v[168:171], a[72:75], v[56:59]
    ds_read_b128 a[8:11], v28 offset:2048
    v_mfma_f32_16x16x32_bf16 v[60:63], v[172:175], a[72:75], v[60:63]
    ds_read_b128 a[16:19], v28 offset:4096
    v_mfma_f32_16x16x32_bf16 v[64:67], v[160:163], a[80:83], v[64:67]
    ds_read_b128 a[24:27], v28 offset:6144
    v_mfma_f32_16x16x32_bf16 v[68:71], v[164:167], a[80:83], v[68:71]
    ds_read_b128 a[32:35], v28 offset:8192
    v_mfma_f32_16x16x32_bf16 v[72:75], v[168:171], a[80:83], v[72:75]
    ds_read_b128 a[40:43], v28 offset:10240
    v_mfma_f32_16x16x32_bf16 v[76:79], v[172:175], a[80:83], v[76:79]
    ds_read_b128 a[48:51], v28 offset:12288
    v_mfma_f32_16x16x32_bf16 v[80:83], v[160:163], a[88:91], v[80:83]
    ds_read_b128 a[4:7], v29 offset:0
    v_mfma_f32_16x16x32_bf16 v[84:87], v[164:167], a[88:91], v[84:87]
    ds_read_b128 a[12:15], v29 offset:2048
    v_mfma_f32_16x16x32_bf16 v[88:91], v[168:171], a[88:91], v[88:91]
    ds_read_b128 a[20:23], v29 offset:4096
    v_mfma_f32_16x16x32_bf16 v[92:95], v[172:175], a[88:91], v[92:95]
    ds_read_b128 a[28:31], v29 offset:6144
    v_mfma_f32_16x16x32_bf16 v[96:99], v[160:163], a[96:99], v[96:99]
    ds_read_b128 a[36:39], v29 offset:8192
    v_mfma_f32_16x16x32_bf16 v[100:103], v[164:167], a[96:99], v[100:103]
    ds_read_b128 a[44:47], v29 offset:10240
    v_mfma_f32_16x16x32_bf16 v[104:107], v[168:171], a[96:99], v[104:107]
    ds_read_b128 a[52:55], v29 offset:12288
    v_mfma_f32_16x16x32_bf16 v[108:111], v[172:175], a[96:99], v[108:111]
    v_mfma_f32_16x16x32_bf16 v[112:115], v[160:163], a[104:107], v[112:115]
    v_mfma_f32_16x16x32_bf16 v[116:119], v[164:167], a[104:107], v[116:119]
    v_mfma_f32_16x16x32_bf16 v[120:123], v[168:171], a[104:107], v[120:123]
    v_mfma_f32_16x16x32_bf16 v[124:127], v[172:175], a[104:107], v[124:127]
    v_mfma_f32_16x16x32_bf16 v[128:131], v[160:163], a[112:115], v[128:131]
    v_mfma_f32_16x16x32_bf16 v[132:135], v[164:167], a[112:115], v[132:135]
    v_mfma_f32_16x16x32_bf16 v[136:139], v[168:171], a[112:115], v[136:139]
    v_mfma_f32_16x16x32_bf16 v[140:143], v[172:175], a[112:115], v[140:143]
    ds_read_b128 v[160:163], v20 offset:16384
    ds_read_b128 v[164:167], v20 offset:18432
    ds_read_b128 v[168:171], v20 offset:20480
    ds_read_b128 v[172:175], v20 offset:22528
    s_waitcnt lgkmcnt(4)
    v_mfma_f32_16x16x32_bf16 v[32:35], v[176:179], a[68:71], v[32:35]
    v_mfma_f32_16x16x32_bf16 v[36:39], v[180:183], a[68:71], v[36:39]
    v_mfma_f32_16x16x32_bf16 v[40:43], v[184:187], a[68:71], v[40:43]
    v_mfma_f32_16x16x32_bf16 v[44:47], v[188:191], a[68:71], v[44:47]
    v_mfma_f32_16x16x32_bf16 v[48:51], v[176:179], a[76:79], v[48:51]
    v_mfma_f32_16x16x32_bf16 v[52:55], v[180:183], a[76:79], v[52:55]
    v_mfma_f32_16x16x32_bf16 v[56:59], v[184:187], a[76:79], v[56:59]
    v_mfma_f32_16x16x32_bf16 v[60:63], v[188:191], a[76:79], v[60:63]
    v_mfma_f32_16x16x32_bf16 v[64:67], v[176:179], a[84:87], v[64:67]
    v_mfma_f32_16x16x32_bf16 v[68:71], v[180:183], a[84:87], v[68:71]
    v_mfma_f32_16x16x32_bf16 v[72:75], v[184:187], a[84:87], v[72:75]
    v_mfma_f32_16x16x32_bf16 v[76:79], v[188:191], a[84:87], v[76:79]
    v_mfma_f32_16x16x32_bf16 v[80:83], v[176:179], a[92:95], v[80:83]
    v_mfma_f32_16x16x32_bf16 v[84:87], v[180:183], a[92:95], v[84:87]
    v_mfma_f32_16x16x32_bf16 v[88:91], v[184:187], a[92:95], v[88:91]
    v_mfma_f32_16x16x32_bf16 v[92:95], v[188:191], a[92:95], v[92:95]
    v_mfma_f32_16x16x32_bf16 v[96:99], v[176:179], a[100:103], v[96:99]
    v_mfma_f32_16x16x32_bf16 v[100:103], v[180:183], a[100:103], v[100:103]
    v_mfma_f32_16x16x32_bf16 v[104:107], v[184:187], a[100:103], v[104:107]
    v_mfma_f32_16x16x32_bf16 v[108:111], v[188:191], a[100:103], v[108:111]
    v_mfma_f32_16x16x32_bf16 v[112:115], v[176:179], a[108:111], v[112:115]
    v_mfma_f32_16x16x32_bf16 v[116:119], v[180:183], a[108:111], v[116:119]
    v_mfma_f32_16x16x32_bf16 v[120:123], v[184:187], a[108:111], v[120:123]
    v_mfma_f32_16x16x32_bf16 v[124:127], v[188:191], a[108:111], v[124:127]
    v_mfma_f32_16x16x32_bf16 v[128:131], v[176:179], a[116:119], v[128:131]
    v_mfma_f32_16x16x32_bf16 v[132:135], v[180:183], a[116:119], v[132:135]
    v_mfma_f32_16x16x32_bf16 v[136:139], v[184:187], a[116:119], v[136:139]
    v_mfma_f32_16x16x32_bf16 v[140:143], v[188:191], a[116:119], v[140:143]
    ds_read_b128 v[176:179], v21 offset:16384
    ds_read_b128 v[180:183], v21 offset:18432
    ds_read_b128 v[184:187], v21 offset:20480
    ds_read_b128 v[188:191], v21 offset:22528
    s_waitcnt lgkmcnt(4)
    v_mfma_f32_16x16x32_bf16 v[32:35], v[160:163], a[0:3], v[32:35]
    v_mfma_f32_16x16x32_bf16 v[36:39], v[164:167], a[0:3], v[36:39]
    v_mfma_f32_16x16x32_bf16 v[40:43], v[168:171], a[0:3], v[40:43]
    v_mfma_f32_16x16x32_bf16 v[44:47], v[172:175], a[0:3], v[44:47]
    v_mfma_f32_16x16x32_bf16 v[48:51], v[160:163], a[8:11], v[48:51]
    s_waitcnt vmcnt(0)
    v_mfma_f32_16x16x32_bf16 v[52:55], v[164:167], a[8:11], v[52:55]
    ds_read_b128 a[64:67], v28 offset:14336
    v_mfma_f32_16x16x32_bf16 v[56:59], v[168:171], a[8:11], v[56:59]
    ds_read_b128 a[72:75], v28 offset:16384
    v_mfma_f32_16x16x32_bf16 v[60:63], v[172:175], a[8:11], v[60:63]
    ds_read_b128 a[80:83], v28 offset:18432
    v_mfma_f32_16x16x32_bf16 v[64:67], v[160:163], a[16:19], v[64:67]
    ds_read_b128 a[88:91], v28 offset:20480
    v_mfma_f32_16x16x32_bf16 v[68:71], v[164:167], a[16:19], v[68:71]
    ds_read_b128 a[96:99], v28 offset:22528
    v_mfma_f32_16x16x32_bf16 v[72:75], v[168:171], a[16:19], v[72:75]
    ds_read_b128 a[104:107], v28 offset:24576
    v_mfma_f32_16x16x32_bf16 v[76:79], v[172:175], a[16:19], v[76:79]
    ds_read_b128 a[112:115], v28 offset:26624
    v_mfma_f32_16x16x32_bf16 v[80:83], v[160:163], a[24:27], v[80:83]
    ds_read_b128 a[68:71], v29 offset:14336
    v_mfma_f32_16x16x32_bf16 v[84:87], v[164:167], a[24:27], v[84:87]
    ds_read_b128 a[76:79], v29 offset:16384
    v_mfma_f32_16x16x32_bf16 v[88:91], v[168:171], a[24:27], v[88:91]
    ds_read_b128 a[84:87], v29 offset:18432
    v_mfma_f32_16x16x32_bf16 v[92:95], v[172:175], a[24:27], v[92:95]
    ds_read_b128 a[92:95], v29 offset:20480
    v_mfma_f32_16x16x32_bf16 v[96:99], v[160:163], a[32:35], v[96:99]
    ds_read_b128 a[100:103], v29 offset:22528
    v_mfma_f32_16x16x32_bf16 v[100:103], v[164:167], a[32:35], v[100:103]
    ds_read_b128 a[108:111], v29 offset:24576
    v_mfma_f32_16x16x32_bf16 v[104:107], v[168:171], a[32:35], v[104:107]
    ds_read_b128 a[116:119], v29 offset:26624
    v_mfma_f32_16x16x32_bf16 v[108:111], v[172:175], a[32:35], v[108:111]
    v_mfma_f32_16x16x32_bf16 v[112:115], v[160:163], a[40:43], v[112:115]
    v_mfma_f32_16x16x32_bf16 v[116:119], v[164:167], a[40:43], v[116:119]
    v_mfma_f32_16x16x32_bf16 v[120:123], v[168:171], a[40:43], v[120:123]
    v_mfma_f32_16x16x32_bf16 v[124:127], v[172:175], a[40:43], v[124:127]
    v_mfma_f32_16x16x32_bf16 v[128:131], v[160:163], a[48:51], v[128:131]
    v_mfma_f32_16x16x32_bf16 v[132:135], v[164:167], a[48:51], v[132:135]
    v_mfma_f32_16x16x32_bf16 v[136:139], v[168:171], a[48:51], v[136:139]
    v_mfma_f32_16x16x32_bf16 v[140:143], v[172:175], a[48:51], v[140:143]
    ds_read_b128 v[160:163], v20 offset:24576
    ds_read_b128 v[164:167], v20 offset:26624
    ds_read_b128 v[168:171], v20 offset:28672
    ds_read_b128 v[172:175], v20 offset:30720
    s_waitcnt lgkmcnt(4)
    v_mfma_f32_16x16x32_bf16 v[32:35], v[176:179], a[4:7], v[32:35]
    v_mfma_f32_16x16x32_bf16 v[36:39], v[180:183], a[4:7], v[36:39]
    v_mfma_f32_16x16x32_bf16 v[40:43], v[184:187], a[4:7], v[40:43]
    v_mfma_f32_16x16x32_bf16 v[44:47], v[188:191], a[4:7], v[44:47]
    v_mfma_f32_16x16x32_bf16 v[48:51], v[176:179], a[12:15], v[48:51]
    v_mfma_f32_16x16x32_bf16 v[52:55], v[180:183], a[12:15], v[52:55]
    v_mfma_f32_16x16x32_bf16 v[56:59], v[184:187], a[12:15], v[56:59]
    v_mfma_f32_16x16x32_bf16 v[60:63], v[188:191], a[12:15], v[60:63]
    v_mfma_f32_16x16x32_bf16 v[64:67], v[176:179], a[20:23], v[64:67]
    v_mfma_f32_16x16x32_bf16 v[68:71], v[180:183], a[20:23], v[68:71]
    v_mfma_f32_16x16x32_bf16 v[72:75], v[184:187], a[20:23], v[72:75]
    v_mfma_f32_16x16x32_bf16 v[76:79], v[188:191], a[20:23], v[76:79]
    v_mfma_f32_16x16x32_bf16 v[80:83], v[176:179], a[28:31], v[80:83]
    v_mfma_f32_16x16x32_bf16 v[84:87], v[180:183], a[28:31], v[84:87]
    v_mfma_f32_16x16x32_bf16 v[88:91], v[184:187], a[28:31], v[88:91]
    v_mfma_f32_16x16x32_bf16 v[92:95], v[188:191], a[28:31], v[92:95]
    v_mfma_f32_16x16x32_bf16 v[96:99], v[176:179], a[36:39], v[96:99]
    v_mfma_f32_16x16x32_bf16 v[100:103], v[180:183], a[36:39], v[100:103]
    v_mfma_f32_16x16x32_bf16 v[104:107], v[184:187], a[36:39], v[104:107]
    v_mfma_f32_16x16x32_bf16 v[108:111], v[188:191], a[36:39], v[108:111]
    v_mfma_f32_16x16x32_bf16 v[112:115], v[176:179], a[44:47], v[112:115]
    v_mfma_f32_16x16x32_bf16 v[116:119], v[180:183], a[44:47], v[116:119]
    v_mfma_f32_16x16x32_bf16 v[120:123], v[184:187], a[44:47], v[120:123]
    v_mfma_f32_16x16x32_bf16 v[124:127], v[188:191], a[44:47], v[124:127]
    v_mfma_f32_16x16x32_bf16 v[128:131], v[176:179], a[52:55], v[128:131]
    v_mfma_f32_16x16x32_bf16 v[132:135], v[180:183], a[52:55], v[132:135]
    v_mfma_f32_16x16x32_bf16 v[136:139], v[184:187], a[52:55], v[136:139]
    v_mfma_f32_16x16x32_bf16 v[140:143], v[188:191], a[52:55], v[140:143]
    ds_read_b128 v[176:179], v21 offset:24576
    ds_read_b128 v[180:183], v21 offset:26624
    ds_read_b128 v[184:187], v21 offset:28672
    ds_read_b128 v[188:191], v21 offset:30720
    s_waitcnt lgkmcnt(4)
    v_mfma_f32_16x16x32_bf16 v[32:35], v[160:163], a[64:67], v[32:35]
    v_mfma_f32_16x16x32_bf16 v[36:39], v[164:167], a[64:67], v[36:39]
    v_mfma_f32_16x16x32_bf16 v[40:43], v[168:171], a[64:67], v[40:43]
    v_mfma_f32_16x16x32_bf16 v[44:47], v[172:175], a[64:67], v[44:47]
    v_mfma_f32_16x16x32_bf16 v[48:51], v[160:163], a[72:75], v[48:51]
    v_mfma_f32_16x16x32_bf16 v[52:55], v[164:167], a[72:75], v[52:55]
    v_mfma_f32_16x16x32_bf16 v[56:59], v[168:171], a[72:75], v[56:59]
    v_mfma_f32_16x16x32_bf16 v[60:63], v[172:175], a[72:75], v[60:63]
    v_mfma_f32_16x16x32_bf16 v[64:67], v[160:163], a[80:83], v[64:67]
    v_mfma_f32_16x16x32_bf16 v[68:71], v[164:167], a[80:83], v[68:71]
    v_mfma_f32_16x16x32_bf16 v[72:75], v[168:171], a[80:83], v[72:75]
    v_mfma_f32_16x16x32_bf16 v[76:79], v[172:175], a[80:83], v[76:79]
    v_mfma_f32_16x16x32_bf16 v[80:83], v[160:163], a[88:91], v[80:83]
    v_mfma_f32_16x16x32_bf16 v[84:87], v[164:167], a[88:91], v[84:87]
    v_mfma_f32_16x16x32_bf16 v[88:91], v[168:171], a[88:91], v[88:91]
    v_mfma_f32_16x16x32_bf16 v[92:95], v[172:175], a[88:91], v[92:95]
    v_mfma_f32_16x16x32_bf16 v[96:99], v[160:163], a[96:99], v[96:99]
    v_mfma_f32_16x16x32_bf16 v[100:103], v[164:167], a[96:99], v[100:103]
    v_mfma_f32_16x16x32_bf16 v[104:107], v[168:171], a[96:99], v[104:107]
    v_mfma_f32_16x16x32_bf16 v[108:111], v[172:175], a[96:99], v[108:111]
    v_mfma_f32_16x16x32_bf16 v[112:115], v[160:163], a[104:107], v[112:115]
    v_mfma_f32_16x16x32_bf16 v[116:119], v[164:167], a[104:107], v[116:119]
    v_mfma_f32_16x16x32_bf16 v[120:123], v[168:171], a[104:107], v[120:123]
    v_mfma_f32_16x16x32_bf16 v[124:127], v[172:175], a[104:107], v[124:127]
    v_mfma_f32_16x16x32_bf16 v[128:131], v[160:163], a[112:115], v[128:131]
    v_mfma_f32_16x16x32_bf16 v[132:135], v[164:167], a[112:115], v[132:135]
    v_mfma_f32_16x16x32_bf16 v[136:139], v[168:171], a[112:115], v[136:139]
    v_mfma_f32_16x16x32_bf16 v[140:143], v[172:175], a[112:115], v[140:143]
    s_waitcnt lgkmcnt(0)
    v_mfma_f32_16x16x32_bf16 v[32:35], v[176:179], a[68:71], v[32:35]
    v_mfma_f32_16x16x32_bf16 v[36:39], v[180:183], a[68:71], v[36:39]
    v_mfma_f32_16x16x32_bf16 v[40:43], v[184:187], a[68:71], v[40:43]
    v_mfma_f32_16x16x32_bf16 v[44:47], v[188:191], a[68:71], v[44:47]
    v_mfma_f32_16x16x32_bf16 v[48:51], v[176:179], a[76:79], v[48:51]
    v_mfma_f32_16x16x32_bf16 v[52:55], v[180:183], a[76:79], v[52:55]
    v_mfma_f32_16x16x32_bf16 v[56:59], v[184:187], a[76:79], v[56:59]
    v_mfma_f32_16x16x32_bf16 v[60:63], v[188:191], a[76:79], v[60:63]
    v_mfma_f32_16x16x32_bf16 v[64:67], v[176:179], a[84:87], v[64:67]
    v_mfma_f32_16x16x32_bf16 v[68:71], v[180:183], a[84:87], v[68:71]
    v_mfma_f32_16x16x32_bf16 v[72:75], v[184:187], a[84:87], v[72:75]
    v_mfma_f32_16x16x32_bf16 v[76:79], v[188:191], a[84:87], v[76:79]
    v_mfma_f32_16x16x32_bf16 v[80:83], v[176:179], a[92:95], v[80:83]
    v_mfma_f32_16x16x32_bf16 v[84:87], v[180:183], a[92:95], v[84:87]
    v_mfma_f32_16x16x32_bf16 v[88:91], v[184:187], a[92:95], v[88:91]
    v_mfma_f32_16x16x32_bf16 v[92:95], v[188:191], a[92:95], v[92:95]
    v_mfma_f32_16x16x32_bf16 v[96:99], v[176:179], a[100:103], v[96:99]
    v_mfma_f32_16x16x32_bf16 v[100:103], v[180:183], a[100:103], v[100:103]
    v_mfma_f32_16x16x32_bf16 v[104:107], v[184:187], a[100:103], v[104:107]
    v_mfma_f32_16x16x32_bf16 v[108:111], v[188:191], a[100:103], v[108:111]
    v_mfma_f32_16x16x32_bf16 v[112:115], v[176:179], a[108:111], v[112:115]
    v_mfma_f32_16x16x32_bf16 v[116:119], v[180:183], a[108:111], v[116:119]
    v_mfma_f32_16x16x32_bf16 v[120:123], v[184:187], a[108:111], v[120:123]
    v_mfma_f32_16x16x32_bf16 v[124:127], v[188:191], a[108:111], v[124:127]
    v_mfma_f32_16x16x32_bf16 v[128:131], v[176:179], a[116:119], v[128:131]
    v_mfma_f32_16x16x32_bf16 v[132:135], v[180:183], a[116:119], v[132:135]
    v_mfma_f32_16x16x32_bf16 v[136:139], v[184:187], a[116:119], v[136:139]
    v_mfma_f32_16x16x32_bf16 v[140:143], v[188:191], a[116:119], v[140:143]
    v_lshlrev_b32 v20, 4, v0
    s_lshl_b32 s20, s16, 2
    s_add_u32 s20, s20, s3
    s_mul_i32 s20, s20, 100352
    s_lshl_b32 s21, s17, 11
    s_add_u32 s20, s20, s21
    v_add_u32 v21, s20, v20
    s_mov_b32 s22, 0x3db8aa3b
    v_mul_f32 v32, s22, v32
    v_mul_f32 v33, s22, v33
    v_mul_f32 v34, s22, v34
    v_mul_f32 v35, s22, v35
    v_mul_f32 v36, s22, v36
    v_mul_f32 v37, s22, v37
    v_mul_f32 v38, s22, v38
    v_mul_f32 v39, s22, v39
    v_cvt_pk_bf16_f32 v160, v32, v33
    v_cvt_pk_bf16_f32 v161, v34, v35
    v_cvt_pk_bf16_f32 v162, v36, v37
    v_cvt_pk_bf16_f32 v163, v38, v39
    global_store_dwordx4 v21, v[160:163], s[12:13] offset:0
    v_mul_f32 v40, s22, v40
    v_mul_f32 v41, s22, v41
    v_mul_f32 v42, s22, v42
    v_mul_f32 v43, s22, v43
    v_mul_f32 v44, s22, v44
    v_mul_f32 v45, s22, v45
    v_mul_f32 v46, s22, v46
    v_mul_f32 v47, s22, v47
    v_cvt_pk_bf16_f32 v164, v40, v41
    v_cvt_pk_bf16_f32 v165, v42, v43
    v_cvt_pk_bf16_f32 v166, v44, v45
    v_cvt_pk_bf16_f32 v167, v46, v47
    global_store_dwordx4 v21, v[164:167], s[12:13] offset:1024
    v_add_u32 v21, 14336, v21
    v_mul_f32 v48, s22, v48
    v_mul_f32 v49, s22, v49
    v_mul_f32 v50, s22, v50
    v_mul_f32 v51, s22, v51
    v_mul_f32 v52, s22, v52
    v_mul_f32 v53, s22, v53
    v_mul_f32 v54, s22, v54
    v_mul_f32 v55, s22, v55
    v_cvt_pk_bf16_f32 v168, v48, v49
    v_cvt_pk_bf16_f32 v169, v50, v51
    v_cvt_pk_bf16_f32 v170, v52, v53
    v_cvt_pk_bf16_f32 v171, v54, v55
    global_store_dwordx4 v21, v[168:171], s[12:13] offset:0
    v_mul_f32 v56, s22, v56
    v_mul_f32 v57, s22, v57
    v_mul_f32 v58, s22, v58
    v_mul_f32 v59, s22, v59
    v_mul_f32 v60, s22, v60
    v_mul_f32 v61, s22, v61
    v_mul_f32 v62, s22, v62
    v_mul_f32 v63, s22, v63
    v_cvt_pk_bf16_f32 v172, v56, v57
    v_cvt_pk_bf16_f32 v173, v58, v59
    v_cvt_pk_bf16_f32 v174, v60, v61
    v_cvt_pk_bf16_f32 v175, v62, v63
    global_store_dwordx4 v21, v[172:175], s[12:13] offset:1024
    v_add_u32 v21, 14336, v21
    v_mul_f32 v64, s22, v64
    v_mul_f32 v65, s22, v65
    v_mul_f32 v66, s22, v66
    v_mul_f32 v67, s22, v67
    v_mul_f32 v68, s22, v68
    v_mul_f32 v69, s22, v69
    v_mul_f32 v70, s22, v70
    v_mul_f32 v71, s22, v71
    v_cvt_pk_bf16_f32 v160, v64, v65
    v_cvt_pk_bf16_f32 v161, v66, v67
    v_cvt_pk_bf16_f32 v162, v68, v69
    v_cvt_pk_bf16_f32 v163, v70, v71
    global_store_dwordx4 v21, v[160:163], s[12:13] offset:0
    v_mul_f32 v72, s22, v72
    v_mul_f32 v73, s22, v73
    v_mul_f32 v74, s22, v74
    v_mul_f32 v75, s22, v75
    v_mul_f32 v76, s22, v76
    v_mul_f32 v77, s22, v77
    v_mul_f32 v78, s22, v78
    v_mul_f32 v79, s22, v79
    v_cvt_pk_bf16_f32 v164, v72, v73
    v_cvt_pk_bf16_f32 v165, v74, v75
    v_cvt_pk_bf16_f32 v166, v76, v77
    v_cvt_pk_bf16_f32 v167, v78, v79
    global_store_dwordx4 v21, v[164:167], s[12:13] offset:1024
    v_add_u32 v21, 14336, v21
    v_mul_f32 v80, s22, v80
    v_mul_f32 v81, s22, v81
    v_mul_f32 v82, s22, v82
    v_mul_f32 v83, s22, v83
    v_mul_f32 v84, s22, v84
    v_mul_f32 v85, s22, v85
    v_mul_f32 v86, s22, v86
    v_mul_f32 v87, s22, v87
    v_cvt_pk_bf16_f32 v168, v80, v81
    v_cvt_pk_bf16_f32 v169, v82, v83
    v_cvt_pk_bf16_f32 v170, v84, v85
    v_cvt_pk_bf16_f32 v171, v86, v87
    global_store_dwordx4 v21, v[168:171], s[12:13] offset:0
    v_mul_f32 v88, s22, v88
    v_mul_f32 v89, s22, v89
    v_mul_f32 v90, s22, v90
    v_mul_f32 v91, s22, v91
    v_mul_f32 v92, s22, v92
    v_mul_f32 v93, s22, v93
    v_mul_f32 v94, s22, v94
    v_mul_f32 v95, s22, v95
    v_cvt_pk_bf16_f32 v172, v88, v89
    v_cvt_pk_bf16_f32 v173, v90, v91
    v_cvt_pk_bf16_f32 v174, v92, v93
    v_cvt_pk_bf16_f32 v175, v94, v95
    global_store_dwordx4 v21, v[172:175], s[12:13] offset:1024
    v_add_u32 v21, 14336, v21
    v_mul_f32 v96, s22, v96
    v_mul_f32 v97, s22, v97
    v_mul_f32 v98, s22, v98
    v_mul_f32 v99, s22, v99
    v_mul_f32 v100, s22, v100
    v_mul_f32 v101, s22, v101
    v_mul_f32 v102, s22, v102
    v_mul_f32 v103, s22, v103
    v_cvt_pk_bf16_f32 v160, v96, v97
    v_cvt_pk_bf16_f32 v161, v98, v99
    v_cvt_pk_bf16_f32 v162, v100, v101
    v_cvt_pk_bf16_f32 v163, v102, v103
    global_store_dwordx4 v21, v[160:163], s[12:13] offset:0
    v_mul_f32 v104, s22, v104
    v_mul_f32 v105, s22, v105
    v_mul_f32 v106, s22, v106
    v_mul_f32 v107, s22, v107
    v_mul_f32 v108, s22, v108
    v_mul_f32 v109, s22, v109
    v_mul_f32 v110, s22, v110
    v_mul_f32 v111, s22, v111
    v_cvt_pk_bf16_f32 v164, v104, v105
    v_cvt_pk_bf16_f32 v165, v106, v107
    v_cvt_pk_bf16_f32 v166, v108, v109
    v_cvt_pk_bf16_f32 v167, v110, v111
    global_store_dwordx4 v21, v[164:167], s[12:13] offset:1024
    v_add_u32 v21, 14336, v21
    v_mul_f32 v112, s22, v112
    v_mul_f32 v113, s22, v113
    v_mul_f32 v114, s22, v114
    v_mul_f32 v115, s22, v115
    v_mul_f32 v116, s22, v116
    v_mul_f32 v117, s22, v117
    v_mul_f32 v118, s22, v118
    v_mul_f32 v119, s22, v119
    v_cvt_pk_bf16_f32 v168, v112, v113
    v_cvt_pk_bf16_f32 v169, v114, v115
    v_cvt_pk_bf16_f32 v170, v116, v117
    v_cvt_pk_bf16_f32 v171, v118, v119
    global_store_dwordx4 v21, v[168:171], s[12:13] offset:0
    v_mul_f32 v120, s22, v120
    v_mul_f32 v121, s22, v121
    v_mul_f32 v122, s22, v122
    v_mul_f32 v123, s22, v123
    v_mul_f32 v124, s22, v124
    v_mul_f32 v125, s22, v125
    v_mul_f32 v126, s22, v126
    v_mul_f32 v127, s22, v127
    v_cvt_pk_bf16_f32 v172, v120, v121
    v_cvt_pk_bf16_f32 v173, v122, v123
    v_cvt_pk_bf16_f32 v174, v124, v125
    v_cvt_pk_bf16_f32 v175, v126, v127
    global_store_dwordx4 v21, v[172:175], s[12:13] offset:1024
    v_add_u32 v21, 14336, v21
    v_mul_f32 v128, s22, v128
    v_mul_f32 v129, s22, v129
    v_mul_f32 v130, s22, v130
    v_mul_f32 v131, s22, v131
    v_mul_f32 v132, s22, v132
    v_mul_f32 v133, s22, v133
    v_mul_f32 v134, s22, v134
    v_mul_f32 v135, s22, v135
    v_cvt_pk_bf16_f32 v160, v128, v129
    v_cvt_pk_bf16_f32 v161, v130, v131
    v_cvt_pk_bf16_f32 v162, v132, v133
    v_cvt_pk_bf16_f32 v163, v134, v135
    global_store_dwordx4 v21, v[160:163], s[12:13] offset:0
    v_mul_f32 v136, s22, v136
    v_mul_f32 v137, s22, v137
    v_mul_f32 v138, s22, v138
    v_mul_f32 v139, s22, v139
    v_mul_f32 v140, s22, v140
    v_mul_f32 v141, s22, v141
    v_mul_f32 v142, s22, v142
    v_mul_f32 v143, s22, v143
    v_cvt_pk_bf16_f32 v164, v136, v137
    v_cvt_pk_bf16_f32 v165, v138, v139
    v_cvt_pk_bf16_f32 v166, v140, v141
    v_cvt_pk_bf16_f32 v167, v142, v143
    global_store_dwordx4 v21, v[164:167], s[12:13] offset:1024
    s_endpgm
K1_B:
    s_sub_u32 s17, s17, 7
    s_mul_i32 s20, s16, 229376
    s_lshl_b32 s21, s17, 7
    s_add_u32 s20, s20, s21
    s_mul_i32 s21, s3, 57344
    s_add_u32 s20, s20, s21
    v_lshrrev_b32 v7, 3, v0
    v_mul_u32_u24 v7, 896, v7
    v_and_b32 v8, 7, v0
    v_lshl_add_u32 v7, v8, 4, v7
    v_add_u32 v7, s20, v7
    s_lshl_b32 s21, s3, 13
    s_waitcnt lgkmcnt(0)
    s_add_u32 m0, s21, 0
    v_add_u32 v8, 0, v7
    global_load_lds_dwordx4 v8, s[10:11]
    s_add_u32 m0, s21, 1024
    v_add_u32 v8, 7168, v7
    global_load_lds_dwordx4 v8, s[10:11]
    s_add_u32 m0, s21, 2048
    v_add_u32 v8, 14336, v7
    global_load_lds_dwordx4 v8, s[10:11]
    s_add_u32 m0, s21, 3072
    v_add_u32 v8, 21504, v7
    global_load_lds_dwordx4 v8, s[10:11]
    s_add_u32 m0, s21, 4096
    v_add_u32 v8, 28672, v7
    global_load_lds_dwordx4 v8, s[10:11]
    s_add_u32 m0, s21, 5120
    v_add_u32 v8, 35840, v7
    global_load_lds_dwordx4 v8, s[10:11]
    s_add_u32 m0, s21, 6144
    v_add_u32 v8, 43008, v7
    global_load_lds_dwordx4 v8, s[10:11]
    s_add_u32 m0, s21, 7168
    v_add_u32 v8, 50176, v7
    global_load_lds_dwordx4 v8, s[10:11]
    s_mul_i32 s22, s3, 3
    s_min_u32 s23, s3, 1
    s_add_u32 s22, s22, s23
    s_lshl_b32 s23, s22, 18
    s_add_u32 s23, s23, s19
    v_lshrrev_b32 v24, 3, v0
    v_and_b32 v22, 7, v0
    v_xor_b32 v22, v22, v3
    v_lshlrev_b32 v22, 4, v22
    v_add_u32 v22, s19, v22
    v_xor_b32 v23, 64, v22
    v_lshrrev_b32 v25, 2, v24
    v_and_b32 v26, 3, v24
    v_lshl_add_u32 v27, v25, 3, v26
    v_lshrrev_b32 v20, 1, v2
    v_xor_b32 v20, v20, v3
    v_lshlrev_b32 v20, 4, v20
    v_lshl_add_u32 v20, v2, 7, v20
    v_xor_b32 v21, 64, v20
    s_sub_u32 s23, s23, s19
    v_lshl_add_u32 v9, v27, 13, s23
    v_add_u32 v200, 0, v9
    v_add_u32 v200, v200, v22
    v_add_u32 v201, 131072, v9
    v_add_u32 v201, v201, v23
    v_add_u32 v202, 32768, v9
    v_add_u32 v202, v202, v22
    v_add_u32 v203, 163840, v9
    v_add_u32 v203, v203, v23
    v_add_u32 v204, 262144, v9
    v_add_u32 v204, v204, v22
    v_add_u32 v205, 393216, v9
    v_add_u32 v205, v205, v23
    v_add_u32 v206, 294912, v9
    v_add_u32 v206, v206, v22
    v_add_u32 v207, 425984, v9
    v_add_u32 v207, v207, v23
    v_add_u32 v208, 524288, v9
    v_add_u32 v208, v208, v22
    v_add_u32 v209, 655360, v9
    v_add_u32 v209, v209, v23
    v_add_u32 v210, 557056, v9
    v_add_u32 v210, v210, v22
    v_add_u32 v211, 688128, v9
    v_add_u32 v211, v211, v23
    v_add_u32 v212, 786432, v9
    v_add_u32 v212, v212, v22
    v_add_u32 v213, 917504, v9
    v_add_u32 v213, v213, v23
    v_add_u32 v214, 819200, v9
    v_add_u32 v214, v214, v22
    v_add_u32 v215, 950272, v9
    v_add_u32 v215, v215, v23
    v_lshl_add_u32 v19, v3, 3, v4
    v_lshlrev_b32 v19, 7, v19
    v_lshl_add_u32 v19, v5, 4, v19
    s_add_u32 s32, s8, 128
    s_addc_u32 s33, s9, 0
    s_add_u32 s34, s8, 256
    s_addc_u32 s35, s9, 0
    s_add_u32 s36, s8, 384
    s_addc_u32 s37, s9, 0
    s_mul_i32 s24, s3, 32768
    s_add_u32 s24, s24, 32768
    v_add_u32 v28, s24, v20
    v_add_u32 v29, s24, v21
    s_add_u32 m0, s24, 0
    s_nop 0
    global_load_lds_dwordx4 v200, s[8:9]
    s_add_u32 m0, s24, 1024
    s_nop 0
    global_load_lds_dwordx4 v201, s[8:9]
    s_add_u32 m0, s24, 2048
    s_nop 0
    global_load_lds_dwordx4 v202, s[8:9]
    s_add_u32 m0, s24, 3072
    s_nop 0
    global_load_lds_dwordx4 v203, s[8:9]
    s_add_u32 m0, s24, 4096
    s_nop 0
    global_load_lds_dwordx4 v204, s[8:9]
    s_add_u32 m0, s24, 5120
    s_nop 0
    global_load_lds_dwordx4 v205, s[8:9]
    s_add_u32 m0, s24, 6144
    s_nop 0
    global_load_lds_dwordx4 v206, s[8:9]
    s_add_u32 m0, s24, 7168
    s_nop 0
    global_load_lds_dwordx4 v207, s[8:9]
    s_add_u32 m0, s24, 8192
    s_nop 0
    global_load_lds_dwordx4 v208, s[8:9]
    s_add_u32 m0, s24, 9216
    s_nop 0
    global_load_lds_dwordx4 v209, s[8:9]
    s_add_u32 m0, s24, 10240
    s_nop 0
    global_load_lds_dwordx4 v210, s[8:9]
    s_add_u32 m0, s24, 11264
    s_nop 0
    global_load_lds_dwordx4 v211, s[8:9]
    s_add_u32 m0, s24, 12288
    s_nop 0
    global_load_lds_dwordx4 v212, s[8:9]
    s_add_u32 m0, s24, 13312
    s_nop 0
    global_load_lds_dwordx4 v213, s[8:9]
    s_add_u32 m0, s24, 14336
    s_nop 0
    global_load_lds_dwordx4 v214, s[8:9]
    s_add_u32 m0, s24, 15360
    s_nop 0
    global_load_lds_dwordx4 v215, s[8:9]
    s_add_u32 m0, s24, 16384
    s_nop 0
    global_load_lds_dwordx4 v200, s[32:33]
    s_add_u32 m0, s24, 17408
    s_nop 0
    global_load_lds_dwordx4 v201, s[32:33]
    s_add_u32 m0, s24, 18432
    s_nop 0
    global_load_lds_dwordx4 v202, s[32:33]
    s_add_u32 m0, s24, 19456
    s_nop 0
    global_load_lds_dwordx4 v203, s[32:33]
    s_add_u32 m0, s24, 20480
    s_nop 0
    global_load_lds_dwordx4 v204, s[32:33]
    s_add_u32 m0, s24, 21504
    s_nop 0
    global_load_lds_dwordx4 v205, s[32:33]
    s_add_u32 m0, s24, 22528
    s_nop 0
    global_load_lds_dwordx4 v206, s[32:33]
    s_add_u32 m0, s24, 23552
    s_nop 0
    global_load_lds_dwordx4 v207, s[32:33]
    s_add_u32 m0, s24, 24576
    s_nop 0
    global_load_lds_dwordx4 v208, s[32:33]
    s_add_u32 m0, s24, 25600
    s_nop 0
    global_load_lds_dwordx4 v209, s[32:33]
    s_add_u32 m0, s24, 26624
    s_nop 0
    global_load_lds_dwordx4 v210, s[32:33]
    s_add_u32 m0, s24, 27648
    s_nop 0
    global_load_lds_dwordx4 v211, s[32:33]
    s_add_u32 m0, s24, 28672
    s_nop 0
    global_load_lds_dwordx4 v212, s[32:33]
    s_add_u32 m0, s24, 29696
    s_nop 0
    global_load_lds_dwordx4 v213, s[32:33]
    s_add_u32 m0, s24, 30720
    s_nop 0
    global_load_lds_dwordx4 v214, s[32:33]
    s_add_u32 m0, s24, 31744
    s_nop 0
    global_load_lds_dwordx4 v215, s[32:33]
    s_waitcnt vmcnt(16)
    s_barrier
    ds_read_b128 a[0:3], v28 offset:0
    ds_read_b128 a[8:11], v28 offset:2048
    ds_read_b128 a[16:19], v28 offset:4096
    ds_read_b128 a[24:27], v28 offset:6144
    ds_read_b128 a[32:35], v28 offset:8192
    ds_read_b128 a[40:43], v28 offset:10240
    ds_read_b128 a[48:51], v28 offset:12288
    ds_read_b128 a[56:59], v28 offset:14336
    ds_read_b128 a[4:7], v29 offset:0
    ds_read_b128 a[12:15], v29 offset:2048
    ds_read_b128 a[20:23], v29 offset:4096
    ds_read_b128 a[28:31], v29 offset:6144
    ds_read_b128 a[36:39], v29 offset:8192
    ds_read_b128 a[44:47], v29 offset:10240
    ds_read_b128 a[52:55], v29 offset:12288
    ds_read_b128 a[60:63], v29 offset:14336
    ds_read_b64_tr_b16 v[160:161], v19 offset:0
    ds_read_b64_tr_b16 v[162:163], v19 offset:512
    ds_read_b64_tr_b16 v[164:165], v19 offset:8
    ds_read_b64_tr_b16 v[166:167], v19 offset:520
    ds_read_b64_tr_b16 v[168:169], v19 offset:64
    ds_read_b64_tr_b16 v[170:171], v19 offset:576
    ds_read_b64_tr_b16 v[172:173], v19 offset:72
    ds_read_b64_tr_b16 v[174:175], v19 offset:584
    s_waitcnt lgkmcnt(8)
    s_add_u32 m0, s24, 0
    s_nop 0
    global_load_lds_dwordx4 v200, s[34:35]
    s_add_u32 m0, s24, 1024
    s_nop 0
    global_load_lds_dwordx4 v201, s[34:35]
    s_add_u32 m0, s24, 2048
    s_nop 0
    global_load_lds_dwordx4 v202, s[34:35]
    s_add_u32 m0, s24, 3072
    s_nop 0
    global_load_lds_dwordx4 v203, s[34:35]
    s_add_u32 m0, s24, 4096
    s_nop 0
    global_load_lds_dwordx4 v204, s[34:35]
    s_add_u32 m0, s24, 5120
    s_nop 0
    global_load_lds_dwordx4 v205, s[34:35]
    s_add_u32 m0, s24, 6144
    s_nop 0
    global_load_lds_dwordx4 v206, s[34:35]
    s_add_u32 m0, s24, 7168
    s_nop 0
    global_load_lds_dwordx4 v207, s[34:35]
    s_add_u32 m0, s24, 8192
    s_nop 0
    global_load_lds_dwordx4 v208, s[34:35]
    s_add_u32 m0, s24, 9216
    s_nop 0
    global_load_lds_dwordx4 v209, s[34:35]
    s_add_u32 m0, s24, 10240
    s_nop 0
    global_load_lds_dwordx4 v210, s[34:35]
    s_add_u32 m0, s24, 11264
    s_nop 0
    global_load_lds_dwordx4 v211, s[34:35]
    s_add_u32 m0, s24, 12288
    s_nop 0
    global_load_lds_dwordx4 v212, s[34:35]
    s_add_u32 m0, s24, 13312
    s_nop 0
    global_load_lds_dwordx4 v213, s[34:35]
    s_add_u32 m0, s24, 14336
    s_nop 0
    global_load_lds_dwordx4 v214, s[34:35]
    s_add_u32 m0, s24, 15360
    s_nop 0
    global_load_lds_dwordx4 v215, s[34:35]
    ds_read_b64_tr_b16 v[176:177], v19 offset:4096
    ds_read_b64_tr_b16 v[178:179], v19 offset:4608
    ds_read_b64_tr_b16 v[180:181], v19 offset:4104
    ds_read_b64_tr_b16 v[182:183], v19 offset:4616
    ds_read_b64_tr_b16 v[184:185], v19 offset:4160
    ds_read_b64_tr_b16 v[186:187], v19 offset:4672
    ds_read_b64_tr_b16 v[188:189], v19 offset:4168
    ds_read_b64_tr_b16 v[190:191], v19 offset:4680
    s_waitcnt lgkmcnt(8)
    v_mfma_f32_16x16x32_bf16 v[32:35], a[0:3], v[160:163], 0
    v_mfma_f32_16x16x32_bf16 v[36:39], a[0:3], v[164:167], 0
    v_mfma_f32_16x16x32_bf16 v[40:43], a[0:3], v[168:171], 0
    v_mfma_f32_16x16x32_bf16 v[44:47], a[0:3], v[172:175], 0
    v_mfma_f32_16x16x32_bf16 v[48:51], a[8:11], v[160:163], 0
    s_waitcnt vmcnt(16)
    v_mfma_f32_16x16x32_bf16 v[52:55], a[8:11], v[164:167], 0
    ds_read_b128 a[64:67], v28 offset:16384
    v_mfma_f32_16x16x32_bf16 v[56:59], a[8:11], v[168:171], 0
    ds_read_b128 a[72:75], v28 offset:18432
    v_mfma_f32_16x16x32_bf16 v[60:63], a[8:11], v[172:175], 0
    ds_read_b128 a[80:83], v28 offset:20480
    v_mfma_f32_16x16x32_bf16 v[64:67], a[16:19], v[160:163], 0
    ds_read_b128 a[88:91], v28 offset:22528
    v_mfma_f32_16x16x32_bf16 v[68:71], a[16:19], v[164:167], 0
    ds_read_b128 a[96:99], v28 offset:24576
    v_mfma_f32_16x16x32_bf16 v[72:75], a[16:19], v[168:171], 0
    ds_read_b128 a[104:107], v28 offset:26624
    v_mfma_f32_16x16x32_bf16 v[76:79], a[16:19], v[172:175], 0
    ds_read_b128 a[112:115], v28 offset:28672
    v_mfma_f32_16x16x32_bf16 v[80:83], a[24:27], v[160:163], 0
    ds_read_b128 a[120:123], v28 offset:30720
    v_mfma_f32_16x16x32_bf16 v[84:87], a[24:27], v[164:167], 0
    ds_read_b128 a[68:71], v29 offset:16384
    v_mfma_f32_16x16x32_bf16 v[88:91], a[24:27], v[168:171], 0
    ds_read_b128 a[76:79], v29 offset:18432
    v_mfma_f32_16x16x32_bf16 v[92:95], a[24:27], v[172:175], 0
    ds_read_b128 a[84:87], v29 offset:20480
    v_mfma_f32_16x16x32_bf16 v[96:99], a[32:35], v[160:163], 0
    ds_read_b128 a[92:95], v29 offset:22528
    v_mfma_f32_16x16x32_bf16 v[100:103], a[32:35], v[164:167], 0
    ds_read_b128 a[100:103], v29 offset:24576
    v_mfma_f32_16x16x32_bf16 v[104:107], a[32:35], v[168:171], 0
    ds_read_b128 a[108:111], v29 offset:26624
    v_mfma_f32_16x16x32_bf16 v[108:111], a[32:35], v[172:175], 0
    ds_read_b128 a[116:119], v29 offset:28672
    v_mfma_f32_16x16x32_bf16 v[112:115], a[40:43], v[160:163], 0
    ds_read_b128 a[124:127], v29 offset:30720
    v_mfma_f32_16x16x32_bf16 v[116:119], a[40:43], v[164:167], 0
    v_mfma_f32_16x16x32_bf16 v[120:123], a[40:43], v[168:171], 0
    v_mfma_f32_16x16x32_bf16 v[124:127], a[40:43], v[172:175], 0
    v_mfma_f32_16x16x32_bf16 v[128:131], a[48:51], v[160:163], 0
    v_mfma_f32_16x16x32_bf16 v[132:135], a[48:51], v[164:167], 0
    v_mfma_f32_16x16x32_bf16 v[136:139], a[48:51], v[168:171], 0
    v_mfma_f32_16x16x32_bf16 v[140:143], a[48:51], v[172:175], 0
    v_mfma_f32_16x16x32_bf16 v[144:147], a[56:59], v[160:163], 0
    v_mfma_f32_16x16x32_bf16 v[148:151], a[56:59], v[164:167], 0
    v_mfma_f32_16x16x32_bf16 v[152:155], a[56:59], v[168:171], 0
    v_mfma_f32_16x16x32_bf16 v[156:159], a[56:59], v[172:175], 0
    ds_read_b64_tr_b16 v[160:161], v19 offset:8192
    ds_read_b64_tr_b16 v[162:163], v19 offset:8704
    ds_read_b64_tr_b16 v[164:165], v19 offset:8200
    ds_read_b64_tr_b16 v[166:167], v19 offset:8712
    ds_read_b64_tr_b16 v[168:169], v19 offset:8256
    ds_read_b64_tr_b16 v[170:171], v19 offset:8768
    ds_read_b64_tr_b16 v[172:173], v19 offset:8264
    ds_read_b64_tr_b16 v[174:175], v19 offset:8776
    s_waitcnt lgkmcnt(8)
    s_add_u32 m0, s24, 16384
    s_nop 0
    global_load_lds_dwordx4 v200, s[36:37]
    s_add_u32 m0, s24, 17408
    s_nop 0
    global_load_lds_dwordx4 v201, s[36:37]
    s_add_u32 m0, s24, 18432
    s_nop 0
    global_load_lds_dwordx4 v202, s[36:37]
    s_add_u32 m0, s24, 19456
    s_nop 0
    global_load_lds_dwordx4 v203, s[36:37]
    s_add_u32 m0, s24, 20480
    s_nop 0
    global_load_lds_dwordx4 v204, s[36:37]
    s_add_u32 m0, s24, 21504
    s_nop 0
    global_load_lds_dwordx4 v205, s[36:37]
    s_add_u32 m0, s24, 22528
    s_nop 0
    global_load_lds_dwordx4 v206, s[36:37]
    s_add_u32 m0, s24, 23552
    s_nop 0
    global_load_lds_dwordx4 v207, s[36:37]
    s_add_u32 m0, s24, 24576
    s_nop 0
    global_load_lds_dwordx4 v208, s[36:37]
    s_add_u32 m0, s24, 25600
    s_nop 0
    global_load_lds_dwordx4 v209, s[36:37]
    s_add_u32 m0, s24, 26624
    s_nop 0
    global_load_lds_dwordx4 v210, s[36:37]
    s_add_u32 m0, s24, 27648
    s_nop 0
    global_load_lds_dwordx4 v211, s[36:37]
    s_add_u32 m0, s24, 28672
    s_nop 0
    global_load_lds_dwordx4 v212, s[36:37]
    s_add_u32 m0, s24, 29696
    s_nop 0
    global_load_lds_dwordx4 v213, s[36:37]
    s_add_u32 m0, s24, 30720
    s_nop 0
    global_load_lds_dwordx4 v214, s[36:37]
    s_add_u32 m0, s24, 31744
    s_nop 0
    global_load_lds_dwordx4 v215, s[36:37]
    v_mfma_f32_16x16x32_bf16 v[32:35], a[4:7], v[176:179], v[32:35]
    v_mfma_f32_16x16x32_bf16 v[36:39], a[4:7], v[180:183], v[36:39]
    v_mfma_f32_16x16x32_bf16 v[40:43], a[4:7], v[184:187], v[40:43]
    v_mfma_f32_16x16x32_bf16 v[44:47], a[4:7], v[188:191], v[44:47]
    v_mfma_f32_16x16x32_bf16 v[48:51], a[12:15], v[176:179], v[48:51]
    v_mfma_f32_16x16x32_bf16 v[52:55], a[12:15], v[180:183], v[52:55]
    v_mfma_f32_16x16x32_bf16 v[56:59], a[12:15], v[184:187], v[56:59]
    v_mfma_f32_16x16x32_bf16 v[60:63], a[12:15], v[188:191], v[60:63]
    v_mfma_f32_16x16x32_bf16 v[64:67], a[20:23], v[176:179], v[64:67]
    v_mfma_f32_16x16x32_bf16 v[68:71], a[20:23], v[180:183], v[68:71]
    v_mfma_f32_16x16x32_bf16 v[72:75], a[20:23], v[184:187], v[72:75]
    v_mfma_f32_16x16x32_bf16 v[76:79], a[20:23], v[188:191], v[76:79]
    v_mfma_f32_16x16x32_bf16 v[80:83], a[28:31], v[176:179], v[80:83]
    v_mfma_f32_16x16x32_bf16 v[84:87], a[28:31], v[180:183], v[84:87]
    v_mfma_f32_16x16x32_bf16 v[88:91], a[28:31], v[184:187], v[88:91]
    v_mfma_f32_16x16x32_bf16 v[92:95], a[28:31], v[188:191], v[92:95]
    v_mfma_f32_16x16x32_bf16 v[96:99], a[36:39], v[176:179], v[96:99]
    v_mfma_f32_16x16x32_bf16 v[100:103], a[36:39], v[180:183], v[100:103]
    v_mfma_f32_16x16x32_bf16 v[104:107], a[36:39], v[184:187], v[104:107]
    v_mfma_f32_16x16x32_bf16 v[108:111], a[36:39], v[188:191], v[108:111]
    v_mfma_f32_16x16x32_bf16 v[112:115], a[44:47], v[176:179], v[112:115]
    v_mfma_f32_16x16x32_bf16 v[116:119], a[44:47], v[180:183], v[116:119]
    v_mfma_f32_16x16x32_bf16 v[120:123], a[44:47], v[184:187], v[120:123]
    v_mfma_f32_16x16x32_bf16 v[124:127], a[44:47], v[188:191], v[124:127]
    v_mfma_f32_16x16x32_bf16 v[128:131], a[52:55], v[176:179], v[128:131]
    v_mfma_f32_16x16x32_bf16 v[132:135], a[52:55], v[180:183], v[132:135]
    v_mfma_f32_16x16x32_bf16 v[136:139], a[52:55], v[184:187], v[136:139]
    v_mfma_f32_16x16x32_bf16 v[140:143], a[52:55], v[188:191], v[140:143]
    v_mfma_f32_16x16x32_bf16 v[144:147], a[60:63], v[176:179], v[144:147]
    v_mfma_f32_16x16x32_bf16 v[148:151], a[60:63], v[180:183], v[148:151]
    v_mfma_f32_16x16x32_bf16 v[152:155], a[60:63], v[184:187], v[152:155]
    v_mfma_f32_16x16x32_bf16 v[156:159], a[60:63], v[188:191], v[156:159]
    ds_read_b64_tr_b16 v[176:177], v19 offset:12288
    ds_read_b64_tr_b16 v[178:179], v19 offset:12800
    ds_read_b64_tr_b16 v[180:181], v19 offset:12296
    ds_read_b64_tr_b16 v[182:183], v19 offset:12808
    ds_read_b64_tr_b16 v[184:185], v19 offset:12352
    ds_read_b64_tr_b16 v[186:187], v19 offset:12864
    ds_read_b64_tr_b16 v[188:189], v19 offset:12360
    ds_read_b64_tr_b16 v[190:191], v19 offset:12872
    s_waitcnt lgkmcnt(8)
    v_mfma_f32_16x16x32_bf16 v[32:35], a[64:67], v[160:163], v[32:35]
    v_mfma_f32_16x16x32_bf16 v[36:39], a[64:67], v[164:167], v[36:39]
    v_mfma_f32_16x16x32_bf16 v[40:43], a[64:67], v[168:171], v[40:43]
    v_mfma_f32_16x16x32_bf16 v[44:47], a[64:67], v[172:175], v[44:47]
    v_mfma_f32_16x16x32_bf16 v[48:51], a[72:75], v[160:163], v[48:51]
    s_waitcnt vmcnt(16)
    v_mfma_f32_16x16x32_bf16 v[52:55], a[72:75], v[164:167], v[52:55]
    ds_read_b128 a[0:3], v28 offset:0
    v_mfma_f32_16x16x32_bf16 v[56:59], a[72:75], v[168:171], v[56:59]
    ds_read_b128 a[8:11], v28 offset:2048
    v_mfma_f32_16x16x32_bf16 v[60:63], a[72:75], v[172:175], v[60:63]
    ds_read_b128 a[16:19], v28 offset:4096
    v_mfma_f32_16x16x32_bf16 v[64:67], a[80:83], v[160:163], v[64:67]
    ds_read_b128 a[24:27], v28 offset:6144
    v_mfma_f32_16x16x32_bf16 v[68:71], a[80:83], v[164:167], v[68:71]
    ds_read_b128 a[32:35], v28 offset:8192
    v_mfma_f32_16x16x32_bf16 v[72:75], a[80:83], v[168:171], v[72:75]
    ds_read_b128 a[40:43], v28 offset:10240
    v_mfma_f32_16x16x32_bf16 v[76:79], a[80:83], v[172:175], v[76:79]
    ds_read_b128 a[48:51], v28 offset:12288
    v_mfma_f32_16x16x32_bf16 v[80:83], a[88:91], v[160:163], v[80:83]
    ds_read_b128 a[56:59], v28 offset:14336
    v_mfma_f32_16x16x32_bf16 v[84:87], a[88:91], v[164:167], v[84:87]
    ds_read_b128 a[4:7], v29 offset:0
    v_mfma_f32_16x16x32_bf16 v[88:91], a[88:91], v[168:171], v[88:91]
    ds_read_b128 a[12:15], v29 offset:2048
    v_mfma_f32_16x16x32_bf16 v[92:95], a[88:91], v[172:175], v[92:95]
    ds_read_b128 a[20:23], v29 offset:4096
    v_mfma_f32_16x16x32_bf16 v[96:99], a[96:99], v[160:163], v[96:99]
    ds_read_b128 a[28:31], v29 offset:6144
    v_mfma_f32_16x16x32_bf16 v[100:103], a[96:99], v[164:167], v[100:103]
    ds_read_b128 a[36:39], v29 offset:8192
    v_mfma_f32_16x16x32_bf16 v[104:107], a[96:99], v[168:171], v[104:107]
    ds_read_b128 a[44:47], v29 offset:10240
    v_mfma_f32_16x16x32_bf16 v[108:111], a[96:99], v[172:175], v[108:111]
    ds_read_b128 a[52:55], v29 offset:12288
    v_mfma_f32_16x16x32_bf16 v[112:115], a[104:107], v[160:163], v[112:115]
    ds_read_b128 a[60:63], v29 offset:14336
    v_mfma_f32_16x16x32_bf16 v[116:119], a[104:107], v[164:167], v[116:119]
    v_mfma_f32_16x16x32_bf16 v[120:123], a[104:107], v[168:171], v[120:123]
    v_mfma_f32_16x16x32_bf16 v[124:127], a[104:107], v[172:175], v[124:127]
    v_mfma_f32_16x16x32_bf16 v[128:131], a[112:115], v[160:163], v[128:131]
    v_mfma_f32_16x16x32_bf16 v[132:135], a[112:115], v[164:167], v[132:135]
    v_mfma_f32_16x16x32_bf16 v[136:139], a[112:115], v[168:171], v[136:139]
    v_mfma_f32_16x16x32_bf16 v[140:143], a[112:115], v[172:175], v[140:143]
    v_mfma_f32_16x16x32_bf16 v[144:147], a[120:123], v[160:163], v[144:147]
    v_mfma_f32_16x16x32_bf16 v[148:151], a[120:123], v[164:167], v[148:151]
    v_mfma_f32_16x16x32_bf16 v[152:155], a[120:123], v[168:171], v[152:155]
    v_mfma_f32_16x16x32_bf16 v[156:159], a[120:123], v[172:175], v[156:159]
    ds_read_b64_tr_b16 v[160:161], v19 offset:16384
    ds_read_b64_tr_b16 v[162:163], v19 offset:16896
    ds_read_b64_tr_b16 v[164:165], v19 offset:16392
    ds_read_b64_tr_b16 v[166:167], v19 offset:16904
    ds_read_b64_tr_b16 v[168:169], v19 offset:16448
    ds_read_b64_tr_b16 v[170:171], v19 offset:16960
    ds_read_b64_tr_b16 v[172:173], v19 offset:16456
    ds_read_b64_tr_b16 v[174:175], v19 offset:16968
    s_waitcnt lgkmcnt(8)
    v_mfma_f32_16x16x32_bf16 v[32:35], a[68:71], v[176:179], v[32:35]
    v_mfma_f32_16x16x32_bf16 v[36:39], a[68:71], v[180:183], v[36:39]
    v_mfma_f32_16x16x32_bf16 v[40:43], a[68:71], v[184:187], v[40:43]
    v_mfma_f32_16x16x32_bf16 v[44:47], a[68:71], v[188:191], v[44:47]
    v_mfma_f32_16x16x32_bf16 v[48:51], a[76:79], v[176:179], v[48:51]
    v_mfma_f32_16x16x32_bf16 v[52:55], a[76:79], v[180:183], v[52:55]
    v_mfma_f32_16x16x32_bf16 v[56:59], a[76:79], v[184:187], v[56:59]
    v_mfma_f32_16x16x32_bf16 v[60:63], a[76:79], v[188:191], v[60:63]
    v_mfma_f32_16x16x32_bf16 v[64:67], a[84:87], v[176:179], v[64:67]
    v_mfma_f32_16x16x32_bf16 v[68:71], a[84:87], v[180:183], v[68:71]
    v_mfma_f32_16x16x32_bf16 v[72:75], a[84:87], v[184:187], v[72:75]
    v_mfma_f32_16x16x32_bf16 v[76:79], a[84:87], v[188:191], v[76:79]
    v_mfma_f32_16x16x32_bf16 v[80:83], a[92:95], v[176:179], v[80:83]
    v_mfma_f32_16x16x32_bf16 v[84:87], a[92:95], v[180:183], v[84:87]
    v_mfma_f32_16x16x32_bf16 v[88:91], a[92:95], v[184:187], v[88:91]
    v_mfma_f32_16x16x32_bf16 v[92:95], a[92:95], v[188:191], v[92:95]
    v_mfma_f32_16x16x32_bf16 v[96:99], a[100:103], v[176:179], v[96:99]
    v_mfma_f32_16x16x32_bf16 v[100:103], a[100:103], v[180:183], v[100:103]
    v_mfma_f32_16x16x32_bf16 v[104:107], a[100:103], v[184:187], v[104:107]
    v_mfma_f32_16x16x32_bf16 v[108:111], a[100:103], v[188:191], v[108:111]
    v_mfma_f32_16x16x32_bf16 v[112:115], a[108:111], v[176:179], v[112:115]
    v_mfma_f32_16x16x32_bf16 v[116:119], a[108:111], v[180:183], v[116:119]
    v_mfma_f32_16x16x32_bf16 v[120:123], a[108:111], v[184:187], v[120:123]
    v_mfma_f32_16x16x32_bf16 v[124:127], a[108:111], v[188:191], v[124:127]
    v_mfma_f32_16x16x32_bf16 v[128:131], a[116:119], v[176:179], v[128:131]
    v_mfma_f32_16x16x32_bf16 v[132:135], a[116:119], v[180:183], v[132:135]
    v_mfma_f32_16x16x32_bf16 v[136:139], a[116:119], v[184:187], v[136:139]
    v_mfma_f32_16x16x32_bf16 v[140:143], a[116:119], v[188:191], v[140:143]
    v_mfma_f32_16x16x32_bf16 v[144:147], a[124:127], v[176:179], v[144:147]
    v_mfma_f32_16x16x32_bf16 v[148:151], a[124:127], v[180:183], v[148:151]
    v_mfma_f32_16x16x32_bf16 v[152:155], a[124:127], v[184:187], v[152:155]
    v_mfma_f32_16x16x32_bf16 v[156:159], a[124:127], v[188:191], v[156:159]
    ds_read_b64_tr_b16 v[176:177], v19 offset:20480
    ds_read_b64_tr_b16 v[178:179], v19 offset:20992
    ds_read_b64_tr_b16 v[180:181], v19 offset:20488
    ds_read_b64_tr_b16 v[182:183], v19 offset:21000
    ds_read_b64_tr_b16 v[184:185], v19 offset:20544
    ds_read_b64_tr_b16 v[186:187], v19 offset:21056
    ds_read_b64_tr_b16 v[188:189], v19 offset:20552
    ds_read_b64_tr_b16 v[190:191], v19 offset:21064
    s_waitcnt lgkmcnt(8)
    v_mfma_f32_16x16x32_bf16 v[32:35], a[0:3], v[160:163], v[32:35]
    v_mfma_f32_16x16x32_bf16 v[36:39], a[0:3], v[164:167], v[36:39]
    v_mfma_f32_16x16x32_bf16 v[40:43], a[0:3], v[168:171], v[40:43]
    v_mfma_f32_16x16x32_bf16 v[44:47], a[0:3], v[172:175], v[44:47]
    v_mfma_f32_16x16x32_bf16 v[48:51], a[8:11], v[160:163], v[48:51]
    s_waitcnt vmcnt(0)
    v_mfma_f32_16x16x32_bf16 v[52:55], a[8:11], v[164:167], v[52:55]
    ds_read_b128 a[64:67], v28 offset:16384
    v_mfma_f32_16x16x32_bf16 v[56:59], a[8:11], v[168:171], v[56:59]
    ds_read_b128 a[72:75], v28 offset:18432
    v_mfma_f32_16x16x32_bf16 v[60:63], a[8:11], v[172:175], v[60:63]
    ds_read_b128 a[80:83], v28 offset:20480
    v_mfma_f32_16x16x32_bf16 v[64:67], a[16:19], v[160:163], v[64:67]
    ds_read_b128 a[88:91], v28 offset:22528
    v_mfma_f32_16x16x32_bf16 v[68:71], a[16:19], v[164:167], v[68:71]
    ds_read_b128 a[96:99], v28 offset:24576
    v_mfma_f32_16x16x32_bf16 v[72:75], a[16:19], v[168:171], v[72:75]
    ds_read_b128 a[104:107], v28 offset:26624
    v_mfma_f32_16x16x32_bf16 v[76:79], a[16:19], v[172:175], v[76:79]
    ds_read_b128 a[112:115], v28 offset:28672
    v_mfma_f32_16x16x32_bf16 v[80:83], a[24:27], v[160:163], v[80:83]
    ds_read_b128 a[120:123], v28 offset:30720
    v_mfma_f32_16x16x32_bf16 v[84:87], a[24:27], v[164:167], v[84:87]
    ds_read_b128 a[68:71], v29 offset:16384
    v_mfma_f32_16x16x32_bf16 v[88:91], a[24:27], v[168:171], v[88:91]
    ds_read_b128 a[76:79], v29 offset:18432
    v_mfma_f32_16x16x32_bf16 v[92:95], a[24:27], v[172:175], v[92:95]
    ds_read_b128 a[84:87], v29 offset:20480
    v_mfma_f32_16x16x32_bf16 v[96:99], a[32:35], v[160:163], v[96:99]
    ds_read_b128 a[92:95], v29 offset:22528
    v_mfma_f32_16x16x32_bf16 v[100:103], a[32:35], v[164:167], v[100:103]
    ds_read_b128 a[100:103], v29 offset:24576
    v_mfma_f32_16x16x32_bf16 v[104:107], a[32:35], v[168:171], v[104:107]
    ds_read_b128 a[108:111], v29 offset:26624
    v_mfma_f32_16x16x32_bf16 v[108:111], a[32:35], v[172:175], v[108:111]
    ds_read_b128 a[116:119], v29 offset:28672
    v_mfma_f32_16x16x32_bf16 v[112:115], a[40:43], v[160:163], v[112:115]
    ds_read_b128 a[124:127], v29 offset:30720
    v_mfma_f32_16x16x32_bf16 v[116:119], a[40:43], v[164:167], v[116:119]
    v_mfma_f32_16x16x32_bf16 v[120:123], a[40:43], v[168:171], v[120:123]
    v_mfma_f32_16x16x32_bf16 v[124:127], a[40:43], v[172:175], v[124:127]
    v_mfma_f32_16x16x32_bf16 v[128:131], a[48:51], v[160:163], v[128:131]
    v_mfma_f32_16x16x32_bf16 v[132:135], a[48:51], v[164:167], v[132:135]
    v_mfma_f32_16x16x32_bf16 v[136:139], a[48:51], v[168:171], v[136:139]
    v_mfma_f32_16x16x32_bf16 v[140:143], a[48:51], v[172:175], v[140:143]
    v_mfma_f32_16x16x32_bf16 v[144:147], a[56:59], v[160:163], v[144:147]
    v_mfma_f32_16x16x32_bf16 v[148:151], a[56:59], v[164:167], v[148:151]
    v_mfma_f32_16x16x32_bf16 v[152:155], a[56:59], v[168:171], v[152:155]
    v_mfma_f32_16x16x32_bf16 v[156:159], a[56:59], v[172:175], v[156:159]
    ds_read_b64_tr_b16 v[160:161], v19 offset:24576
    ds_read_b64_tr_b16 v[162:163], v19 offset:25088
    ds_read_b64_tr_b16 v[164:165], v19 offset:24584
    ds_read_b64_tr_b16 v[166:167], v19 offset:25096
    ds_read_b64_tr_b16 v[168:169], v19 offset:24640
    ds_read_b64_tr_b16 v[170:171], v19 offset:25152
    ds_read_b64_tr_b16 v[172:173], v19 offset:24648
    ds_read_b64_tr_b16 v[174:175], v19 offset:25160
    s_waitcnt lgkmcnt(8)
    v_mfma_f32_16x16x32_bf16 v[32:35], a[4:7], v[176:179], v[32:35]
    v_mfma_f32_16x16x32_bf16 v[36:39], a[4:7], v[180:183], v[36:39]
    v_mfma_f32_16x16x32_bf16 v[40:43], a[4:7], v[184:187], v[40:43]
    v_mfma_f32_16x16x32_bf16 v[44:47], a[4:7], v[188:191], v[44:47]
    v_mfma_f32_16x16x32_bf16 v[48:51], a[12:15], v[176:179], v[48:51]
    v_mfma_f32_16x16x32_bf16 v[52:55], a[12:15], v[180:183], v[52:55]
    v_mfma_f32_16x16x32_bf16 v[56:59], a[12:15], v[184:187], v[56:59]
    v_mfma_f32_16x16x32_bf16 v[60:63], a[12:15], v[188:191], v[60:63]
    v_mfma_f32_16x16x32_bf16 v[64:67], a[20:23], v[176:179], v[64:67]
    v_mfma_f32_16x16x32_bf16 v[68:71], a[20:23], v[180:183], v[68:71]
    v_mfma_f32_16x16x32_bf16 v[72:75], a[20:23], v[184:187], v[72:75]
    v_mfma_f32_16x16x32_bf16 v[76:79], a[20:23], v[188:191], v[76:79]
    v_mfma_f32_16x16x32_bf16 v[80:83], a[28:31], v[176:179], v[80:83]
    v_mfma_f32_16x16x32_bf16 v[84:87], a[28:31], v[180:183], v[84:87]
    v_mfma_f32_16x16x32_bf16 v[88:91], a[28:31], v[184:187], v[88:91]
    v_mfma_f32_16x16x32_bf16 v[92:95], a[28:31], v[188:191], v[92:95]
    v_mfma_f32_16x16x32_bf16 v[96:99], a[36:39], v[176:179], v[96:99]
    v_mfma_f32_16x16x32_bf16 v[100:103], a[36:39], v[180:183], v[100:103]
    v_mfma_f32_16x16x32_bf16 v[104:107], a[36:39], v[184:187], v[104:107]
    v_mfma_f32_16x16x32_bf16 v[108:111], a[36:39], v[188:191], v[108:111]
    v_mfma_f32_16x16x32_bf16 v[112:115], a[44:47], v[176:179], v[112:115]
    v_mfma_f32_16x16x32_bf16 v[116:119], a[44:47], v[180:183], v[116:119]
    v_mfma_f32_16x16x32_bf16 v[120:123], a[44:47], v[184:187], v[120:123]
    v_mfma_f32_16x16x32_bf16 v[124:127], a[44:47], v[188:191], v[124:127]
    v_mfma_f32_16x16x32_bf16 v[128:131], a[52:55], v[176:179], v[128:131]
    v_mfma_f32_16x16x32_bf16 v[132:135], a[52:55], v[180:183], v[132:135]
    v_mfma_f32_16x16x32_bf16 v[136:139], a[52:55], v[184:187], v[136:139]
    v_mfma_f32_16x16x32_bf16 v[140:143], a[52:55], v[188:191], v[140:143]
    v_mfma_f32_16x16x32_bf16 v[144:147], a[60:63], v[176:179], v[144:147]
    v_mfma_f32_16x16x32_bf16 v[148:151], a[60:63], v[180:183], v[148:151]
    v_mfma_f32_16x16x32_bf16 v[152:155], a[60:63], v[184:187], v[152:155]
    v_mfma_f32_16x16x32_bf16 v[156:159], a[60:63], v[188:191], v[156:159]
    ds_read_b64_tr_b16 v[176:177], v19 offset:28672
    ds_read_b64_tr_b16 v[178:179], v19 offset:29184
    ds_read_b64_tr_b16 v[180:181], v19 offset:28680
    ds_read_b64_tr_b16 v[182:183], v19 offset:29192
    ds_read_b64_tr_b16 v[184:185], v19 offset:28736
    ds_read_b64_tr_b16 v[186:187], v19 offset:29248
    ds_read_b64_tr_b16 v[188:189], v19 offset:28744
    ds_read_b64_tr_b16 v[190:191], v19 offset:29256
    s_waitcnt lgkmcnt(8)
    v_mfma_f32_16x16x32_bf16 v[32:35], a[64:67], v[160:163], v[32:35]
    v_mfma_f32_16x16x32_bf16 v[36:39], a[64:67], v[164:167], v[36:39]
    v_mfma_f32_16x16x32_bf16 v[40:43], a[64:67], v[168:171], v[40:43]
    v_mfma_f32_16x16x32_bf16 v[44:47], a[64:67], v[172:175], v[44:47]
    v_mfma_f32_16x16x32_bf16 v[48:51], a[72:75], v[160:163], v[48:51]
    v_mfma_f32_16x16x32_bf16 v[52:55], a[72:75], v[164:167], v[52:55]
    v_mfma_f32_16x16x32_bf16 v[56:59], a[72:75], v[168:171], v[56:59]
    v_mfma_f32_16x16x32_bf16 v[60:63], a[72:75], v[172:175], v[60:63]
    v_mfma_f32_16x16x32_bf16 v[64:67], a[80:83], v[160:163], v[64:67]
    v_mfma_f32_16x16x32_bf16 v[68:71], a[80:83], v[164:167], v[68:71]
    v_mfma_f32_16x16x32_bf16 v[72:75], a[80:83], v[168:171], v[72:75]
    v_mfma_f32_16x16x32_bf16 v[76:79], a[80:83], v[172:175], v[76:79]
    v_mfma_f32_16x16x32_bf16 v[80:83], a[88:91], v[160:163], v[80:83]
    v_mfma_f32_16x16x32_bf16 v[84:87], a[88:91], v[164:167], v[84:87]
    v_mfma_f32_16x16x32_bf16 v[88:91], a[88:91], v[168:171], v[88:91]
    v_mfma_f32_16x16x32_bf16 v[92:95], a[88:91], v[172:175], v[92:95]
    v_mfma_f32_16x16x32_bf16 v[96:99], a[96:99], v[160:163], v[96:99]
    v_mfma_f32_16x16x32_bf16 v[100:103], a[96:99], v[164:167], v[100:103]
    v_mfma_f32_16x16x32_bf16 v[104:107], a[96:99], v[168:171], v[104:107]
    v_mfma_f32_16x16x32_bf16 v[108:111], a[96:99], v[172:175], v[108:111]
    v_mfma_f32_16x16x32_bf16 v[112:115], a[104:107], v[160:163], v[112:115]
    v_mfma_f32_16x16x32_bf16 v[116:119], a[104:107], v[164:167], v[116:119]
    v_mfma_f32_16x16x32_bf16 v[120:123], a[104:107], v[168:171], v[120:123]
    v_mfma_f32_16x16x32_bf16 v[124:127], a[104:107], v[172:175], v[124:127]
    v_mfma_f32_16x16x32_bf16 v[128:131], a[112:115], v[160:163], v[128:131]
    v_mfma_f32_16x16x32_bf16 v[132:135], a[112:115], v[164:167], v[132:135]
    v_mfma_f32_16x16x32_bf16 v[136:139], a[112:115], v[168:171], v[136:139]
    v_mfma_f32_16x16x32_bf16 v[140:143], a[112:115], v[172:175], v[140:143]
    v_mfma_f32_16x16x32_bf16 v[144:147], a[120:123], v[160:163], v[144:147]
    v_mfma_f32_16x16x32_bf16 v[148:151], a[120:123], v[164:167], v[148:151]
    v_mfma_f32_16x16x32_bf16 v[152:155], a[120:123], v[168:171], v[152:155]
    v_mfma_f32_16x16x32_bf16 v[156:159], a[120:123], v[172:175], v[156:159]
    s_waitcnt lgkmcnt(0)
    v_mfma_f32_16x16x32_bf16 v[32:35], a[68:71], v[176:179], v[32:35]
    v_mfma_f32_16x16x32_bf16 v[36:39], a[68:71], v[180:183], v[36:39]
    v_mfma_f32_16x16x32_bf16 v[40:43], a[68:71], v[184:187], v[40:43]
    v_mfma_f32_16x16x32_bf16 v[44:47], a[68:71], v[188:191], v[44:47]
    v_mfma_f32_16x16x32_bf16 v[48:51], a[76:79], v[176:179], v[48:51]
    v_mfma_f32_16x16x32_bf16 v[52:55], a[76:79], v[180:183], v[52:55]
    v_mfma_f32_16x16x32_bf16 v[56:59], a[76:79], v[184:187], v[56:59]
    v_mfma_f32_16x16x32_bf16 v[60:63], a[76:79], v[188:191], v[60:63]
    v_mfma_f32_16x16x32_bf16 v[64:67], a[84:87], v[176:179], v[64:67]
    v_mfma_f32_16x16x32_bf16 v[68:71], a[84:87], v[180:183], v[68:71]
    v_mfma_f32_16x16x32_bf16 v[72:75], a[84:87], v[184:187], v[72:75]
    v_mfma_f32_16x16x32_bf16 v[76:79], a[84:87], v[188:191], v[76:79]
    v_mfma_f32_16x16x32_bf16 v[80:83], a[92:95], v[176:179], v[80:83]
    v_mfma_f32_16x16x32_bf16 v[84:87], a[92:95], v[180:183], v[84:87]
    v_mfma_f32_16x16x32_bf16 v[88:91], a[92:95], v[184:187], v[88:91]
    v_mfma_f32_16x16x32_bf16 v[92:95], a[92:95], v[188:191], v[92:95]
    v_mfma_f32_16x16x32_bf16 v[96:99], a[100:103], v[176:179], v[96:99]
    v_mfma_f32_16x16x32_bf16 v[100:103], a[100:103], v[180:183], v[100:103]
    v_mfma_f32_16x16x32_bf16 v[104:107], a[100:103], v[184:187], v[104:107]
    v_mfma_f32_16x16x32_bf16 v[108:111], a[100:103], v[188:191], v[108:111]
    v_mfma_f32_16x16x32_bf16 v[112:115], a[108:111], v[176:179], v[112:115]
    v_mfma_f32_16x16x32_bf16 v[116:119], a[108:111], v[180:183], v[116:119]
    v_mfma_f32_16x16x32_bf16 v[120:123], a[108:111], v[184:187], v[120:123]
    v_mfma_f32_16x16x32_bf16 v[124:127], a[108:111], v[188:191], v[124:127]
    v_mfma_f32_16x16x32_bf16 v[128:131], a[116:119], v[176:179], v[128:131]
    v_mfma_f32_16x16x32_bf16 v[132:135], a[116:119], v[180:183], v[132:135]
    v_mfma_f32_16x16x32_bf16 v[136:139], a[116:119], v[184:187], v[136:139]
    v_mfma_f32_16x16x32_bf16 v[140:143], a[116:119], v[188:191], v[140:143]
    v_mfma_f32_16x16x32_bf16 v[144:147], a[124:127], v[176:179], v[144:147]
    v_mfma_f32_16x16x32_bf16 v[148:151], a[124:127], v[180:183], v[148:151]
    v_mfma_f32_16x16x32_bf16 v[152:155], a[124:127], v[184:187], v[152:155]
    v_mfma_f32_16x16x32_bf16 v[156:159], a[124:127], v[188:191], v[156:159]
    s_lshl_b32 s20, s17, 5
    s_add_u32 s20, s20, s16
    s_mul_i32 s20, s20, 28672
    s_lshl_b32 s21, s22, 10
    s_add_u32 s20, s20, s21
    s_add_u32 s20, s20, 6422528
    v_lshlrev_b32 v21, 4, v0
    v_add_u32 v21, s20, v21
    v_cvt_pk_bf16_f32 v160, v32, v33
    v_cvt_pk_bf16_f32 v161, v34, v35
    v_cvt_pk_bf16_f32 v162, v48, v49
    v_cvt_pk_bf16_f32 v163, v50, v51
    global_store_dwordx4 v21, v[160:163], s[12:13] offset:0
    v_cvt_pk_bf16_f32 v164, v64, v65
    v_cvt_pk_bf16_f32 v165, v66, v67
    v_cvt_pk_bf16_f32 v166, v80, v81
    v_cvt_pk_bf16_f32 v167, v82, v83
    global_store_dwordx4 v21, v[164:167], s[12:13] offset:1024
    v_cvt_pk_bf16_f32 v168, v96, v97
    v_cvt_pk_bf16_f32 v169, v98, v99
    v_cvt_pk_bf16_f32 v170, v112, v113
    v_cvt_pk_bf16_f32 v171, v114, v115
    global_store_dwordx4 v21, v[168:171], s[12:13] offset:2048
    v_cvt_pk_bf16_f32 v172, v128, v129
    v_cvt_pk_bf16_f32 v173, v130, v131
    v_cvt_pk_bf16_f32 v174, v144, v145
    v_cvt_pk_bf16_f32 v175, v146, v147
    global_store_dwordx4 v21, v[172:175], s[12:13] offset:3072
    v_add_u32 v21, 14336, v21
    v_cvt_pk_bf16_f32 v160, v36, v37
    v_cvt_pk_bf16_f32 v161, v38, v39
    v_cvt_pk_bf16_f32 v162, v52, v53
    v_cvt_pk_bf16_f32 v163, v54, v55
    global_store_dwordx4 v21, v[160:163], s[12:13] offset:0
    v_cvt_pk_bf16_f32 v164, v68, v69
    v_cvt_pk_bf16_f32 v165, v70, v71
    v_cvt_pk_bf16_f32 v166, v84, v85
    v_cvt_pk_bf16_f32 v167, v86, v87
    global_store_dwordx4 v21, v[164:167], s[12:13] offset:1024
    v_cvt_pk_bf16_f32 v168, v100, v101
    v_cvt_pk_bf16_f32 v169, v102, v103
    v_cvt_pk_bf16_f32 v170, v116, v117
    v_cvt_pk_bf16_f32 v171, v118, v119
    global_store_dwordx4 v21, v[168:171], s[12:13] offset:2048
    v_cvt_pk_bf16_f32 v172, v132, v133
    v_cvt_pk_bf16_f32 v173, v134, v135
    v_cvt_pk_bf16_f32 v174, v148, v149
    v_cvt_pk_bf16_f32 v175, v150, v151
    global_store_dwordx4 v21, v[172:175], s[12:13] offset:3072
    v_add_u32 v21, 444416, v21
    v_cvt_pk_bf16_f32 v160, v40, v41
    v_cvt_pk_bf16_f32 v161, v42, v43
    v_cvt_pk_bf16_f32 v162, v56, v57
    v_cvt_pk_bf16_f32 v163, v58, v59
    global_store_dwordx4 v21, v[160:163], s[12:13] offset:0
    v_cvt_pk_bf16_f32 v164, v72, v73
    v_cvt_pk_bf16_f32 v165, v74, v75
    v_cvt_pk_bf16_f32 v166, v88, v89
    v_cvt_pk_bf16_f32 v167, v90, v91
    global_store_dwordx4 v21, v[164:167], s[12:13] offset:1024
    v_cvt_pk_bf16_f32 v168, v104, v105
    v_cvt_pk_bf16_f32 v169, v106, v107
    v_cvt_pk_bf16_f32 v170, v120, v121
    v_cvt_pk_bf16_f32 v171, v122, v123
    global_store_dwordx4 v21, v[168:171], s[12:13] offset:2048
    v_cvt_pk_bf16_f32 v172, v136, v137
    v_cvt_pk_bf16_f32 v173, v138, v139
    v_cvt_pk_bf16_f32 v174, v152, v153
    v_cvt_pk_bf16_f32 v175, v154, v155
    global_store_dwordx4 v21, v[172:175], s[12:13] offset:3072
    v_add_u32 v21, 14336, v21
    v_cvt_pk_bf16_f32 v160, v44, v45
    v_cvt_pk_bf16_f32 v161, v46, v47
    v_cvt_pk_bf16_f32 v162, v60, v61
    v_cvt_pk_bf16_f32 v163, v62, v63
    global_store_dwordx4 v21, v[160:163], s[12:13] offset:0
    v_cvt_pk_bf16_f32 v164, v76, v77
    v_cvt_pk_bf16_f32 v165, v78, v79
    v_cvt_pk_bf16_f32 v166, v92, v93
    v_cvt_pk_bf16_f32 v167, v94, v95
    global_store_dwordx4 v21, v[164:167], s[12:13] offset:1024
    v_cvt_pk_bf16_f32 v168, v108, v109
    v_cvt_pk_bf16_f32 v169, v110, v111
    v_cvt_pk_bf16_f32 v170, v124, v125
    v_cvt_pk_bf16_f32 v171, v126, v127
    global_store_dwordx4 v21, v[168:171], s[12:13] offset:2048
    v_cvt_pk_bf16_f32 v172, v140, v141
    v_cvt_pk_bf16_f32 v173, v142, v143
    v_cvt_pk_bf16_f32 v174, v156, v157
    v_cvt_pk_bf16_f32 v175, v158, v159
    global_store_dwordx4 v21, v[172:175], s[12:13] offset:3072
    s_endpgm
K1_misc:
    s_sub_u32 s17, s17, 28
    s_lshl_b32 s17, s17, 3
    s_add_u32 s17, s17, s16
    s_lshl_b32 s18, s17, 12
    s_lshl_b32 s19, s3, 10
    s_add_u32 s18, s18, s19
    v_lshlrev_b32 v2, 4, v0
    v_add_u32 v3, s18, v2
    v_add_u32 v2, s19, v2
    v_mov_b32 v4, -1
    v_mov_b32 v5, -1
    v_mov_b32 v6, -1
    v_mov_b32 v7, -1
    s_mov_b32 s23, 0x20000
    s_lshl_b32 s24, s17, 1
    s_lshr_b32 s25, s3, 1
    s_add_u32 s24, s24, s25
    s_mul_i32 s24, s24, 28672
    s_and_b32 s25, s3, 1
    s_mul_i32 s26, s25, 448
    s_add_u32 s26, s26, s24
    v_and_b32 v8, 15, v0
    v_lshrrev_b32 v9, 4, v0
    v_mul_u32_u24 v8, 896, v8
    v_lshl_add_u32 v8, v9, 4, v8
    v_add_u32 v8, s26, v8
    v_add_u32 v9, 14336, v8
    s_mul_i32 s25, s25, 14336
    s_add_u32 s24, s24, s25
    s_add_u32 s24, s24, 53710848
    v_lshlrev_b32 v10, 4, v0
    v_add_u32 v10, s24, v10
    v_add_u32 v11, 8192, v10
    s_waitcnt lgkmcnt(0)
    global_load_dwordx4 v[32:35], v8, s[28:29] offset:0
    global_load_dwordx4 v[36:39], v9, s[28:29] offset:0
    global_load_dwordx4 v[40:43], v8, s[28:29] offset:64
    global_load_dwordx4 v[44:47], v9, s[28:29] offset:64
    global_load_dwordx4 v[48:51], v8, s[28:29] offset:128
    global_load_dwordx4 v[52:55], v9, s[28:29] offset:128
    global_load_dwordx4 v[56:59], v8, s[28:29] offset:192
    global_load_dwordx4 v[60:63], v9, s[28:29] offset:192
    global_load_dwordx4 v[64:67], v8, s[28:29] offset:256
    global_load_dwordx4 v[68:71], v9, s[28:29] offset:256
    global_load_dwordx4 v[72:75], v8, s[28:29] offset:320
    global_load_dwordx4 v[76:79], v9, s[28:29] offset:320
    global_load_dwordx4 v[80:83], v8, s[28:29] offset:384
    global_load_dwordx4 v[84:87], v9, s[28:29] offset:384
    s_add_u32 s20, s12, 12852224
    s_addc_u32 s21, s13, 0
    s_mov_b32 s22, 451584
    s_mov_b32 s24, 0
    buffer_store_dwordx4 v[4:7], v3, s[20:23], s24 offen
    s_mov_b32 s24, 131072
    buffer_store_dwordx4 v[4:7], v3, s[20:23], s24 offen
    s_mov_b32 s24, 262144
    buffer_store_dwordx4 v[4:7], v3, s[20:23], s24 offen
    s_mov_b32 s24, 393216
    buffer_store_dwordx4 v[4:7], v3, s[20:23], s24 offen
    s_add_u32 s20, s12, 13769728
    s_addc_u32 s21, s13, 0
    s_mov_b32 s22, 451584
    s_mov_b32 s24, 0
    buffer_store_dwordx4 v[4:7], v3, s[20:23], s24 offen
    s_mov_b32 s24, 131072
    buffer_store_dwordx4 v[4:7], v3, s[20:23], s24 offen
    s_mov_b32 s24, 262144
    buffer_store_dwordx4 v[4:7], v3, s[20:23], s24 offen
    s_mov_b32 s24, 393216
    buffer_store_dwordx4 v[4:7], v3, s[20:23], s24 offen
    s_add_u32 s20, s12, 14680064
    s_addc_u32 s21, s13, 0
    s_mov_b32 s22, 645120
    s_mov_b32 s24, 0
    buffer_store_dwordx4 v[4:7], v3, s[20:23], s24 offen
    s_mov_b32 s24, 131072
    buffer_store_dwordx4 v[4:7], v3, s[20:23], s24 offen
    s_mov_b32 s24, 262144
    buffer_store_dwordx4 v[4:7], v3, s[20:23], s24 offen
    s_mov_b32 s24, 393216
    buffer_store_dwordx4 v[4:7], v3, s[20:23], s24 offen
    s_mov_b32 s24, 524288
    buffer_store_dwordx4 v[4:7], v3, s[20:23], s24 offen
    s_waitcnt vmcnt(13)
    global_store_dwordx4 v10, v[32:35], s[12:13] offset:-4096
    global_store_dwordx4 v10, v[36:39], s[12:13] offset:-3072
    global_store_dwordx4 v10, v[40:43], s[12:13] offset:-2048
    global_store_dwordx4 v10, v[44:47], s[12:13] offset:-1024
    global_store_dwordx4 v10, v[48:51], s[12:13] offset:0
    global_store_dwordx4 v10, v[52:55], s[12:13] offset:1024
    global_store_dwordx4 v10, v[56:59], s[12:13] offset:2048
    global_store_dwordx4 v10, v[60:63], s[12:13] offset:3072
    global_store_dwordx4 v11, v[64:67], s[12:13] offset:-4096
    global_store_dwordx4 v11, v[68:71], s[12:13] offset:-3072
    global_store_dwordx4 v11, v[72:75], s[12:13] offset:-2048
    global_store_dwordx4 v11, v[76:79], s[12:13] offset:-1024
    global_store_dwordx4 v11, v[80:83], s[12:13] offset:0
    global_store_dwordx4 v11, v[84:87], s[12:13] offset:1024
    s_cmp_gt_u32 s17, 9
    s_cbranch_scc1 K1_end
    s_cmp_lt_u32 s17, 2
    s_cbranch_scc1 K1_mem0
    v_mov_b32 v8, 0
    v_mov_b32 v9, 0
    v_mov_b32 v10, 0
    v_mov_b32 v11, 0
    v_add_u32 v3, 15327232, v3
    global_store_dwordx4 v3, v[8:11], s[12:13]
    s_endpgm
K1_mem0:
    s_nop 0
    v_lshrrev_b32 v8, 4, v3
    v_cmp_gt_u32 vcc, 448, v8
    s_and_saveexec_b64 s[26:27], vcc
    s_cbranch_execz K1_end
    v_and_b32 v9, 7, v8
    v_mul_u32_u24 v9, 896, v9
    v_lshrrev_b32 v10, 3, v8
    v_lshl_add_u32 v10, v10, 4, v9
    global_load_dwordx4 v[12:15], v10, s[14:15]
    v_lshrrev_b32 v10, 4, v8
    v_lshl_add_u32 v9, v10, 5, v9
    v_bfe_u32 v10, v8, 3, 1
    v_lshl_add_u32 v9, v10, 2, v9
    global_load_dword v16, v9, s[14:15]
    global_load_dword v17, v9, s[14:15] offset:8
    global_load_dword v18, v9, s[14:15] offset:16
    global_load_dword v19, v9, s[14:15] offset:24
    v_add_u32 v20, 13303808, v3
    v_add_u32 v21, 14221312, v3
    v_add_u32 v22, 12845056, v3
    v_add_u32 v23, 13762560, v3
    s_mov_b32 s24, -2
    s_waitcnt vmcnt(0)
    v_min_u32 v12, s24, v12
    v_min_u32 v13, s24, v13
    v_min_u32 v14, s24, v14
    v_min_u32 v15, s24, v15
    v_min_u32 v16, s24, v16
    v_min_u32 v17, s24, v17
    v_min_u32 v18, s24, v18
    v_min_u32 v19, s24, v19
    global_store_dwordx4 v20, v[12:15], s[12:13]
    global_store_dwordx4 v21, v[12:15], s[12:13]
    global_store_dwordx4 v22, v[16:19], s[12:13]
    global_store_dwordx4 v23, v[16:19], s[12:13]
K1_end:
    s_endpgm
.globl main_kernel
.p2align 8
.type main_kernel,@function
main_kernel:
    s_load_dwordx4 s[4:7], s[0:1], 0
    s_load_dwordx4 s[8:11], s[0:1], 16
    s_load_dwordx2 s[12:13], s[0:1], 96
    s_load_dwordx2 s[14:15], s[0:1], 80
    s_load_dwordx2 s[16:17], s[0:1], 88
    s_getreg_b32 s20, hwreg(HW_REG_XCC_ID, 0, 4)
    s_cmp_ge_u32 s2, 256
    s_cbranch_scc1 K2_end
    v_lshrrev_b32 v1, 6, v0
    v_and_b32 v0, 63, v0
    v_readfirstlane_b32 s3, v1
    v_lshlrev_b32 v1, 4, v0
    s_and_b32 s20, s20, 7
    s_waitcnt lgkmcnt(0)
    s_add_u32 s18, s12, 15335424
    s_addc_u32 s19, s13, 0
    s_cmp_eq_u32 s3, 0
    s_cbranch_scc1 K2_nopf
    s_getpc_b64 s[40:41]
K2_pc:
    s_lshr_b32 s42, s2, 3
    s_and_b32 s42, s42, 3
    s_mul_i32 s42, s42, 3
    s_add_u32 s42, s42, s3
    s_sub_u32 s42, s42, 1
    s_lshl_b32 s42, s42, 13
    v_lshl_add_u32 v10, v0, 7, s42
    v_min_u32 v10, K2_end-main_kernel, v10
    s_sub_u32 s40, s40, K2_pc-main_kernel
    s_subb_u32 s41, s41, 0
    v_mov_b32 v11, s41
    v_add_co_u32 v10, vcc, s40, v10
    v_addc_co_u32 v11, vcc, 0, v11, vcc
    global_load_dword v10, v[10:11], off
    s_waitcnt vmcnt(0)
K2_nopf:
    s_cmp_lg_u32 s3, 0
    s_cbranch_scc1 BC_1
    s_mov_b64 exec, 1
    s_add_u32 s21, s20, 1
    v_mov_b32 v4, s21
    v_mov_b32 v5, 0
    v_mov_b32 v3, 8192
    s_lshl_b32 s22, s20, 7
    v_mov_b32 v6, s22
    v_add_u32 v6, 8320, v6
    v_mov_b32 v7, 1
    global_atomic_cmpswap v4, v3, v[4:5], s[18:19] sc0 sc1
    global_atomic_add v2, v6, v7, s[18:19] sc0 sc1
    s_waitcnt vmcnt(0)
    v_readfirstlane_b32 s22, v4
    v_readfirstlane_b32 s23, v2
    s_cmp_eq_u32 s22, 0
    s_cselect_b32 s22, s21, s22
    s_cmp_lg_u32 s22, s21
    s_cselect_b32 s23, 99, s23
    s_cmp_lt_u32 s23, 31
    s_cbranch_scc1 EL_2
    v_mov_b32 v3, 9344
    global_atomic_add v2, v3, v7, s[18:19] sc0 sc1
    s_waitcnt vmcnt(0)
    v_add_u32 v2, 32, v2
EL_2:
    s_lshl_b32 s22, s22, 16
    v_or_b32 v2, s22, v2
    v_mov_b32 v3, 163584
    ds_write_b32 v3, v2
    s_mov_b64 exec, -1
    s_waitcnt lgkmcnt(0)
BC_1:
    s_barrier
    v_mov_b32 v3, 163584
    ds_read_b32 v2, v3
    s_waitcnt lgkmcnt(0)
    v_readfirstlane_b32 s21, v2
    s_lshr_b32 s22, s21, 16
    s_and_b32 s21, s21, 0xffff
    s_cmp_lt_u32 s21, 32
    s_cbranch_scc1 ROLE_CHAIN
    s_sub_u32 s21, s21, 32
    s_cmp_ge_u32 s21, 120
    s_cbranch_scc1 ROLE_FFT
    s_mov_b32 s29, 0
    s_sub_u32 s23, s21, 30
    s_cmp_ge_u32 s21, 30
    s_cselect_b32 s21, s23, s21
    s_addc_u32 s29, s29, 0
    s_sub_u32 s23, s21, 30
    s_cmp_ge_u32 s21, 30
    s_cselect_b32 s21, s23, s21
    s_addc_u32 s29, s29, 0
    s_sub_u32 s23, s21, 30
    s_cmp_ge_u32 s21, 30
    s_cselect_b32 s21, s23, s21
    s_addc_u32 s29, s29, 0
    s_cmp_lt_u32 s21, 14
    s_cbranch_scc1 ROLE_HB
    s_sub_u32 s21, s21, 14
    s_branch ROLE_HA
ROLE_CHAIN:
    v_mbcnt_lo_u32_b32 v0, -1, 0
    v_mbcnt_hi_u32_b32 v0, -1, v0
    v_lshlrev_b32 v1, 4, v0
    s_cmp_lg_u32 s3, 0
    s_cbranch_scc1 RG_3
    s_mov_b64 exec, 1
    s_add_u32 s23, s20, 1
    s_cmp_eq_u32 s23, s22
    s_cselect_b32 s23, 1, 0
    s_add_u32 s23, s23, 0x100
    v_mov_b32 v2, s23
    v_mov_b32 v3, 9600
    global_atomic_add v3, v2, s[18:19] sc1
    s_mov_b64 exec, -1
RG_3:
    s_cmp_eq_u32 s21, 30
    s_cbranch_scc1 ROLE_CP
    s_mov_b32 s43, 1
    s_cmp_lt_u32 s21, 16
    s_cbranch_scc0 CH_B
    s_mov_b32 s26, s21
    s_branch LOAD_A
CH_B:
    s_sub_u32 s26, s21, 16
    s_branch LOAD_B
ROLE_HA:
    s_mov_b32 s43, 0
    s_mov_b32 s26, s21
LOAD_A:
    s_lshl_b32 s28, s3, 1
    s_mul_i32 s28, s28, s43
    s_add_u32 s27, s28, 0
    s_sub_u32 s44, s27, 7
    s_cmp_ge_u32 s27, 7
    s_cselect_b32 s27, s44, s27
    s_lshl_b32 s60, s27, 11
    s_add_u32 s27, s28, 1
    s_sub_u32 s44, s27, 7
    s_cmp_ge_u32 s27, 7
    s_cselect_b32 s27, s44, s27
    s_lshl_b32 s61, s27, 11
    s_add_u32 s27, s28, 2
    s_sub_u32 s44, s27, 7
    s_cmp_ge_u32 s27, 7
    s_cselect_b32 s27, s44, s27
    s_lshl_b32 s62, s27, 11
    s_add_u32 s27, s28, 3
    s_sub_u32 s44, s27, 7
    s_cmp_ge_u32 s27, 7
    s_cselect_b32 s27, s44, s27
    s_lshl_b32 s63, s27, 11
    s_add_u32 s27, s28, 4
    s_sub_u32 s44, s27, 7
    s_cmp_ge_u32 s27, 7
    s_cselect_b32 s27, s44, s27
    s_lshl_b32 s64, s27, 11
    s_add_u32 s27, s28, 5
    s_sub_u32 s44, s27, 7
    s_cmp_ge_u32 s27, 7
    s_cselect_b32 s27, s44, s27
    s_lshl_b32 s65, s27, 11
    s_add_u32 s27, s28, 6
    s_sub_u32 s44, s27, 7
    s_cmp_ge_u32 s27, 7
    s_cselect_b32 s27, s44, s27
    s_lshl_b32 s66, s27, 11
    s_lshl_b32 s27, s26, 2
    s_add_u32 s27, s27, s3
    s_mul_i32 s27, s27, 100352
    v_add_u32 v3, s27, v1
    v_add_u32 v2, s60, v3
    global_load_dwordx4 a[0:3], v2, s[12:13] offset:0
    global_load_dwordx4 a[4:7], v2, s[12:13] offset:1024
    v_add_u32 v2, s61, v3
    global_load_dwordx4 a[8:11], v2, s[12:13] offset:0
    global_load_dwordx4 a[12:15], v2, s[12:13] offset:1024
    v_add_u32 v2, s62, v3
    global_load_dwordx4 a[16:19], v2, s[12:13] offset:0
    global_load_dwordx4 a[20:23], v2, s[12:13] offset:1024
    v_add_u32 v2, s63, v3
    global_load_dwordx4 a[24:27], v2, s[12:13] offset:0
    global_load_dwordx4 a[28:31], v2, s[12:13] offset:1024
    v_add_u32 v2, s64, v3
    global_load_dwordx4 a[32:35], v2, s[12:13] offset:0
    global_load_dwordx4 a[36:39], v2, s[12:13] offset:1024
    v_add_u32 v2, s65, v3
    global_load_dwordx4 a[40:43], v2, s[12:13] offset:0
    global_load_dwordx4 a[44:47], v2, s[12:13] offset:1024
    v_add_u32 v2, s66, v3
    global_load_dwordx4 a[48:51], v2, s[12:13] offset:0
    global_load_dwordx4 a[52:55], v2, s[12:13] offset:1024
    v_add_u32 v3, 14336, v3
    v_add_u32 v2, s60, v3
    global_load_dwordx4 a[56:59], v2, s[12:13] offset:0
    global_load_dwordx4 a[60:63], v2, s[12:13] offset:1024
    v_add_u32 v2, s61, v3
    global_load_dwordx4 a[64:67], v2, s[12:13] offset:0
    global_load_dwordx4 a[68:71], v2, s[12:13] offset:1024
    v_add_u32 v2, s62, v3
    global_load_dwordx4 a[72:75], v2, s[12:13] offset:0
    global_load_dwordx4 a[76:79], v2, s[12:13] offset:1024
    v_add_u32 v2, s63, v3
    global_load_dwordx4 a[80:83], v2, s[12:13] offset:0
    global_load_dwordx4 a[84:87], v2, s[12:13] offset:1024
    v_add_u32 v2, s64, v3
    global_load_dwordx4 a[88:91], v2, s[12:13] offset:0
    global_load_dwordx4 a[92:95], v2, s[12:13] offset:1024
    v_add_u32 v2, s65, v3
    global_load_dwordx4 a[96:99], v2, s[12:13] offset:0
    global_load_dwordx4 a[100:103], v2, s[12:13] offset:1024
    v_add_u32 v2, s66, v3
    global_load_dwordx4 a[104:107], v2, s[12:13] offset:0
    global_load_dwordx4 a[108:111], v2, s[12:13] offset:1024
    v_add_u32 v3, 14336, v3
    v_add_u32 v2, s60, v3
    global_load_dwordx4 a[112:115], v2, s[12:13] offset:0
    global_load_dwordx4 a[116:119], v2, s[12:13] offset:1024
    v_add_u32 v2, s61, v3
    global_load_dwordx4 a[120:123], v2, s[12:13] offset:0
    global_load_dwordx4 a[124:127], v2, s[12:13] offset:1024
    v_add_u32 v2, s62, v3
    global_load_dwordx4 a[128:131], v2, s[12:13] offset:0
    global_load_dwordx4 a[132:135], v2, s[12:13] offset:1024
    v_add_u32 v2, s63, v3
    global_load_dwordx4 a[136:139], v2, s[12:13] offset:0
    global_load_dwordx4 a[140:143], v2, s[12:13] offset:1024
    v_add_u32 v2, s64, v3
    global_load_dwordx4 a[144:147], v2, s[12:13] offset:0
    global_load_dwordx4 a[148:151], v2, s[12:13] offset:1024
    v_add_u32 v2, s65, v3
    global_load_dwordx4 a[152:155], v2, s[12:13] offset:0
    global_load_dwordx4 a[156:159], v2, s[12:13] offset:1024
    v_add_u32 v2, s66, v3
    global_load_dwordx4 a[160:163], v2, s[12:13] offset:0
    global_load_dwordx4 a[164:167], v2, s[12:13] offset:1024
    v_add_u32 v3, 14336, v3
    v_add_u32 v2, s60, v3
    global_load_dwordx4 a[168:171], v2, s[12:13] offset:0
    global_load_dwordx4 a[172:175], v2, s[12:13] offset:1024
    v_add_u32 v2, s61, v3
    global_load_dwordx4 a[176:179], v2, s[12:13] offset:0
    global_load_dwordx4 a[180:183], v2, s[12:13] offset:1024
    v_add_u32 v2, s62, v3
    global_load_dwordx4 a[184:187], v2, s[12:13] offset:0
    global_load_dwordx4 a[188:191], v2, s[12:13] offset:1024
    v_add_u32 v2, s63, v3
    global_load_dwordx4 a[192:195], v2, s[12:13] offset:0
    global_load_dwordx4 a[196:199], v2, s[12:13] offset:1024
    v_add_u32 v2, s64, v3
    global_load_dwordx4 a[200:203], v2, s[12:13] offset:0
    global_load_dwordx4 a[204:207], v2, s[12:13] offset:1024
    v_add_u32 v2, s65, v3
    global_load_dwordx4 a[208:211], v2, s[12:13] offset:0
    global_load_dwordx4 a[212:215], v2, s[12:13] offset:1024
    v_add_u32 v2, s66, v3
    global_load_dwordx4 a[216:219], v2, s[12:13] offset:0
    global_load_dwordx4 a[220:223], v2, s[12:13] offset:1024
    v_add_u32 v3, 14336, v3
    s_waitcnt vmcnt(42)
    v_add_u32 v2, s60, v3
    global_load_dwordx4 a[224:227], v2, s[12:13] offset:0
    global_load_dwordx4 a[228:231], v2, s[12:13] offset:1024
    v_add_u32 v2, s61, v3
    global_load_dwordx4 a[232:235], v2, s[12:13] offset:0
    global_load_dwordx4 a[236:239], v2, s[12:13] offset:1024
    v_add_u32 v2, s62, v3
    global_load_dwordx4 a[240:243], v2, s[12:13] offset:0
    global_load_dwordx4 a[244:247], v2, s[12:13] offset:1024
    v_add_u32 v2, s63, v3
    global_load_dwordx4 a[248:251], v2, s[12:13] offset:0
    global_load_dwordx4 a[252:255], v2, s[12:13] offset:1024
    v_add_u32 v2, s64, v3
    global_load_dwordx4 v[120:123], v2, s[12:13] offset:0
    global_load_dwordx4 v[124:127], v2, s[12:13] offset:1024
    v_add_u32 v2, s65, v3
    global_load_dwordx4 v[128:131], v2, s[12:13] offset:0
    global_load_dwordx4 v[132:135], v2, s[12:13] offset:1024
    v_add_u32 v2, s66, v3
    global_load_dwordx4 v[136:139], v2, s[12:13] offset:0
    global_load_dwordx4 v[140:143], v2, s[12:13] offset:1024
    v_add_u32 v3, 14336, v3
    s_waitcnt vmcnt(42)
    v_add_u32 v2, s60, v3
    global_load_dwordx4 v[144:147], v2, s[12:13] offset:0
    global_load_dwordx4 v[148:151], v2, s[12:13] offset:1024
    v_add_u32 v2, s61, v3
    global_load_dwordx4 v[152:155], v2, s[12:13] offset:0
    global_load_dwordx4 v[156:159], v2, s[12:13] offset:1024
    v_add_u32 v2, s62, v3
    global_load_dwordx4 v[160:163], v2, s[12:13] offset:0
    global_load_dwordx4 v[164:167], v2, s[12:13] offset:1024
    v_add_u32 v2, s63, v3
    global_load_dwordx4 v[168:171], v2, s[12:13] offset:0
    global_load_dwordx4 v[172:175], v2, s[12:13] offset:1024
    v_add_u32 v2, s64, v3
    global_load_dwordx4 v[176:179], v2, s[12:13] offset:0
    global_load_dwordx4 v[180:183], v2, s[12:13] offset:1024
    v_add_u32 v2, s65, v3
    global_load_dwordx4 v[184:187], v2, s[12:13] offset:0
    global_load_dwordx4 v[188:191], v2, s[12:13] offset:1024
    v_add_u32 v2, s66, v3
    global_load_dwordx4 v[192:195], v2, s[12:13] offset:0
    global_load_dwordx4 v[196:199], v2, s[12:13] offset:1024
    v_add_u32 v3, 14336, v3
    s_waitcnt vmcnt(42)
    v_add_u32 v2, s60, v3
    global_load_dwordx4 v[200:203], v2, s[12:13] offset:0
    global_load_dwordx4 v[204:207], v2, s[12:13] offset:1024
    v_add_u32 v2, s61, v3
    global_load_dwordx4 v[208:211], v2, s[12:13] offset:0
    global_load_dwordx4 v[212:215], v2, s[12:13] offset:1024
    v_add_u32 v2, s62, v3
    global_load_dwordx4 v[216:219], v2, s[12:13] offset:0
    global_load_dwordx4 v[220:223], v2, s[12:13] offset:1024
    v_add_u32 v2, s63, v3
    global_load_dwordx4 v[224:227], v2, s[12:13] offset:0
    global_load_dwordx4 v[228:231], v2, s[12:13] offset:1024
    v_add_u32 v2, s64, v3
    global_load_dwordx4 v[232:235], v2, s[12:13] offset:0
    global_load_dwordx4 v[236:239], v2, s[12:13] offset:1024
    v_add_u32 v2, s65, v3
    global_load_dwordx4 v[240:243], v2, s[12:13] offset:0
    global_load_dwordx4 v[244:247], v2, s[12:13] offset:1024
    v_add_u32 v2, s66, v3
    global_load_dwordx4 v[248:251], v2, s[12:13] offset:0
    global_load_dwordx4 v[252:255], v2, s[12:13] offset:1024
    s_waitcnt vmcnt(42)
    s_cmp_eq_u32 s43, 0
    s_cbranch_scc1 HA_start
    v_and_b32 v2, 8, v0
    v_cmp_ne_u32 s[50:51], 0, v2
    v_mov_b32 v2, 0x4444
    v_mov_b32 v3, 0xeeee
    v_cndmask_b32 v4, v2, v3, s[50:51]
    v_and_b32 v8, 15, v0
    v_lshrrev_b32 v9, 4, v0
    s_mul_i32 s27, s3, 14
    v_add_u32 v10, s27, v9
    v_lshrrev_b32 v11, 1, v9
    v_add3_u32 v11, v11, s27, 12
    v_and_b32 v12, 7, v8
    v_lshlrev_b32 v12, 4, v12
    v_lshrrev_b32 v14, 1, v10
    v_lshl_add_u32 v5, v14, 8, v12
    v_and_b32 v14, 1, v10
    v_lshl_add_u32 v5, v14, 3, v5
    v_add_u32 v5, 16384, v5
    v_lshrrev_b32 v14, 1, v11
    v_lshl_add_u32 v6, v14, 8, v12
    v_and_b32 v14, 1, v11
    v_lshl_add_u32 v6, v14, 3, v6
    v_add_u32 v6, 16384, v6
    v_and_b32 v14, 1, v9
    v_cmp_eq_u32 vcc, 1, v14
    v_mov_b32 v14, 32768
    s_nop 0
    v_cndmask_b32 v6, v6, v14, vcc
    v_mov_b64 v[16:17], 0
    v_mov_b64 v[18:19], 0
    v_add_u32 v14, 32768, v1
    ds_write_b128 v14, v[16:19]
    v_lshrrev_b32 v14, 2, v10
    v_and_b32 v15, 3, v10
    v_lshlrev_b32 v13, 11, v14
    v_lshl_add_u32 v13, v15, 8, v13
    v_lshl_add_u32 v13, v8, 4, v13
    v_lshrrev_b32 v14, 2, v11
    v_and_b32 v15, 3, v11
    v_lshlrev_b32 v7, 11, v14
    v_lshl_add_u32 v7, v15, 8, v7
    v_lshl_add_u32 v7, v8, 4, v7
    v_and_b32 v14, 2, v8
    v_lshrrev_b32 v15, 3, v8
    v_add_u32 v14, v14, v15
    v_lshlrev_b32 v112, 7, v14
    v_bfe_u32 v14, v8, 2, 1
    v_lshl_add_u32 v112, v14, 3, v112
    v_and_b32 v14, 1, v8
    v_lshl_add_u32 v112, v14, 2, v112
    s_lshl_b32 s27, s26, 9
    v_add_u32 v112, s27, v112
    s_lshl_b32 s27, s26, 7
    s_add_u32 s27, s27, 8192
    v_lshl_add_u32 v113, v8, 2, s27
    v_and_b32 v14, 1, v9
    v_cmp_eq_u32 vcc, 1, v14
    s_nop 1
    v_cndmask_b32 v112, v112, v113, vcc
    v_lshrrev_b32 v15, 1, v9
    v_lshl_add_u32 v112, v15, 4, v112
    s_lshl_b32 s27, s3, 5
    v_add_u32 v112, s27, v112
    s_mul_i32 s27, s3, 3072
    v_add_u32 v114, s27, v1
    v_add_u32 v14, 1, v15
    v_lshlrev_b32 v115, 10, v14
    v_lshl_add_u32 v115, v8, 4, v115
    v_and_b32 v14, 3, v8
    v_lshl_add_u32 v14, v14, 1, v15
    v_lshlrev_b32 v14, 4, v14
    v_cndmask_b32 v115, v115, v14, vcc
    s_lshr_b32 s27, s3, 1
    s_lshl_b32 s27, s27, 8
    s_and_b32 s28, s3, 1
    s_lshl_b32 s28, s28, 3
    s_add_u32 s27, s27, s28
    v_add_u32 v115, s27, v115
    v_and_b32 v10, 1, v9
    v_lshlrev_b32 v10, 2, v10
    v_and_b32 v11, 7, v8
    v_sub_u32 v10, v11, v10
    v_lshrrev_b32 v11, 3, v8
    v_lshl_add_u32 v10, v11, 2, v10
    v_and_b32 v12, 4, v8
    v_lshrrev_b32 v12, 2, v12
    v_and_b32 v14, 1, v9
    v_cmp_eq_u32 vcc, v12, v14
    s_nop 1
    v_cndmask_b32 v10, 15, v10, vcc
    v_mov_b32 v11, 0x3f80
    v_mov_b32 v12, 0x3f800000
    v_cmp_eq_u32 vcc, 0, v10
    s_nop 1
    v_cndmask_b32 v116, 0, v11, vcc
    v_cmp_eq_u32 vcc, 1, v10
    s_nop 1
    v_cndmask_b32 v116, v116, v12, vcc
    v_cmp_eq_u32 vcc, 2, v10
    s_nop 1
    v_cndmask_b32 v117, 0, v11, vcc
    v_cmp_eq_u32 vcc, 3, v10
    s_nop 1
    v_cndmask_b32 v117, v117, v12, vcc
    v_cmp_eq_u32 vcc, 4, v10
    s_nop 1
    v_cndmask_b32 v118, 0, v11, vcc
    v_cmp_eq_u32 vcc, 5, v10
    s_nop 1
    v_cndmask_b32 v118, v118, v12, vcc
    v_cmp_eq_u32 vcc, 6, v10
    s_nop 1
    v_cndmask_b32 v119, 0, v11, vcc
    v_cmp_eq_u32 vcc, 7, v10
    s_nop 1
    v_cndmask_b32 v119, v119, v12, vcc
    v_mov_b64 v[76:77], 0
    v_mov_b64 v[78:79], 0
    v_mov_b64 v[92:93], 0
    v_mov_b64 v[94:95], 0
    s_lshr_b32 s60, s60, 1
    s_lshr_b32 s61, s61, 1
    s_lshr_b32 s62, s62, 1
    s_lshr_b32 s63, s63, 1
    s_lshr_b32 s64, s64, 1
    s_lshr_b32 s65, s65, 1
    s_lshr_b32 s66, s66, 1
    s_sub_u32 s90, s62, s60
    s_sub_u32 s91, s63, s60
    s_sub_u32 s92, s64, s60
    s_sub_u32 s93, s65, s60
    s_sub_u32 s94, s66, s60
    v_mov_b32 v0, v13
    v_add_u32 v113, s61, v1
    v_add_u32 v1, s60, v1
    s_mov_b32 s44, 0x0000ffff
    s_mov_b32 s45, 0x0000ffff
    s_mov_b32 s46, 0x000fffff
    s_mov_b32 s47, 0x000fffff
    s_mov_b32 s40, 0
    s_add_u32 s30, s12, 12845056
    s_addc_u32 s31, s13, 0
    s_add_u32 s36, s12, 14680064
    s_addc_u32 s37, s13, 0
    s_add_u32 s32, s12, 53708800
    s_addc_u32 s33, s13, 0
    s_lshl_b32 s27, s26, 2
    s_add_u32 s27, s27, s3
    s_cmp_lt_u32 s26, 8
    s_cbranch_scc1 A_pf_vo
    s_sub_u32 s27, s27, s26
    s_add_u32 s27, s27, 7
    s_cmp_lg_u32 s3, 0
    s_cbranch_scc1 A_pf_vo
    s_mov_b32 s59, 9600
    s_mov_b32 s55, 0
    s_sub_u32 s27, s26, 8
    s_mul_i32 s27, s27, 7168
    s_add_u32 s27, s27, 53706752
    s_mov_b32 s54, 28672
    s_cmp_lt_u32 s26, 12
    s_cbranch_scc1 A_pf_init
    s_mov_b32 s54, 7168
    s_mov_b32 s27, 12845056
    s_cmp_ge_u32 s26, 14
    s_cselect_b32 s54, 10240, s54
    s_cmp_eq_u32 s26, 14
    s_cselect_b32 s27, 14680064, s27
    s_cmp_eq_u32 s26, 15
    s_cselect_b32 s27, 14682112, s27
A_pf_init:
    v_lshlrev_b32 v3, 3, v1
    s_add_u32 s38, s12, s27
    s_addc_u32 s39, s13, 0
    global_load_dword v2, v3, s[38:39] sc1
    s_add_u32 s38, s38, s54
    s_addc_u32 s39, s39, 0
    global_load_dword v2, v3, s[38:39] sc1
    s_add_u32 s38, s38, s54
    s_addc_u32 s39, s39, 0
    s_branch A_pf_done
A_pf_vo:
    s_and_b32 s59, s27, -4
    s_add_u32 s59, s59, 128
    s_mov_b32 s55, 64
    s_lshl_b32 s27, s27, 13
    s_add_u32 s27, s27, 25264128
    s_mov_b32 s27, 53706752
    s_lshl_b32 s28, s60, 3
    s_sub_u32 s27, s27, s28
    s_mov_b32 s54, 0
    s_add_u32 s38, s12, s27
    s_addc_u32 s39, s13, 0
A_pf_done:
    s_mov_b32 s58, 0
    v_mov_b32 v3, 9600
    s_mov_b32 s24, 524288
TW_4:
    global_load_dword v2, v3, s[18:19] sc1
    s_sub_u32 s24, s24, 1
    s_cbranch_scc1 BAIL_3
    s_waitcnt vmcnt(0)
    v_readfirstlane_b32 s23, v2
    s_cmp_lt_u32 s23, 7936
    s_cbranch_scc1 TW_4
    s_cmp_eq_u32 s23, 7967
    s_cselect_b32 s23, 1, 0
    s_waitcnt lgkmcnt(0)
    s_barrier
    global_load_dwordx4 v[64:67], v0, s[32:33] offset:-2048
    global_load_dwordx4 v[68:71], v0, s[32:33] offset:0
    global_load_dwordx4 v[72:75], v0, s[32:33] offset:2048
    global_load_dwordx4 v[80:83], v0, s[32:33] offset:-1024
    global_load_dwordx4 v[84:87], v0, s[32:33] offset:1024
    global_load_dwordx4 v[88:91], v0, s[32:33] offset:3072
    s_mov_b64 exec, s[44:45]
    global_load_dwordx4 v[76:79], v7, s[32:33] offset:-2048
    global_load_dwordx4 v[92:95], v7, s[32:33] offset:-1024
    s_mov_b64 exec, -1
A_top:
    v_mov_b64 v[36:37], 0
    v_mov_b64 v[38:39], 0
    v_mov_b64 v[40:41], 0
    v_mov_b64 v[42:43], 0
    v_mov_b64 v[44:45], 0
    v_mov_b64 v[46:47], 0
    v_mov_b64 v[48:49], 0
    v_mov_b64 v[50:51], 0
    v_mov_b64 v[52:53], 0
    v_mov_b64 v[54:55], 0
    v_mov_b64 v[56:57], 0
    v_mov_b64 v[58:59], 0
    v_mov_b64 v[60:61], 0
    v_mov_b64 v[62:63], 0
    v_add_u32 v16, s90, v1
    v_add_u32 v20, s91, v1
    v_add_u32 v24, s92, v1
    v_add_u32 v28, s93, v1
    v_add_u32 v32, s94, v1
    v_add_u32 v104, 1024, v5
    s_mov_b32 s41, 524288
    s_mov_b32 s42, 0
    s_sleep 13
    global_load_dwordx4 v[8:11], v1, s[30:31] sc1
    global_load_dwordx4 v[12:15], v113, s[30:31] sc1
    s_sleep 3
A_poll:
    global_load_dwordx4 v[96:99], v1, s[30:31] sc1
    global_load_dwordx4 v[100:103], v113, s[30:31] sc1
    s_waitcnt vmcnt(3)
    v_max3_u32 v2, v8, v9, v10
    s_waitcnt vmcnt(2)
    v_max3_u32 v2, v2, v11, v12
    v_max3_u32 v2, v2, v13, v14
    v_max_u32 v2, v2, v15
    v_cmp_eq_u32 vcc, -1, v2
    s_cbranch_vccz A_g0
    global_load_dwordx4 v[8:11], v1, s[30:31] sc1
    global_load_dwordx4 v[12:15], v113, s[30:31] sc1
    s_waitcnt vmcnt(3)
    v_max3_u32 v2, v96, v97, v98
    s_waitcnt vmcnt(2)
    v_max3_u32 v2, v2, v99, v100
    v_max3_u32 v2, v2, v101, v102
    v_max_u32 v2, v2, v103
    v_cmp_eq_u32 vcc, -1, v2
    s_sub_u32 s41, s41, 1
    s_cbranch_scc1 BAIL_4
    s_cbranch_vccnz A_poll
    v_smfmac_f32_16x16x64_bf16 v[36:39], v[96:99], a[0:7], v4
    v_mov_b64 v[8:9], v[96:97]
    v_mov_b64 v[10:11], v[98:99]
    v_mov_b64 v[12:13], v[100:101]
    v_mov_b64 v[14:15], v[102:103]
    s_branch A_go1
A_g0:
    v_smfmac_f32_16x16x64_bf16 v[36:39], v[8:11], a[0:7], v4
A_go1:
    ds_write_b128 v1, v[8:11] offset:16384
    v_smfmac_f32_16x16x64_bf16 v[40:43], v[8:11], a[56:63], v4
    ds_write_b128 v113, v[12:15] offset:16384
    v_smfmac_f32_16x16x64_bf16 v[44:47], v[8:11], a[112:119], v4
    v_lshlrev_b32 v3, 3, v1
    v_smfmac_f32_16x16x64_bf16 v[48:51], v[8:11], a[168:175], v4
    v_smfmac_f32_16x16x64_bf16 v[52:55], v[8:11], a[224:231], v4
    v_smfmac_f32_16x16x64_bf16 v[56:59], v[8:11], v[144:151], v4
    s_waitcnt lgkmcnt(0)
    s_barrier
    ds_read_b128 v[16:19], v16 offset:16384
    v_smfmac_f32_16x16x64_bf16 v[60:63], v[8:11], v[200:207], v4
    ds_read_b128 v[20:23], v20 offset:16384
    v_smfmac_f32_16x16x64_bf16 v[36:39], v[12:15], a[8:15], v4
    ds_read_b128 v[24:27], v24 offset:16384
    v_smfmac_f32_16x16x64_bf16 v[40:43], v[12:15], a[64:71], v4
    ds_read_b128 v[28:31], v28 offset:16384
    v_smfmac_f32_16x16x64_bf16 v[44:47], v[12:15], a[120:127], v4
    ds_read_b128 v[32:35], v32 offset:16384
    v_smfmac_f32_16x16x64_bf16 v[48:51], v[12:15], a[176:183], v4
    s_cmp_lg_u32 s58, 0
    s_cselect_b64 exec, -1, 1
    global_load_dword v3, v3, s[38:39] sc1
    s_mov_b64 exec, -1
    v_smfmac_f32_16x16x64_bf16 v[52:55], v[12:15], a[232:239], v4
    v_smfmac_f32_16x16x64_bf16 v[56:59], v[12:15], v[152:159], v4
    v_smfmac_f32_16x16x64_bf16 v[60:63], v[12:15], v[208:215], v4
    s_waitcnt lgkmcnt(4)
    v_smfmac_f32_16x16x64_bf16 v[36:39], v[16:19], a[16:23], v4
    v_smfmac_f32_16x16x64_bf16 v[40:43], v[16:19], a[72:79], v4
    v_smfmac_f32_16x16x64_bf16 v[44:47], v[16:19], a[128:135], v4
    v_smfmac_f32_16x16x64_bf16 v[48:51], v[16:19], a[184:191], v4
    v_smfmac_f32_16x16x64_bf16 v[52:55], v[16:19], a[240:247], v4
    v_smfmac_f32_16x16x64_bf16 v[56:59], v[16:19], v[160:167], v4
    v_smfmac_f32_16x16x64_bf16 v[60:63], v[16:19], v[216:223], v4
    s_waitcnt lgkmcnt(0) vmcnt(1)
    v_smfmac_f32_16x16x64_bf16 v[60:63], v[20:23], v[224:231], v4
    ds_read2_b32 v[98:99], v5 offset0:1 offset1:33
    ds_read2_b32 v[96:97], v5 offset0:0 offset1:32
    v_smfmac_f32_16x16x64_bf16 v[52:55], v[20:23], a[248:255], v4
    ds_read2_b32 v[102:103], v5 offset0:129 offset1:161
    ds_read2_b32 v[100:101], v5 offset0:128 offset1:160
    v_smfmac_f32_16x16x64_bf16 v[60:63], v[24:27], v[232:239], v4
    ds_read2_b32 v[106:107], v104 offset0:1 offset1:33
    ds_read2_b32 v[104:105], v104 offset0:0 offset1:32
    v_smfmac_f32_16x16x64_bf16 v[56:59], v[20:23], v[168:175], v4
    ds_read2_b32 v[110:111], v6 offset0:1 offset1:33
    ds_read2_b32 v[108:109], v6 offset0:0 offset1:32
    v_smfmac_f32_16x16x64_bf16 v[60:63], v[28:31], v[240:247], v4
    v_mov_b64 v[8:9], 0
    v_smfmac_f32_16x16x64_bf16 v[52:55], v[24:27], v[120:127], v4
    v_mov_b64 v[10:11], 0
    v_smfmac_f32_16x16x64_bf16 v[60:63], v[32:35], v[248:255], v4
    v_mov_b64 v[12:13], 0
    v_smfmac_f32_16x16x64_bf16 v[56:59], v[24:27], v[176:183], v4
    v_mov_b64 v[14:15], 0
    v_smfmac_f32_16x16x64_bf16 v[52:55], v[28:31], v[128:135], v4
    v_cvt_pk_bf16_f32 v60, v60, v61
    v_smfmac_f32_16x16x64_bf16 v[56:59], v[28:31], v[184:191], v4
    v_cvt_pk_bf16_f32 v61, v62, v63
    v_smfmac_f32_16x16x64_bf16 v[52:55], v[32:35], v[136:143], v4
    v_mov_b32_dpp v62, v60 row_ror:8 row_mask:0xf bank_mask:0xf
    v_smfmac_f32_16x16x64_bf16 v[56:59], v[32:35], v[192:199], v4
    v_mov_b32_dpp v63, v61 row_ror:8 row_mask:0xf bank_mask:0xf
    v_smfmac_f32_16x16x64_bf16 v[36:39], v[20:23], a[24:31], v4
    v_mfma_f32_16x16x32_bf16 v[16:19], v[60:63], v[116:119], 0
    v_cvt_pk_bf16_f32 v52, v52, v53
    v_smfmac_f32_16x16x64_bf16 v[40:43], v[20:23], a[80:87], v4
    v_cvt_pk_bf16_f32 v53, v54, v55
    v_smfmac_f32_16x16x64_bf16 v[36:39], v[24:27], a[32:39], v4
    v_cvt_pk_bf16_f32 v54, v56, v57
    v_smfmac_f32_16x16x64_bf16 v[40:43], v[24:27], a[88:95], v4
    v_cvt_pk_bf16_f32 v55, v58, v59
    v_smfmac_f32_16x16x64_bf16 v[36:39], v[28:31], a[40:47], v4
    v_mfma_f32_16x16x32_bf16 v[56:59], v[52:55], v[116:119], 0
    v_cvt_pk_bf16_f32 v54, v16, v17
    v_smfmac_f32_16x16x64_bf16 v[40:43], v[28:31], a[96:103], v4
    v_cvt_pk_bf16_f32 v55, v18, v19
    v_smfmac_f32_16x16x64_bf16 v[36:39], v[32:35], a[48:55], v4
    v_mov_b64 v[16:17], 0
    v_smfmac_f32_16x16x64_bf16 v[40:43], v[32:35], a[104:111], v4
    v_mov_b64 v[18:19], 0
    v_smfmac_f32_16x16x64_bf16 v[44:47], v[20:23], a[136:143], v4
    v_cvt_pk_bf16_f32 v52, v56, v57
    v_smfmac_f32_16x16x64_bf16 v[44:47], v[24:27], a[144:151], v4
    v_cvt_pk_bf16_f32 v53, v58, v59
    v_smfmac_f32_16x16x64_bf16 v[44:47], v[28:31], a[152:159], v4
    v_cvt_pk_bf16_f32 v36, v36, v37
    v_smfmac_f32_16x16x64_bf16 v[48:51], v[20:23], a[192:199], v4
    v_cvt_pk_bf16_f32 v37, v38, v39
    v_smfmac_f32_16x16x64_bf16 v[44:47], v[32:35], a[160:167], v4
    v_cvt_pk_bf16_f32 v38, v40, v41
    v_smfmac_f32_16x16x64_bf16 v[48:51], v[24:27], a[200:207], v4
    v_cvt_pk_bf16_f32 v39, v42, v43
    v_smfmac_f32_16x16x64_bf16 v[48:51], v[28:31], a[208:215], v4
    v_mfma_f32_16x16x32_bf16 v[40:43], v[36:39], v[116:119], 0
    v_cvt_pk_bf16_f32 v44, v44, v45
    v_smfmac_f32_16x16x64_bf16 v[48:51], v[32:35], a[216:223], v4
    v_cvt_pk_bf16_f32 v45, v46, v47
    s_waitcnt lgkmcnt(0)
    v_smfmac_f32_16x16x64_bf16 v[8:11], v[52:55], v[104:111], v4
    v_cvt_pk_bf16_f32 v36, v40, v41
    v_smfmac_f32_16x16x64_bf16 v[12:15], v[52:55], v[72:79], v4
    v_cvt_pk_bf16_f32 v37, v42, v43
    v_cvt_pk_bf16_f32 v46, v48, v49
    v_cvt_pk_bf16_f32 v47, v50, v51
    s_nop 1
    v_mfma_f32_16x16x32_bf16 v[48:51], v[44:47], v[116:119], 0
    v_smfmac_f32_16x16x64_bf16 v[16:19], v[52:55], v[88:95], v4
    s_nop 3
    v_cvt_pk_bf16_f32 v38, v48, v49
    v_cvt_pk_bf16_f32 v39, v50, v51
    s_nop 1
    v_smfmac_f32_16x16x64_bf16 v[8:11], v[36:39], v[96:103], v4
    v_smfmac_f32_16x16x64_bf16 v[12:15], v[36:39], v[64:71], v4
    v_smfmac_f32_16x16x64_bf16 v[16:19], v[36:39], v[80:87], v4
    v_mov_b64 v[24:25], 0
    ds_write_b128 v114, v[8:11] offset:0
    s_nop 1
    ds_write_b128 v114, v[12:15] offset:1024
    s_nop 2
    ds_write_b128 v114, v[16:19] offset:2048
    s_waitcnt lgkmcnt(0)
    s_barrier
    ds_read2st64_b64 v[8:11], v115 offset0:0 offset1:1
    ds_read2st64_b64 v[12:15], v115 offset0:6 offset1:7
    ds_read2st64_b64 v[16:19], v115 offset0:12 offset1:13
    ds_read2st64_b64 v[20:23], v115 offset0:18 offset1:19
    s_waitcnt lgkmcnt(3)
    v_pk_add_f32 v[8:9], v[8:9], v[10:11]
    s_waitcnt lgkmcnt(2)
    v_pk_add_f32 v[12:13], v[12:13], v[14:15]
    s_waitcnt lgkmcnt(1)
    v_pk_add_f32 v[16:17], v[16:17], v[18:19]
    v_pk_add_f32 v[8:9], v[8:9], v[12:13]
    s_waitcnt lgkmcnt(0)
    v_pk_add_f32 v[20:21], v[20:21], v[22:23]
    v_pk_add_f32 v[8:9], v[8:9], v[16:17]
    v_pk_add_f32 v[8:9], v[8:9], v[20:21]
A_exp:
    s_mov_b64 exec, s[46:47]
    v_exp_f32 v24, v8
    v_exp_f32 v25, v9
    s_mov_b64 exec, -1
    v_add_f32_dpp v26, v24, v24 row_ror:8 row_mask:0xf bank_mask:0xf
    v_add_f32_dpp v27, v25, v25 row_ror:8 row_mask:0xf bank_mask:0xf
    s_nop 0
    v_add_f32_dpp v26, v26, v26 row_ror:4 row_mask:0xf bank_mask:0xf
    v_add_f32_dpp v27, v27, v27 row_ror:4 row_mask:0xf bank_mask:0xf
    s_nop 0
    v_add_f32_dpp v26, v26, v26 row_ror:2 row_mask:0xf bank_mask:0xf
    v_add_f32_dpp v27, v27, v27 row_ror:2 row_mask:0xf bank_mask:0xf
    s_nop 0
    v_add_f32_dpp v26, v26, v26 row_ror:1 row_mask:0xf bank_mask:0xf
    v_add_f32_dpp v27, v27, v27 row_ror:1 row_mask:0xf bank_mask:0xf
    s_nop 0
    v_add_f32_dpp v26, v26, v26 row_bcast:15 row_mask:0xa bank_mask:0xf
    v_add_f32_dpp v27, v27, v27 row_bcast:15 row_mask:0xa bank_mask:0xf
    s_nop 0
    v_add_f32_dpp v26, v26, v26 row_bcast:31 row_mask:0xc bank_mask:0xf
    v_add_f32_dpp v27, v27, v27 row_bcast:31 row_mask:0xc bank_mask:0xf
    v_readlane_b32 s80, v26, 63
    v_readlane_b32 s81, v27, 63
    s_nop 0
    v_rcp_f32 v26, s80
    v_rcp_f32 v27, s81
    s_sub_u32 s80, s80, 310378496
    s_sub_u32 s81, s81, 310378496
    s_max_u32 s80, s80, s81
    s_cmp_ge_u32 s80, 1509949440
    s_cbranch_scc1 A_fb
A_st:
    v_mul_f32_e64 v24, v24, v26 clamp
    v_mul_f32_e64 v25, v25, v27 clamp
    s_cmp_lg_u32 s23, 0
    s_nop 0
    v_permlane32_swap_b32 v24, v25
    s_mov_b64 exec, s[46:47]
    v_cvt_pk_bf16_f32 v24, v24, v25
    s_cbranch_scc0 SM_5
    global_store_dword v112, v24, s[36:37]
SM_6:
    s_mov_b64 exec, -1
    s_add_u32 s40, s40, 1
    s_cmp_ge_u32 s40, 63
    s_cbranch_scc1 CH_end
    s_add_u32 s38, s38, s54
    s_addc_u32 s39, s39, 0
    s_add_u32 s30, s30, 7168
    s_addc_u32 s31, s31, 0
    s_add_u32 s36, s36, 10240
    s_addc_u32 s37, s37, 0
    s_add_u32 s32, s32, 28672
    s_addc_u32 s33, s33, 0
    s_cmp_eq_u32 s55, 64
    s_cselect_b32 s58, 0, 1
    global_load_dwordx4 v[64:67], v0, s[32:33] offset:-2048
    global_load_dwordx4 v[68:71], v0, s[32:33] offset:0
    global_load_dwordx4 v[72:75], v0, s[32:33] offset:2048
    global_load_dwordx4 v[80:83], v0, s[32:33] offset:-1024
    global_load_dwordx4 v[84:87], v0, s[32:33] offset:1024
    global_load_dwordx4 v[88:91], v0, s[32:33] offset:3072
    s_mov_b64 exec, s[44:45]
    global_load_dwordx4 v[76:79], v7, s[32:33] offset:-2048
    global_load_dwordx4 v[92:95], v7, s[32:33] offset:-1024
    s_mov_b64 exec, -1
    s_branch A_top
A_fb:
    s_cmp_lg_u32 s42, 0
    s_cbranch_scc1 A_st
    s_mov_b32 s42, 1
    v_max_f32_dpp v26, v8, v8 row_ror:8 row_mask:0xf bank_mask:0xf
    v_max_f32_dpp v27, v9, v9 row_ror:8 row_mask:0xf bank_mask:0xf
    s_nop 0
    v_max_f32_dpp v26, v26, v26 row_ror:4 row_mask:0xf bank_mask:0xf
    v_max_f32_dpp v27, v27, v27 row_ror:4 row_mask:0xf bank_mask:0xf
    s_nop 0
    v_max_f32_dpp v26, v26, v26 row_ror:2 row_mask:0xf bank_mask:0xf
    v_max_f32_dpp v27, v27, v27 row_ror:2 row_mask:0xf bank_mask:0xf
    s_nop 0
    v_max_f32_dpp v26, v26, v26 row_ror:1 row_mask:0xf bank_mask:0xf
    v_max_f32_dpp v27, v27, v27 row_ror:1 row_mask:0xf bank_mask:0xf
    s_nop 0
    v_max_f32_dpp v26, v26, v26 row_bcast:15 row_mask:0xa bank_mask:0xf
    v_max_f32_dpp v27, v27, v27 row_bcast:15 row_mask:0xa bank_mask:0xf
    s_nop 0
    v_max_f32_dpp v26, v26, v26 row_bcast:31 row_mask:0xc bank_mask:0xf
    v_max_f32_dpp v27, v27, v27 row_bcast:31 row_mask:0xc bank_mask:0xf
    v_readlane_b32 s80, v26, 63
    v_readlane_b32 s81, v27, 63
    s_nop 0
    v_subrev_f32 v8, s80, v8
    v_subrev_f32 v9, s81, v9
    s_branch A_exp
CH_end:
    s_endpgm
ROLE_HB:
    s_mov_b32 s43, 0
    s_mov_b32 s26, s21
LOAD_B:
    s_lshl_b32 s28, s3, 1
    s_mul_i32 s28, s28, s43
    s_add_u32 s27, s28, 0
    s_sub_u32 s44, s27, 7
    s_cmp_ge_u32 s27, 7
    s_cselect_b32 s27, s44, s27
    s_lshl_b32 s60, s27, 11
    s_add_u32 s27, s28, 1
    s_sub_u32 s44, s27, 7
    s_cmp_ge_u32 s27, 7
    s_cselect_b32 s27, s44, s27
    s_lshl_b32 s61, s27, 11
    s_add_u32 s27, s28, 2
    s_sub_u32 s44, s27, 7
    s_cmp_ge_u32 s27, 7
    s_cselect_b32 s27, s44, s27
    s_lshl_b32 s62, s27, 11
    s_add_u32 s27, s28, 3
    s_sub_u32 s44, s27, 7
    s_cmp_ge_u32 s27, 7
    s_cselect_b32 s27, s44, s27
    s_lshl_b32 s63, s27, 11
    s_add_u32 s27, s28, 4
    s_sub_u32 s44, s27, 7
    s_cmp_ge_u32 s27, 7
    s_cselect_b32 s27, s44, s27
    s_lshl_b32 s64, s27, 11
    s_add_u32 s27, s28, 5
    s_sub_u32 s44, s27, 7
    s_cmp_ge_u32 s27, 7
    s_cselect_b32 s27, s44, s27
    s_lshl_b32 s65, s27, 11
    s_add_u32 s27, s28, 6
    s_sub_u32 s44, s27, 7
    s_cmp_ge_u32 s27, 7
    s_cselect_b32 s27, s44, s27
    s_lshl_b32 s66, s27, 11
    s_mul_i32 s27, s26, 458752
    s_mul_i32 s28, s3, 114688
    s_add_u32 s27, s27, s28
    s_add_u32 s27, s27, 6422528
    v_add_u32 v3, s27, v1
    s_mul_i32 s28, s3, 28672
    v_add_u32 v3, 86016, v3
    v_add_u32 v2, s60, v3
    s_add_u32 m0, s28, 0
    s_nop 0
    global_load_lds_dwordx4 v2, s[12:13] offset:0
    global_load_lds_dwordx4 v2, s[12:13] offset:1024
    v_add_u32 v2, s61, v3
    s_add_u32 m0, s28, 2048
    s_nop 0
    global_load_lds_dwordx4 v2, s[12:13] offset:0
    global_load_lds_dwordx4 v2, s[12:13] offset:1024
    v_add_u32 v2, s62, v3
    s_add_u32 m0, s28, 4096
    s_nop 0
    global_load_lds_dwordx4 v2, s[12:13] offset:0
    global_load_lds_dwordx4 v2, s[12:13] offset:1024
    v_add_u32 v2, s63, v3
    s_add_u32 m0, s28, 6144
    s_nop 0
    global_load_lds_dwordx4 v2, s[12:13] offset:0
    global_load_lds_dwordx4 v2, s[12:13] offset:1024
    v_add_u32 v2, s64, v3
    s_add_u32 m0, s28, 8192
    s_nop 0
    global_load_lds_dwordx4 v2, s[12:13] offset:0
    global_load_lds_dwordx4 v2, s[12:13] offset:1024
    v_add_u32 v2, s65, v3
    s_add_u32 m0, s28, 10240
    s_nop 0
    global_load_lds_dwordx4 v2, s[12:13] offset:0
    global_load_lds_dwordx4 v2, s[12:13] offset:1024
    v_add_u32 v2, s66, v3
    s_add_u32 m0, s28, 12288
    s_nop 0
    global_load_lds_dwordx4 v2, s[12:13] offset:0
    global_load_lds_dwordx4 v2, s[12:13] offset:1024
    v_add_u32 v3, 14336, v3
    v_add_u32 v2, s60, v3
    s_add_u32 m0, s28, 14336
    s_nop 0
    global_load_lds_dwordx4 v2, s[12:13] offset:0
    global_load_lds_dwordx4 v2, s[12:13] offset:1024
    v_add_u32 v2, s61, v3
    s_add_u32 m0, s28, 16384
    s_nop 0
    global_load_lds_dwordx4 v2, s[12:13] offset:0
    global_load_lds_dwordx4 v2, s[12:13] offset:1024
    v_add_u32 v2, s62, v3
    s_add_u32 m0, s28, 18432
    s_nop 0
    global_load_lds_dwordx4 v2, s[12:13] offset:0
    global_load_lds_dwordx4 v2, s[12:13] offset:1024
    v_add_u32 v2, s63, v3
    s_add_u32 m0, s28, 20480
    s_nop 0
    global_load_lds_dwordx4 v2, s[12:13] offset:0
    global_load_lds_dwordx4 v2, s[12:13] offset:1024
    v_add_u32 v2, s64, v3
    s_add_u32 m0, s28, 22528
    s_nop 0
    global_load_lds_dwordx4 v2, s[12:13] offset:0
    global_load_lds_dwordx4 v2, s[12:13] offset:1024
    v_add_u32 v2, s65, v3
    s_add_u32 m0, s28, 24576
    s_nop 0
    global_load_lds_dwordx4 v2, s[12:13] offset:0
    global_load_lds_dwordx4 v2, s[12:13] offset:1024
    v_add_u32 v2, s66, v3
    s_add_u32 m0, s28, 26624
    s_nop 0
    global_load_lds_dwordx4 v2, s[12:13] offset:0
    global_load_lds_dwordx4 v2, s[12:13] offset:1024
    v_subrev_u32 v3, 100352, v3
    v_add_u32 v2, s60, v3
    global_load_dwordx4 a[0:3], v2, s[12:13] offset:0
    global_load_dwordx4 a[4:7], v2, s[12:13] offset:1024
    v_add_u32 v2, s61, v3
    global_load_dwordx4 a[8:11], v2, s[12:13] offset:0
    global_load_dwordx4 a[12:15], v2, s[12:13] offset:1024
    v_add_u32 v2, s62, v3
    global_load_dwordx4 a[16:19], v2, s[12:13] offset:0
    global_load_dwordx4 a[20:23], v2, s[12:13] offset:1024
    v_add_u32 v2, s63, v3
    global_load_dwordx4 a[24:27], v2, s[12:13] offset:0
    global_load_dwordx4 a[28:31], v2, s[12:13] offset:1024
    v_add_u32 v2, s64, v3
    global_load_dwordx4 a[32:35], v2, s[12:13] offset:0
    global_load_dwordx4 a[36:39], v2, s[12:13] offset:1024
    v_add_u32 v2, s65, v3
    global_load_dwordx4 a[40:43], v2, s[12:13] offset:0
    global_load_dwordx4 a[44:47], v2, s[12:13] offset:1024
    v_add_u32 v2, s66, v3
    global_load_dwordx4 a[48:51], v2, s[12:13] offset:0
    global_load_dwordx4 a[52:55], v2, s[12:13] offset:1024
    v_add_u32 v3, 14336, v3
    v_add_u32 v2, s60, v3
    global_load_dwordx4 a[56:59], v2, s[12:13] offset:0
    global_load_dwordx4 a[60:63], v2, s[12:13] offset:1024
    v_add_u32 v2, s61, v3
    global_load_dwordx4 a[64:67], v2, s[12:13] offset:0
    global_load_dwordx4 a[68:71], v2, s[12:13] offset:1024
    v_add_u32 v2, s62, v3
    global_load_dwordx4 a[72:75], v2, s[12:13] offset:0
    global_load_dwordx4 a[76:79], v2, s[12:13] offset:1024
    v_add_u32 v2, s63, v3
    global_load_dwordx4 a[80:83], v2, s[12:13] offset:0
    global_load_dwordx4 a[84:87], v2, s[12:13] offset:1024
    v_add_u32 v2, s64, v3
    global_load_dwordx4 a[88:91], v2, s[12:13] offset:0
    global_load_dwordx4 a[92:95], v2, s[12:13] offset:1024
    v_add_u32 v2, s65, v3
    global_load_dwordx4 a[96:99], v2, s[12:13] offset:0
    global_load_dwordx4 a[100:103], v2, s[12:13] offset:1024
    v_add_u32 v2, s66, v3
    global_load_dwordx4 a[104:107], v2, s[12:13] offset:0
    global_load_dwordx4 a[108:111], v2, s[12:13] offset:1024
    s_waitcnt vmcnt(42)
    v_add_u32 v3, 14336, v3
    v_add_u32 v2, s60, v3
    global_load_dwordx4 a[112:115], v2, s[12:13] offset:0
    global_load_dwordx4 a[116:119], v2, s[12:13] offset:1024
    v_add_u32 v2, s61, v3
    global_load_dwordx4 a[120:123], v2, s[12:13] offset:0
    global_load_dwordx4 a[124:127], v2, s[12:13] offset:1024
    v_add_u32 v2, s62, v3
    global_load_dwordx4 a[128:131], v2, s[12:13] offset:0
    global_load_dwordx4 a[132:135], v2, s[12:13] offset:1024
    v_add_u32 v2, s63, v3
    global_load_dwordx4 a[136:139], v2, s[12:13] offset:0
    global_load_dwordx4 a[140:143], v2, s[12:13] offset:1024
    v_add_u32 v2, s64, v3
    global_load_dwordx4 a[144:147], v2, s[12:13] offset:0
    global_load_dwordx4 a[148:151], v2, s[12:13] offset:1024
    v_add_u32 v2, s65, v3
    global_load_dwordx4 a[152:155], v2, s[12:13] offset:0
    global_load_dwordx4 a[156:159], v2, s[12:13] offset:1024
    v_add_u32 v2, s66, v3
    global_load_dwordx4 a[160:163], v2, s[12:13] offset:0
    global_load_dwordx4 a[164:167], v2, s[12:13] offset:1024
    s_waitcnt vmcnt(42)
    v_add_u32 v3, 14336, v3
    v_add_u32 v2, s60, v3
    global_load_dwordx4 a[168:171], v2, s[12:13] offset:0
    global_load_dwordx4 a[172:175], v2, s[12:13] offset:1024
    v_add_u32 v2, s61, v3
    global_load_dwordx4 a[176:179], v2, s[12:13] offset:0
    global_load_dwordx4 a[180:183], v2, s[12:13] offset:1024
    v_add_u32 v2, s62, v3
    global_load_dwordx4 a[184:187], v2, s[12:13] offset:0
    global_load_dwordx4 a[188:191], v2, s[12:13] offset:1024
    v_add_u32 v2, s63, v3
    global_load_dwordx4 a[192:195], v2, s[12:13] offset:0
    global_load_dwordx4 a[196:199], v2, s[12:13] offset:1024
    v_add_u32 v2, s64, v3
    global_load_dwordx4 a[200:203], v2, s[12:13] offset:0
    global_load_dwordx4 a[204:207], v2, s[12:13] offset:1024
    v_add_u32 v2, s65, v3
    global_load_dwordx4 a[208:211], v2, s[12:13] offset:0
    global_load_dwordx4 a[212:215], v2, s[12:13] offset:1024
    v_add_u32 v2, s66, v3
    global_load_dwordx4 a[216:219], v2, s[12:13] offset:0
    global_load_dwordx4 a[220:223], v2, s[12:13] offset:1024
    s_waitcnt vmcnt(42)
    v_add_u32 v3, 14336, v3
    v_add_u32 v2, s60, v3
    global_load_dwordx4 a[224:227], v2, s[12:13] offset:0
    global_load_dwordx4 a[228:231], v2, s[12:13] offset:1024
    v_add_u32 v2, s61, v3
    global_load_dwordx4 a[232:235], v2, s[12:13] offset:0
    global_load_dwordx4 a[236:239], v2, s[12:13] offset:1024
    v_add_u32 v2, s62, v3
    global_load_dwordx4 a[240:243], v2, s[12:13] offset:0
    global_load_dwordx4 a[244:247], v2, s[12:13] offset:1024
    v_add_u32 v2, s63, v3
    global_load_dwordx4 a[248:251], v2, s[12:13] offset:0
    global_load_dwordx4 a[252:255], v2, s[12:13] offset:1024
    v_add_u32 v2, s64, v3
    global_load_dwordx4 v[176:179], v2, s[12:13] offset:0
    global_load_dwordx4 v[180:183], v2, s[12:13] offset:1024
    v_add_u32 v2, s65, v3
    global_load_dwordx4 v[184:187], v2, s[12:13] offset:0
    global_load_dwordx4 v[188:191], v2, s[12:13] offset:1024
    v_add_u32 v2, s66, v3
    global_load_dwordx4 v[192:195], v2, s[12:13] offset:0
    global_load_dwordx4 v[196:199], v2, s[12:13] offset:1024
    s_waitcnt vmcnt(42)
    v_add_u32 v3, 14336, v3
    v_add_u32 v2, s60, v3
    global_load_dwordx4 v[200:203], v2, s[12:13] offset:0
    global_load_dwordx4 v[204:207], v2, s[12:13] offset:1024
    v_add_u32 v2, s61, v3
    global_load_dwordx4 v[208:211], v2, s[12:13] offset:0
    global_load_dwordx4 v[212:215], v2, s[12:13] offset:1024
    v_add_u32 v2, s62, v3
    global_load_dwordx4 v[216:219], v2, s[12:13] offset:0
    global_load_dwordx4 v[220:223], v2, s[12:13] offset:1024
    v_add_u32 v2, s63, v3
    global_load_dwordx4 v[224:227], v2, s[12:13] offset:0
    global_load_dwordx4 v[228:231], v2, s[12:13] offset:1024
    v_add_u32 v2, s64, v3
    global_load_dwordx4 v[232:235], v2, s[12:13] offset:0
    global_load_dwordx4 v[236:239], v2, s[12:13] offset:1024
    v_add_u32 v2, s65, v3
    global_load_dwordx4 v[240:243], v2, s[12:13] offset:0
    global_load_dwordx4 v[244:247], v2, s[12:13] offset:1024
    v_add_u32 v2, s66, v3
    global_load_dwordx4 v[248:251], v2, s[12:13] offset:0
    global_load_dwordx4 v[252:255], v2, s[12:13] offset:1024
    s_waitcnt vmcnt(42)
    v_and_b32 v2, 8, v0
    v_cmp_ne_u32 s[50:51], 0, v2
    v_mov_b32 v2, 0x4444
    v_mov_b32 v3, 0xeeee
    v_cndmask_b32 v4, v2, v3, s[50:51]
    s_mul_i32 s27, s3, 28672
    v_add_u32 v5, s27, v1
    s_cmp_eq_u32 s43, 0
    s_cbranch_scc1 HB_start
    v_and_b32 v8, 15, v0
    v_lshrrev_b32 v9, 4, v0
    v_lshrrev_b32 v10, 3, v8
    v_and_b32 v11, 7, v8
    s_lshl_b32 s27, s3, 11
    v_lshlrev_b32 v6, 9, v10
    v_lshl_add_u32 v6, v11, 4, v6
    v_lshl_add_u32 v6, v9, 7, v6
    v_add_u32 v6, s27, v6
    v_and_b32 v12, 2, v9
    v_add_u32 v12, v12, v10
    v_lshlrev_b32 v7, 7, v12
    v_lshl_add_u32 v7, v11, 4, v7
    s_lshl_b32 s27, s3, 9
    s_add_u32 s27, s27, 8192
    v_add_u32 v7, s27, v7
    v_mul_u32_u24 v168, 640, v9
    v_lshrrev_b32 v12, 2, v8
    v_lshl_add_u32 v168, v12, 5, v168
    v_and_b32 v12, 3, v8
    v_lshl_add_u32 v168, v12, 2, v168
    s_mul_i32 s27, s3, 2560
    s_add_u32 s27, s27, 114688
    v_add_u32 v168, s27, v168
    s_lshl_b32 s27, s3, 2
    v_add_u32 v12, s27, v9
    v_mul_u32_u24 v169, 160, v12
    v_lshl_add_u32 v169, v8, 3, v169
    v_add_u32 v169, 114688, v169
    s_and_b32 s27, s26, 1
    s_lshl_b32 s27, s27, 9
    s_lshr_b32 s28, s26, 1
    s_lshl_b32 s28, s28, 10
    s_add_u32 s27, s27, s28
    v_lshlrev_b32 v170, 8, v10
    v_and_b32 v13, 1, v8
    v_lshl_add_u32 v170, v13, 7, v170
    v_lshl_add_u32 v170, v12, 4, v170
    v_lshrrev_b32 v13, 1, v11
    v_lshl_add_u32 v170, v13, 2, v170
    v_add_u32 v170, s27, v170
    s_lshr_b32 s60, s60, 1
    s_lshr_b32 s61, s61, 1
    s_lshr_b32 s62, s62, 1
    s_lshr_b32 s63, s63, 1
    s_lshr_b32 s64, s64, 1
    s_lshr_b32 s65, s65, 1
    s_lshr_b32 s66, s66, 1
    s_sub_u32 s90, s62, s60
    s_sub_u32 s91, s63, s60
    s_sub_u32 s92, s64, s60
    s_sub_u32 s93, s65, s60
    s_sub_u32 s94, s66, s60
    v_add_u32 v164, s60, v1
    v_add_u32 v165, s61, v1
    v_add_u32 v166, 0x20000, v164
    v_add_u32 v167, 0x20000, v165
    s_lshl_b32 s27, s26, 2
    v_lshl_add_u32 v172, v0, 6, s27
    v_mov_b32 v174, 0
    s_lshl_b32 s27, s26, 15
    s_lshl_b32 s28, s3, 13
    s_add_u32 s27, s27, s28
    s_add_u32 s27, s27, 24350720
    s_mov_b32 s40, 0
    s_mov_b32 s44, 0x80008000
    s_mov_b64 s[56:57], 0
    s_add_u32 s32, s12, s27
    s_addc_u32 s33, s13, 0
    s_add_u32 s30, s12, 12845056
    s_addc_u32 s31, s13, 0
    s_add_u32 s34, s12, 12852224
    s_addc_u32 s35, s13, 0
    s_add_u32 s52, s12, 13762560
    s_addc_u32 s53, s13, 0
    s_add_u32 s36, s12, 14680064
    s_addc_u32 s37, s13, 0
    v_mov_b32 v3, 9600
    s_mov_b32 s24, 524288
TW_7:
    global_load_dword v2, v3, s[18:19] sc1
    s_sub_u32 s24, s24, 1
    s_cbranch_scc1 BAIL_3
    s_waitcnt vmcnt(0)
    v_readfirstlane_b32 s23, v2
    s_cmp_lt_u32 s23, 7936
    s_cbranch_scc1 TW_7
    s_cmp_eq_u32 s23, 7967
    s_cselect_b32 s23, 1, 0
    s_waitcnt lgkmcnt(0)
    s_barrier
    v_mov_b64 v[36:37], 0
    v_mov_b64 v[38:39], 0
    v_mov_b64 v[40:41], 0
    v_mov_b64 v[42:43], 0
    v_mov_b64 v[44:45], 0
    v_mov_b64 v[46:47], 0
    v_mov_b64 v[48:49], 0
    v_mov_b64 v[50:51], 0
    v_mov_b64 v[52:53], 0
    v_mov_b64 v[54:55], 0
    v_mov_b64 v[56:57], 0
    v_mov_b64 v[58:59], 0
    v_mov_b64 v[60:61], 0
    v_mov_b64 v[62:63], 0
    v_mov_b64 v[64:65], 0
    v_mov_b64 v[66:67], 0
    v_mov_b64 v[116:117], 0
    v_mov_b64 v[118:119], 0
    v_mov_b64 v[120:121], 0
    v_mov_b64 v[122:123], 0
    v_add_u32 v16, s90, v166
    v_add_u32 v20, s91, v166
    v_add_u32 v24, s92, v166
    v_add_u32 v28, s93, v166
    v_add_u32 v32, s94, v166
B_top:
    s_mov_b32 s41, 524288
B_poll:
    global_load_dwordx4 v[8:11], v164, s[30:31] sc1
    global_load_dwordx4 v[12:15], v165, s[30:31] sc1
    s_sub_u32 s41, s41, 1
    s_cbranch_scc1 BAIL_5
    s_waitcnt vmcnt(1)
    v_max3_u32 v2, v8, v9, v10
    s_waitcnt vmcnt(0)
    v_max3_u32 v2, v2, v11, v12
    v_max3_u32 v2, v2, v13, v14
    v_max_u32 v2, v2, v15
    v_cmp_eq_u32 vcc, -1, v2
    s_cbranch_vccnz B_poll
    v_cmp_eq_u32 s[56:57], 0, v174
    s_bitcmp1_b64 s[56:57], s40
    s_cbranch_scc1 B_voflag
B_vok:
    ds_write_b128 v166, v[8:11]
    ds_write_b128 v167, v[12:15]
    ds_read_b128 v[68:71], v5 offset:0
    ds_read_b128 v[72:75], v5 offset:1024
    ds_read_b128 v[76:79], v5 offset:14336
    ds_read_b128 v[80:83], v5 offset:15360
    s_waitcnt lgkmcnt(2)
    v_smfmac_f32_16x16x64_bf16 v[60:63], v[8:11], v[68:75], v4
    ds_read_b128 v[68:71], v5 offset:2048
    v_smfmac_f32_16x16x64_bf16 v[36:39], v[8:11], a[0:7], v4
    ds_read_b128 v[72:75], v5 offset:3072
    v_smfmac_f32_16x16x64_bf16 v[44:47], v[8:11], a[112:119], v4
    global_load_dwordx4 v[84:87], v1, s[32:33] offset:-4096 sc1
    v_smfmac_f32_16x16x64_bf16 v[52:55], v[8:11], a[224:231], v4
    s_waitcnt lgkmcnt(2)
    v_smfmac_f32_16x16x64_bf16 v[64:67], v[8:11], v[76:83], v4
    ds_read_b128 v[76:79], v5 offset:16384
    v_smfmac_f32_16x16x64_bf16 v[40:43], v[8:11], a[56:63], v4
    ds_read_b128 v[80:83], v5 offset:17408
    v_smfmac_f32_16x16x64_bf16 v[48:51], v[8:11], a[168:175], v4
    global_load_dwordx4 v[88:91], v1, s[32:33] offset:-3072 sc1
    v_smfmac_f32_16x16x64_bf16 v[56:59], v[8:11], v[200:207], v4
    s_barrier
    ds_read_b128 v[16:19], v16
    ds_read_b128 v[20:23], v20
    ds_read_b128 v[24:27], v24
    ds_read_b128 v[28:31], v28
    ds_read_b128 v[32:35], v32
    s_waitcnt lgkmcnt(7)
    v_smfmac_f32_16x16x64_bf16 v[60:63], v[12:15], v[68:75], v4
    ds_read_b128 v[68:71], v5 offset:4096
    v_smfmac_f32_16x16x64_bf16 v[36:39], v[12:15], a[8:15], v4
    ds_read_b128 v[72:75], v5 offset:5120
    v_smfmac_f32_16x16x64_bf16 v[44:47], v[12:15], a[120:127], v4
    global_load_dwordx4 v[92:95], v1, s[32:33] offset:-2048 sc1
    v_smfmac_f32_16x16x64_bf16 v[52:55], v[12:15], a[232:239], v4
    s_waitcnt lgkmcnt(7)
    v_smfmac_f32_16x16x64_bf16 v[64:67], v[12:15], v[76:83], v4
    ds_read_b128 v[76:79], v5 offset:18432
    v_smfmac_f32_16x16x64_bf16 v[40:43], v[12:15], a[64:71], v4
    ds_read_b128 v[80:83], v5 offset:19456
    v_smfmac_f32_16x16x64_bf16 v[48:51], v[12:15], a[176:183], v4
    global_load_dwordx4 v[96:99], v1, s[32:33] offset:-1024 sc1
    v_smfmac_f32_16x16x64_bf16 v[56:59], v[12:15], v[208:215], v4
    s_waitcnt lgkmcnt(2)
    v_smfmac_f32_16x16x64_bf16 v[60:63], v[16:19], v[68:75], v4
    ds_read_b128 v[68:71], v5 offset:6144
    v_smfmac_f32_16x16x64_bf16 v[36:39], v[16:19], a[16:23], v4
    ds_read_b128 v[72:75], v5 offset:7168
    v_smfmac_f32_16x16x64_bf16 v[44:47], v[16:19], a[128:135], v4
    global_load_dwordx4 v[100:103], v1, s[32:33] offset:0 sc1
    v_smfmac_f32_16x16x64_bf16 v[52:55], v[16:19], a[240:247], v4
    s_waitcnt lgkmcnt(2)
    v_smfmac_f32_16x16x64_bf16 v[64:67], v[16:19], v[76:83], v4
    ds_read_b128 v[76:79], v5 offset:20480
    v_smfmac_f32_16x16x64_bf16 v[40:43], v[16:19], a[72:79], v4
    ds_read_b128 v[80:83], v5 offset:21504
    v_smfmac_f32_16x16x64_bf16 v[48:51], v[16:19], a[184:191], v4
    global_load_dwordx4 v[104:107], v1, s[32:33] offset:1024 sc1
    v_smfmac_f32_16x16x64_bf16 v[56:59], v[16:19], v[216:223], v4
    s_waitcnt lgkmcnt(2)
    v_smfmac_f32_16x16x64_bf16 v[60:63], v[20:23], v[68:75], v4
    ds_read_b128 v[68:71], v5 offset:8192
    v_smfmac_f32_16x16x64_bf16 v[36:39], v[20:23], a[24:31], v4
    ds_read_b128 v[72:75], v5 offset:9216
    v_smfmac_f32_16x16x64_bf16 v[44:47], v[20:23], a[136:143], v4
    global_load_dwordx4 v[108:111], v1, s[32:33] offset:2048 sc1
    v_smfmac_f32_16x16x64_bf16 v[52:55], v[20:23], a[248:255], v4
    s_waitcnt lgkmcnt(2)
    v_smfmac_f32_16x16x64_bf16 v[64:67], v[20:23], v[76:83], v4
    ds_read_b128 v[76:79], v5 offset:22528
    v_smfmac_f32_16x16x64_bf16 v[40:43], v[20:23], a[80:87], v4
    ds_read_b128 v[80:83], v5 offset:23552
    v_smfmac_f32_16x16x64_bf16 v[48:51], v[20:23], a[192:199], v4
    global_load_dwordx4 v[112:115], v1, s[32:33] offset:3072 sc1
    v_smfmac_f32_16x16x64_bf16 v[56:59], v[20:23], v[224:231], v4
    s_waitcnt lgkmcnt(2)
    v_smfmac_f32_16x16x64_bf16 v[60:63], v[24:27], v[68:75], v4
    ds_read_b128 v[68:71], v5 offset:10240
    v_smfmac_f32_16x16x64_bf16 v[36:39], v[24:27], a[32:39], v4
    ds_read_b128 v[72:75], v5 offset:11264
    v_smfmac_f32_16x16x64_bf16 v[44:47], v[24:27], a[144:151], v4
    s_mov_b64 exec, s[56:57]
    global_load_dword v174, v172, s[18:19] sc1
    s_mov_b64 exec, -1
    v_smfmac_f32_16x16x64_bf16 v[52:55], v[24:27], v[176:183], v4
    s_waitcnt lgkmcnt(2)
    v_smfmac_f32_16x16x64_bf16 v[64:67], v[24:27], v[76:83], v4
    ds_read_b128 v[76:79], v5 offset:24576
    v_smfmac_f32_16x16x64_bf16 v[40:43], v[24:27], a[88:95], v4
    ds_read_b128 v[80:83], v5 offset:25600
    v_smfmac_f32_16x16x64_bf16 v[48:51], v[24:27], a[200:207], v4
    v_smfmac_f32_16x16x64_bf16 v[56:59], v[24:27], v[232:239], v4
    s_waitcnt lgkmcnt(2)
    v_smfmac_f32_16x16x64_bf16 v[60:63], v[28:31], v[68:75], v4
    ds_read_b128 v[68:71], v5 offset:12288
    v_smfmac_f32_16x16x64_bf16 v[36:39], v[28:31], a[40:47], v4
    ds_read_b128 v[72:75], v5 offset:13312
    v_smfmac_f32_16x16x64_bf16 v[44:47], v[28:31], a[152:159], v4
    v_smfmac_f32_16x16x64_bf16 v[52:55], v[28:31], v[184:191], v4
    s_waitcnt lgkmcnt(2)
    v_smfmac_f32_16x16x64_bf16 v[64:67], v[28:31], v[76:83], v4
    ds_read_b128 v[76:79], v5 offset:26624
    v_smfmac_f32_16x16x64_bf16 v[40:43], v[28:31], a[96:103], v4
    ds_read_b128 v[80:83], v5 offset:27648
    v_smfmac_f32_16x16x64_bf16 v[48:51], v[28:31], a[208:215], v4
    v_smfmac_f32_16x16x64_bf16 v[56:59], v[28:31], v[240:247], v4
    s_waitcnt lgkmcnt(2)
    v_smfmac_f32_16x16x64_bf16 v[60:63], v[32:35], v[68:75], v4
    v_smfmac_f32_16x16x64_bf16 v[36:39], v[32:35], a[48:55], v4
    v_smfmac_f32_16x16x64_bf16 v[44:47], v[32:35], a[160:167], v4
    v_smfmac_f32_16x16x64_bf16 v[52:55], v[32:35], v[192:199], v4
    s_waitcnt lgkmcnt(0)
    v_smfmac_f32_16x16x64_bf16 v[64:67], v[32:35], v[76:83], v4
    v_smfmac_f32_16x16x64_bf16 v[40:43], v[32:35], a[104:111], v4
    v_smfmac_f32_16x16x64_bf16 v[48:51], v[32:35], a[216:223], v4
    v_smfmac_f32_16x16x64_bf16 v[56:59], v[32:35], v[248:255], v4
    s_sleep 8
    global_load_dwordx4 v[148:151], v6, s[36:37] sc1
    global_load_dwordx4 v[152:155], v6, s[36:37] offset:1024 sc1
    global_load_dwordx4 v[156:159], v7, s[36:37] sc1
    v_cvt_pk_bf16_f32 v68, v36, v37
    v_cvt_pk_bf16_f32 v69, v44, v45
    v_cvt_pk_bf16_f32 v70, v38, v39
    v_cvt_pk_bf16_f32 v71, v46, v47
    v_cvt_pk_bf16_f32 v72, v52, v53
    v_cvt_pk_bf16_f32 v73, v60, v61
    v_cvt_pk_bf16_f32 v74, v54, v55
    v_cvt_pk_bf16_f32 v75, v62, v63
    v_cvt_pk_bf16_f32 v76, v40, v41
    v_cvt_pk_bf16_f32 v77, v48, v49
    v_cvt_pk_bf16_f32 v78, v42, v43
    v_cvt_pk_bf16_f32 v79, v50, v51
    v_cvt_pk_bf16_f32 v80, v56, v57
    v_cvt_pk_bf16_f32 v81, v64, v65
    v_cvt_pk_bf16_f32 v82, v58, v59
    v_cvt_pk_bf16_f32 v83, v66, v67
    s_sleep 2
    global_load_dwordx4 v[124:127], v6, s[36:37] sc1
    global_load_dwordx4 v[128:131], v6, s[36:37] offset:1024 sc1
    global_load_dwordx4 v[132:135], v7, s[36:37] sc1
B_pp:
    s_waitcnt vmcnt(5)
    v_smfmac_f32_16x16x64_bf16 v[116:119], v[148:151], v[84:91], v4
    v_or3_b32 v2, v148, v149, v150
    v_smfmac_f32_16x16x64_bf16 v[120:123], v[148:151], v[92:99], v4
    s_waitcnt vmcnt(4)
    v_or3_b32 v3, v151, v152, v153
    v_smfmac_f32_16x16x64_bf16 v[116:119], v[152:155], v[100:107], v4
    v_or3_b32 v2, v2, v154, v155
    v_smfmac_f32_16x16x64_bf16 v[120:123], v[152:155], v[108:115], v4
    s_waitcnt vmcnt(3)
    v_or3_b32 v3, v3, v156, v157
    v_smfmac_f32_16x16x64_bf16 v[116:119], v[156:159], v[68:75], v4
    v_or3_b32 v2, v2, v158, v159
    v_smfmac_f32_16x16x64_bf16 v[120:123], v[156:159], v[76:83], v4
    v_or_b32 v2, v2, v3
    v_and_b32 v2, s44, v2
    v_cmp_ne_u32 vcc, 0, v2
    s_cbranch_vccz B_go
    global_load_dwordx4 v[148:151], v6, s[36:37] sc1
    global_load_dwordx4 v[152:155], v6, s[36:37] offset:1024 sc1
    global_load_dwordx4 v[156:159], v7, s[36:37] sc1
    v_mov_b64 v[116:117], 0
    v_mov_b64 v[118:119], 0
    v_mov_b64 v[120:121], 0
    v_mov_b64 v[122:123], 0
    s_waitcnt vmcnt(5)
    v_smfmac_f32_16x16x64_bf16 v[116:119], v[124:127], v[84:91], v4
    v_or3_b32 v2, v124, v125, v126
    v_smfmac_f32_16x16x64_bf16 v[120:123], v[124:127], v[92:99], v4
    s_waitcnt vmcnt(4)
    v_or3_b32 v3, v127, v128, v129
    v_smfmac_f32_16x16x64_bf16 v[116:119], v[128:131], v[100:107], v4
    v_or3_b32 v2, v2, v130, v131
    v_smfmac_f32_16x16x64_bf16 v[120:123], v[128:131], v[108:115], v4
    s_waitcnt vmcnt(3)
    v_or3_b32 v3, v3, v132, v133
    v_smfmac_f32_16x16x64_bf16 v[116:119], v[132:135], v[68:75], v4
    v_or3_b32 v2, v2, v134, v135
    v_smfmac_f32_16x16x64_bf16 v[120:123], v[132:135], v[76:83], v4
    v_or_b32 v2, v2, v3
    v_and_b32 v2, s44, v2
    v_cmp_ne_u32 vcc, 0, v2
    s_cbranch_vccz B_go
    global_load_dwordx4 v[124:127], v6, s[36:37] sc1
    global_load_dwordx4 v[128:131], v6, s[36:37] offset:1024 sc1
    global_load_dwordx4 v[132:135], v7, s[36:37] sc1
    v_mov_b64 v[116:117], 0
    v_mov_b64 v[118:119], 0
    v_mov_b64 v[120:121], 0
    v_mov_b64 v[122:123], 0
    s_sub_u32 s41, s41, 1
    s_cbranch_scc0 B_pp
    s_branch BAIL_5
B_go:
    s_nop 3
    ds_write2_b32 v168, v116, v120 offset0:0 offset1:4
    ds_write2_b32 v168, v117, v121 offset0:40 offset1:44
    ds_write2_b32 v168, v118, v122 offset0:80 offset1:84
    ds_write2_b32 v168, v119, v123 offset0:120 offset1:124
    s_add_u32 s40, s40, 1
    s_waitcnt lgkmcnt(0)
    s_barrier
    s_cmp_ge_u32 s3, 2
    s_cbranch_scc1 B_nopub
    ds_read_b64 v[8:9], v169 offset:0
    ds_read_b64 v[10:11], v169 offset:1280
    ds_read_b64 v[12:13], v169 offset:2560
    ds_read_b64 v[14:15], v169 offset:3840
    ds_read_b64 v[16:17], v169 offset:5120
    ds_read_b64 v[18:19], v169 offset:6400
    ds_read_b64 v[20:21], v169 offset:7680
    ds_read_b64 v[22:23], v169 offset:8960
    s_cmp_lg_u32 s23, 0
    s_waitcnt lgkmcnt(6)
    v_pk_add_f32 v[8:9], v[8:9], v[10:11]
    s_waitcnt lgkmcnt(4)
    v_pk_add_f32 v[12:13], v[12:13], v[14:15]
    s_waitcnt lgkmcnt(2)
    v_pk_add_f32 v[16:17], v[16:17], v[18:19]
    v_pk_add_f32 v[8:9], v[8:9], v[12:13]
    s_waitcnt lgkmcnt(0)
    v_pk_add_f32 v[20:21], v[20:21], v[22:23]
    v_pk_add_f32 v[8:9], v[8:9], v[16:17]
    v_pk_add_f32 v[8:9], v[8:9], v[20:21]
    v_cvt_pk_bf16_f32 v175, v8, v9
    v_min_u32 v175, -2, v175
    s_cbranch_scc0 SM_8
    global_store_dword v170, v175, s[34:35]
SM_9:
B_nopub:
    s_add_u32 s52, s52, 7168
    s_addc_u32 s53, s53, 0
    s_cmp_ge_u32 s40, 63
    s_cbranch_scc1 B_end
    s_add_u32 s30, s30, 7168
    s_addc_u32 s31, s31, 0
    s_add_u32 s34, s34, 7168
    s_addc_u32 s35, s35, 0
    s_add_u32 s36, s36, 10240
    s_addc_u32 s37, s37, 0
    s_add_u32 s32, s32, 458752
    s_addc_u32 s33, s33, 0
    v_mov_b64 v[36:37], 0
    v_mov_b64 v[38:39], 0
    v_mov_b64 v[40:41], 0
    v_mov_b64 v[42:43], 0
    v_mov_b64 v[44:45], 0
    v_mov_b64 v[46:47], 0
    v_mov_b64 v[48:49], 0
    v_mov_b64 v[50:51], 0
    v_mov_b64 v[52:53], 0
    v_mov_b64 v[54:55], 0
    v_mov_b64 v[56:57], 0
    v_mov_b64 v[58:59], 0
    v_mov_b64 v[60:61], 0
    v_mov_b64 v[62:63], 0
    v_mov_b64 v[64:65], 0
    v_mov_b64 v[66:67], 0
    v_mov_b64 v[116:117], 0
    v_mov_b64 v[118:119], 0
    v_mov_b64 v[120:121], 0
    v_mov_b64 v[122:123], 0
    v_add_u32 v16, s90, v166
    v_add_u32 v20, s91, v166
    v_add_u32 v24, s92, v166
    v_add_u32 v28, s93, v166
    v_add_u32 v32, s94, v166
    s_branch B_top
B_np2:
    s_waitcnt vmcnt(0)
    s_branch B_nopub
B_voflag:
    global_load_dword v174, v172, s[18:19] sc1
    s_sub_u32 s41, s41, 1
    s_cbranch_scc1 BAIL_5
    s_waitcnt vmcnt(0)
    v_cmp_eq_u32 s[56:57], 0, v174
    s_bitcmp1_b64 s[56:57], s40
    s_cbranch_scc0 B_vok
    s_sleep 2
    s_branch B_voflag
B_end:
    s_cmp_ge_u32 s3, 2
    s_cbranch_scc1 K2_end
    global_store_dword v170, v175, s[52:53] sc1
    s_endpgm
SM_5:
    global_store_dword v112, v24, s[36:37] sc1
    s_branch SM_6
SM_8:
    global_store_dword v170, v175, s[34:35] sc1
    s_branch SM_9
ROLE_CP:
    s_add_u32 s40, s3, 1
    s_mul_i32 s27, s40, 7168
    s_add_u32 s28, s27, 13765632
    s_add_u32 s27, s27, 12848128
    s_add_u32 s30, s12, s27
    s_addc_u32 s31, s13, 0
    s_add_u32 s52, s12, s28
    s_addc_u32 s53, s13, 0
CP_top:
    s_mov_b32 s41, 524288
CP_poll:
    global_load_dwordx4 v[8:11], v1, s[30:31] offset:-3072 sc1
    global_load_dwordx4 v[12:15], v1, s[30:31] offset:-2048 sc1
    global_load_dwordx4 v[16:19], v1, s[30:31] offset:-1024 sc1
    global_load_dwordx4 v[20:23], v1, s[30:31] offset:0 sc1
    global_load_dwordx4 v[24:27], v1, s[30:31] offset:1024 sc1
    global_load_dwordx4 v[28:31], v1, s[30:31] offset:2048 sc1
    global_load_dwordx4 v[32:35], v1, s[30:31] offset:3072 sc1
    s_sub_u32 s41, s41, 1
    s_cbranch_scc1 BAIL_6
    s_waitcnt vmcnt(0)
    v_max3_u32 v2, v8, v9, v10
    v_max3_u32 v2, v2, v11, v12
    v_max3_u32 v2, v2, v13, v14
    v_max3_u32 v2, v2, v15, v16
    v_max3_u32 v2, v2, v17, v18
    v_max3_u32 v2, v2, v19, v20
    v_max3_u32 v2, v2, v21, v22
    v_max3_u32 v2, v2, v23, v24
    v_max3_u32 v2, v2, v25, v26
    v_max3_u32 v2, v2, v27, v28
    v_max3_u32 v2, v2, v29, v30
    v_max3_u32 v2, v2, v31, v32
    v_max3_u32 v2, v2, v33, v34
    v_max_u32 v2, v2, v35
    v_cmp_eq_u32 vcc, -1, v2
    s_cbranch_vccz CP_ok
    s_cmp_ge_u32 s40, 63
    s_cbranch_scc1 CP_poll
    s_sleep 4
    s_branch CP_poll
CP_ok:
    global_store_dwordx4 v1, v[8:11], s[52:53] offset:-3072 sc1
    global_store_dwordx4 v1, v[12:15], s[52:53] offset:-2048 sc1
    global_store_dwordx4 v1, v[16:19], s[52:53] offset:-1024 sc1
    global_store_dwordx4 v1, v[20:23], s[52:53] offset:0 sc1
    global_store_dwordx4 v1, v[24:27], s[52:53] offset:1024 sc1
    global_store_dwordx4 v1, v[28:31], s[52:53] offset:2048 sc1
    global_store_dwordx4 v1, v[32:35], s[52:53] offset:3072 sc1
    s_add_u32 s30, s30, 28672
    s_addc_u32 s31, s31, 0
    s_add_u32 s52, s52, 28672
    s_addc_u32 s53, s53, 0
    s_add_u32 s40, s40, 4
    s_cmp_lt_u32 s40, 63
    s_waitcnt vmcnt(0)
    s_cbranch_scc1 CP_top
    s_endpgm
HB_start:
    s_mul_i32 s27, s3, 7168
    v_add_u32 v6, s27, v1
    s_mov_b32 s40, s29
    s_mul_i32 s58, s40, 28672
    s_mul_i32 s59, s3, 7168
    s_add_u32 m0, s59, 114688
    s_add_u32 s58, s58, 53706752
    s_add_u32 s56, s12, s58
    s_addc_u32 s57, s13, 0
    global_load_lds_dwordx4 v6, s[56:57] offset:0
    global_load_lds_dwordx4 v6, s[56:57] offset:1024
    global_load_lds_dwordx4 v6, s[56:57] offset:2048
    global_load_lds_dwordx4 v6, s[56:57] offset:3072
    s_add_u32 m0, m0, 4096
    s_add_u32 s56, s56, 4096
    s_addc_u32 s57, s57, 0
    global_load_lds_dwordx4 v6, s[56:57] offset:0
    global_load_lds_dwordx4 v6, s[56:57] offset:1024
    global_load_lds_dwordx4 v6, s[56:57] offset:2048
    v_add_u32 v7, 114688, v1
    s_waitcnt vmcnt(0)
    s_barrier
HB_vo:
    ds_read_b128 v[8:11], v7 offset:0
    ds_read_b128 v[12:15], v7 offset:1024
    ds_read_b128 v[16:19], v5 offset:0
    ds_read_b128 v[20:23], v5 offset:14336
    ds_read_b128 v[24:27], v7 offset:2048
    ds_read_b128 v[28:31], v7 offset:3072
    ds_read_b128 v[32:35], v5 offset:1024
    ds_read_b128 v[36:39], v5 offset:15360
    s_waitcnt lgkmcnt(4)
    v_mfma_f32_16x16x32_bf16 v[40:43], v[8:11], a[0:3], 0
    v_mfma_f32_16x16x32_bf16 v[44:47], v[12:15], a[0:3], 0
    v_mfma_f32_16x16x32_bf16 v[48:51], v[8:11], a[56:59], 0
    v_mfma_f32_16x16x32_bf16 v[52:55], v[12:15], a[56:59], 0
    v_mfma_f32_16x16x32_bf16 v[56:59], v[8:11], a[112:115], 0
    v_mfma_f32_16x16x32_bf16 v[60:63], v[12:15], a[112:115], 0
    v_mfma_f32_16x16x32_bf16 v[64:67], v[8:11], a[168:171], 0
    v_mfma_f32_16x16x32_bf16 v[68:71], v[12:15], a[168:171], 0
    v_mfma_f32_16x16x32_bf16 v[72:75], v[8:11], a[224:227], 0
    v_mfma_f32_16x16x32_bf16 v[76:79], v[12:15], a[224:227], 0
    v_mfma_f32_16x16x32_bf16 v[80:83], v[8:11], v[200:203], 0
    v_mfma_f32_16x16x32_bf16 v[84:87], v[12:15], v[200:203], 0
    v_mfma_f32_16x16x32_bf16 v[88:91], v[8:11], v[16:19], 0
    v_mfma_f32_16x16x32_bf16 v[92:95], v[12:15], v[16:19], 0
    v_mfma_f32_16x16x32_bf16 v[96:99], v[8:11], v[20:23], 0
    v_mfma_f32_16x16x32_bf16 v[100:103], v[12:15], v[20:23], 0
    ds_read_b128 v[8:11], v7 offset:4096
    ds_read_b128 v[12:15], v7 offset:5120
    ds_read_b128 v[16:19], v5 offset:2048
    ds_read_b128 v[20:23], v5 offset:16384
    s_waitcnt lgkmcnt(4)
    v_mfma_f32_16x16x32_bf16 v[40:43], v[24:27], a[4:7], v[40:43]
    v_mfma_f32_16x16x32_bf16 v[44:47], v[28:31], a[4:7], v[44:47]
    v_mfma_f32_16x16x32_bf16 v[48:51], v[24:27], a[60:63], v[48:51]
    v_mfma_f32_16x16x32_bf16 v[52:55], v[28:31], a[60:63], v[52:55]
    v_mfma_f32_16x16x32_bf16 v[56:59], v[24:27], a[116:119], v[56:59]
    v_mfma_f32_16x16x32_bf16 v[60:63], v[28:31], a[116:119], v[60:63]
    v_mfma_f32_16x16x32_bf16 v[64:67], v[24:27], a[172:175], v[64:67]
    v_mfma_f32_16x16x32_bf16 v[68:71], v[28:31], a[172:175], v[68:71]
    v_mfma_f32_16x16x32_bf16 v[72:75], v[24:27], a[228:231], v[72:75]
    v_mfma_f32_16x16x32_bf16 v[76:79], v[28:31], a[228:231], v[76:79]
    v_mfma_f32_16x16x32_bf16 v[80:83], v[24:27], v[204:207], v[80:83]
    v_mfma_f32_16x16x32_bf16 v[84:87], v[28:31], v[204:207], v[84:87]
    v_mfma_f32_16x16x32_bf16 v[88:91], v[24:27], v[32:35], v[88:91]
    v_mfma_f32_16x16x32_bf16 v[92:95], v[28:31], v[32:35], v[92:95]
    v_mfma_f32_16x16x32_bf16 v[96:99], v[24:27], v[36:39], v[96:99]
    v_mfma_f32_16x16x32_bf16 v[100:103], v[28:31], v[36:39], v[100:103]
    ds_read_b128 v[24:27], v7 offset:6144
    ds_read_b128 v[28:31], v7 offset:7168
    ds_read_b128 v[32:35], v5 offset:3072
    ds_read_b128 v[36:39], v5 offset:17408
    s_waitcnt lgkmcnt(4)
    v_mfma_f32_16x16x32_bf16 v[40:43], v[8:11], a[8:11], v[40:43]
    v_mfma_f32_16x16x32_bf16 v[44:47], v[12:15], a[8:11], v[44:47]
    v_mfma_f32_16x16x32_bf16 v[48:51], v[8:11], a[64:67], v[48:51]
    v_mfma_f32_16x16x32_bf16 v[52:55], v[12:15], a[64:67], v[52:55]
    v_mfma_f32_16x16x32_bf16 v[56:59], v[8:11], a[120:123], v[56:59]
    v_mfma_f32_16x16x32_bf16 v[60:63], v[12:15], a[120:123], v[60:63]
    v_mfma_f32_16x16x32_bf16 v[64:67], v[8:11], a[176:179], v[64:67]
    v_mfma_f32_16x16x32_bf16 v[68:71], v[12:15], a[176:179], v[68:71]
    v_mfma_f32_16x16x32_bf16 v[72:75], v[8:11], a[232:235], v[72:75]
    v_mfma_f32_16x16x32_bf16 v[76:79], v[12:15], a[232:235], v[76:79]
    v_mfma_f32_16x16x32_bf16 v[80:83], v[8:11], v[208:211], v[80:83]
    v_mfma_f32_16x16x32_bf16 v[84:87], v[12:15], v[208:211], v[84:87]
    v_mfma_f32_16x16x32_bf16 v[88:91], v[8:11], v[16:19], v[88:91]
    v_mfma_f32_16x16x32_bf16 v[92:95], v[12:15], v[16:19], v[92:95]
    v_mfma_f32_16x16x32_bf16 v[96:99], v[8:11], v[20:23], v[96:99]
    v_mfma_f32_16x16x32_bf16 v[100:103], v[12:15], v[20:23], v[100:103]
    ds_read_b128 v[8:11], v7 offset:8192
    ds_read_b128 v[12:15], v7 offset:9216
    ds_read_b128 v[16:19], v5 offset:4096
    ds_read_b128 v[20:23], v5 offset:18432
    s_waitcnt lgkmcnt(4)
    v_mfma_f32_16x16x32_bf16 v[40:43], v[24:27], a[12:15], v[40:43]
    v_mfma_f32_16x16x32_bf16 v[44:47], v[28:31], a[12:15], v[44:47]
    v_mfma_f32_16x16x32_bf16 v[48:51], v[24:27], a[68:71], v[48:51]
    v_mfma_f32_16x16x32_bf16 v[52:55], v[28:31], a[68:71], v[52:55]
    v_mfma_f32_16x16x32_bf16 v[56:59], v[24:27], a[124:127], v[56:59]
    v_mfma_f32_16x16x32_bf16 v[60:63], v[28:31], a[124:127], v[60:63]
    v_mfma_f32_16x16x32_bf16 v[64:67], v[24:27], a[180:183], v[64:67]
    v_mfma_f32_16x16x32_bf16 v[68:71], v[28:31], a[180:183], v[68:71]
    v_mfma_f32_16x16x32_bf16 v[72:75], v[24:27], a[236:239], v[72:75]
    v_mfma_f32_16x16x32_bf16 v[76:79], v[28:31], a[236:239], v[76:79]
    v_mfma_f32_16x16x32_bf16 v[80:83], v[24:27], v[212:215], v[80:83]
    v_mfma_f32_16x16x32_bf16 v[84:87], v[28:31], v[212:215], v[84:87]
    v_mfma_f32_16x16x32_bf16 v[88:91], v[24:27], v[32:35], v[88:91]
    v_mfma_f32_16x16x32_bf16 v[92:95], v[28:31], v[32:35], v[92:95]
    v_mfma_f32_16x16x32_bf16 v[96:99], v[24:27], v[36:39], v[96:99]
    v_mfma_f32_16x16x32_bf16 v[100:103], v[28:31], v[36:39], v[100:103]
    ds_read_b128 v[24:27], v7 offset:10240
    ds_read_b128 v[28:31], v7 offset:11264
    ds_read_b128 v[32:35], v5 offset:5120
    ds_read_b128 v[36:39], v5 offset:19456
    s_waitcnt lgkmcnt(4)
    v_mfma_f32_16x16x32_bf16 v[40:43], v[8:11], a[16:19], v[40:43]
    v_mfma_f32_16x16x32_bf16 v[44:47], v[12:15], a[16:19], v[44:47]
    v_mfma_f32_16x16x32_bf16 v[48:51], v[8:11], a[72:75], v[48:51]
    v_mfma_f32_16x16x32_bf16 v[52:55], v[12:15], a[72:75], v[52:55]
    v_mfma_f32_16x16x32_bf16 v[56:59], v[8:11], a[128:131], v[56:59]
    v_mfma_f32_16x16x32_bf16 v[60:63], v[12:15], a[128:131], v[60:63]
    v_mfma_f32_16x16x32_bf16 v[64:67], v[8:11], a[184:187], v[64:67]
    v_mfma_f32_16x16x32_bf16 v[68:71], v[12:15], a[184:187], v[68:71]
    v_mfma_f32_16x16x32_bf16 v[72:75], v[8:11], a[240:243], v[72:75]
    v_mfma_f32_16x16x32_bf16 v[76:79], v[12:15], a[240:243], v[76:79]
    v_mfma_f32_16x16x32_bf16 v[80:83], v[8:11], v[216:219], v[80:83]
    v_mfma_f32_16x16x32_bf16 v[84:87], v[12:15], v[216:219], v[84:87]
    v_mfma_f32_16x16x32_bf16 v[88:91], v[8:11], v[16:19], v[88:91]
    v_mfma_f32_16x16x32_bf16 v[92:95], v[12:15], v[16:19], v[92:95]
    v_mfma_f32_16x16x32_bf16 v[96:99], v[8:11], v[20:23], v[96:99]
    v_mfma_f32_16x16x32_bf16 v[100:103], v[12:15], v[20:23], v[100:103]
    ds_read_b128 v[8:11], v7 offset:12288
    ds_read_b128 v[12:15], v7 offset:13312
    ds_read_b128 v[16:19], v5 offset:6144
    ds_read_b128 v[20:23], v5 offset:20480
    s_waitcnt lgkmcnt(4)
    v_mfma_f32_16x16x32_bf16 v[40:43], v[24:27], a[20:23], v[40:43]
    v_mfma_f32_16x16x32_bf16 v[44:47], v[28:31], a[20:23], v[44:47]
    v_mfma_f32_16x16x32_bf16 v[48:51], v[24:27], a[76:79], v[48:51]
    v_mfma_f32_16x16x32_bf16 v[52:55], v[28:31], a[76:79], v[52:55]
    v_mfma_f32_16x16x32_bf16 v[56:59], v[24:27], a[132:135], v[56:59]
    v_mfma_f32_16x16x32_bf16 v[60:63], v[28:31], a[132:135], v[60:63]
    v_mfma_f32_16x16x32_bf16 v[64:67], v[24:27], a[188:191], v[64:67]
    v_mfma_f32_16x16x32_bf16 v[68:71], v[28:31], a[188:191], v[68:71]
    v_mfma_f32_16x16x32_bf16 v[72:75], v[24:27], a[244:247], v[72:75]
    v_mfma_f32_16x16x32_bf16 v[76:79], v[28:31], a[244:247], v[76:79]
    v_mfma_f32_16x16x32_bf16 v[80:83], v[24:27], v[220:223], v[80:83]
    v_mfma_f32_16x16x32_bf16 v[84:87], v[28:31], v[220:223], v[84:87]
    v_mfma_f32_16x16x32_bf16 v[88:91], v[24:27], v[32:35], v[88:91]
    v_mfma_f32_16x16x32_bf16 v[92:95], v[28:31], v[32:35], v[92:95]
    v_mfma_f32_16x16x32_bf16 v[96:99], v[24:27], v[36:39], v[96:99]
    v_mfma_f32_16x16x32_bf16 v[100:103], v[28:31], v[36:39], v[100:103]
    ds_read_b128 v[24:27], v7 offset:14336
    ds_read_b128 v[28:31], v7 offset:15360
    ds_read_b128 v[32:35], v5 offset:7168
    ds_read_b128 v[36:39], v5 offset:21504
    s_waitcnt lgkmcnt(4)
    v_mfma_f32_16x16x32_bf16 v[40:43], v[8:11], a[24:27], v[40:43]
    v_mfma_f32_16x16x32_bf16 v[44:47], v[12:15], a[24:27], v[44:47]
    v_mfma_f32_16x16x32_bf16 v[48:51], v[8:11], a[80:83], v[48:51]
    v_mfma_f32_16x16x32_bf16 v[52:55], v[12:15], a[80:83], v[52:55]
    v_mfma_f32_16x16x32_bf16 v[56:59], v[8:11], a[136:139], v[56:59]
    v_mfma_f32_16x16x32_bf16 v[60:63], v[12:15], a[136:139], v[60:63]
    v_mfma_f32_16x16x32_bf16 v[64:67], v[8:11], a[192:195], v[64:67]
    v_mfma_f32_16x16x32_bf16 v[68:71], v[12:15], a[192:195], v[68:71]
    v_mfma_f32_16x16x32_bf16 v[72:75], v[8:11], a[248:251], v[72:75]
    v_mfma_f32_16x16x32_bf16 v[76:79], v[12:15], a[248:251], v[76:79]
    v_mfma_f32_16x16x32_bf16 v[80:83], v[8:11], v[224:227], v[80:83]
    v_mfma_f32_16x16x32_bf16 v[84:87], v[12:15], v[224:227], v[84:87]
    v_mfma_f32_16x16x32_bf16 v[88:91], v[8:11], v[16:19], v[88:91]
    v_mfma_f32_16x16x32_bf16 v[92:95], v[12:15], v[16:19], v[92:95]
    v_mfma_f32_16x16x32_bf16 v[96:99], v[8:11], v[20:23], v[96:99]
    v_mfma_f32_16x16x32_bf16 v[100:103], v[12:15], v[20:23], v[100:103]
    ds_read_b128 v[8:11], v7 offset:16384
    ds_read_b128 v[12:15], v7 offset:17408
    ds_read_b128 v[16:19], v5 offset:8192
    ds_read_b128 v[20:23], v5 offset:22528
    s_waitcnt lgkmcnt(4)
    v_mfma_f32_16x16x32_bf16 v[40:43], v[24:27], a[28:31], v[40:43]
    v_mfma_f32_16x16x32_bf16 v[44:47], v[28:31], a[28:31], v[44:47]
    v_mfma_f32_16x16x32_bf16 v[48:51], v[24:27], a[84:87], v[48:51]
    v_mfma_f32_16x16x32_bf16 v[52:55], v[28:31], a[84:87], v[52:55]
    v_mfma_f32_16x16x32_bf16 v[56:59], v[24:27], a[140:143], v[56:59]
    v_mfma_f32_16x16x32_bf16 v[60:63], v[28:31], a[140:143], v[60:63]
    v_mfma_f32_16x16x32_bf16 v[64:67], v[24:27], a[196:199], v[64:67]
    v_mfma_f32_16x16x32_bf16 v[68:71], v[28:31], a[196:199], v[68:71]
    v_mfma_f32_16x16x32_bf16 v[72:75], v[24:27], a[252:255], v[72:75]
    v_mfma_f32_16x16x32_bf16 v[76:79], v[28:31], a[252:255], v[76:79]
    v_mfma_f32_16x16x32_bf16 v[80:83], v[24:27], v[228:231], v[80:83]
    v_mfma_f32_16x16x32_bf16 v[84:87], v[28:31], v[228:231], v[84:87]
    v_mfma_f32_16x16x32_bf16 v[88:91], v[24:27], v[32:35], v[88:91]
    v_mfma_f32_16x16x32_bf16 v[92:95], v[28:31], v[32:35], v[92:95]
    v_mfma_f32_16x16x32_bf16 v[96:99], v[24:27], v[36:39], v[96:99]
    v_mfma_f32_16x16x32_bf16 v[100:103], v[28:31], v[36:39], v[100:103]
    ds_read_b128 v[24:27], v7 offset:18432
    ds_read_b128 v[28:31], v7 offset:19456
    ds_read_b128 v[32:35], v5 offset:9216
    ds_read_b128 v[36:39], v5 offset:23552
    s_waitcnt lgkmcnt(4)
    v_mfma_f32_16x16x32_bf16 v[40:43], v[8:11], a[32:35], v[40:43]
    v_mfma_f32_16x16x32_bf16 v[44:47], v[12:15], a[32:35], v[44:47]
    v_mfma_f32_16x16x32_bf16 v[48:51], v[8:11], a[88:91], v[48:51]
    v_mfma_f32_16x16x32_bf16 v[52:55], v[12:15], a[88:91], v[52:55]
    v_mfma_f32_16x16x32_bf16 v[56:59], v[8:11], a[144:147], v[56:59]
    v_mfma_f32_16x16x32_bf16 v[60:63], v[12:15], a[144:147], v[60:63]
    v_mfma_f32_16x16x32_bf16 v[64:67], v[8:11], a[200:203], v[64:67]
    v_mfma_f32_16x16x32_bf16 v[68:71], v[12:15], a[200:203], v[68:71]
    v_mfma_f32_16x16x32_bf16 v[72:75], v[8:11], v[176:179], v[72:75]
    v_mfma_f32_16x16x32_bf16 v[76:79], v[12:15], v[176:179], v[76:79]
    v_mfma_f32_16x16x32_bf16 v[80:83], v[8:11], v[232:235], v[80:83]
    v_mfma_f32_16x16x32_bf16 v[84:87], v[12:15], v[232:235], v[84:87]
    v_mfma_f32_16x16x32_bf16 v[88:91], v[8:11], v[16:19], v[88:91]
    v_mfma_f32_16x16x32_bf16 v[92:95], v[12:15], v[16:19], v[92:95]
    v_mfma_f32_16x16x32_bf16 v[96:99], v[8:11], v[20:23], v[96:99]
    v_mfma_f32_16x16x32_bf16 v[100:103], v[12:15], v[20:23], v[100:103]
    ds_read_b128 v[8:11], v7 offset:20480
    ds_read_b128 v[12:15], v7 offset:21504
    ds_read_b128 v[16:19], v5 offset:10240
    ds_read_b128 v[20:23], v5 offset:24576
    s_waitcnt lgkmcnt(4)
    v_mfma_f32_16x16x32_bf16 v[40:43], v[24:27], a[36:39], v[40:43]
    v_mfma_f32_16x16x32_bf16 v[44:47], v[28:31], a[36:39], v[44:47]
    v_mfma_f32_16x16x32_bf16 v[48:51], v[24:27], a[92:95], v[48:51]
    v_mfma_f32_16x16x32_bf16 v[52:55], v[28:31], a[92:95], v[52:55]
    v_mfma_f32_16x16x32_bf16 v[56:59], v[24:27], a[148:151], v[56:59]
    v_mfma_f32_16x16x32_bf16 v[60:63], v[28:31], a[148:151], v[60:63]
    v_mfma_f32_16x16x32_bf16 v[64:67], v[24:27], a[204:207], v[64:67]
    v_mfma_f32_16x16x32_bf16 v[68:71], v[28:31], a[204:207], v[68:71]
    v_mfma_f32_16x16x32_bf16 v[72:75], v[24:27], v[180:183], v[72:75]
    v_mfma_f32_16x16x32_bf16 v[76:79], v[28:31], v[180:183], v[76:79]
    v_mfma_f32_16x16x32_bf16 v[80:83], v[24:27], v[236:239], v[80:83]
    v_mfma_f32_16x16x32_bf16 v[84:87], v[28:31], v[236:239], v[84:87]
    v_mfma_f32_16x16x32_bf16 v[88:91], v[24:27], v[32:35], v[88:91]
    v_mfma_f32_16x16x32_bf16 v[92:95], v[28:31], v[32:35], v[92:95]
    v_mfma_f32_16x16x32_bf16 v[96:99], v[24:27], v[36:39], v[96:99]
    v_mfma_f32_16x16x32_bf16 v[100:103], v[28:31], v[36:39], v[100:103]
    ds_read_b128 v[24:27], v7 offset:22528
    ds_read_b128 v[28:31], v7 offset:23552
    ds_read_b128 v[32:35], v5 offset:11264
    ds_read_b128 v[36:39], v5 offset:25600
    s_waitcnt lgkmcnt(4)
    v_mfma_f32_16x16x32_bf16 v[40:43], v[8:11], a[40:43], v[40:43]
    v_mfma_f32_16x16x32_bf16 v[44:47], v[12:15], a[40:43], v[44:47]
    v_mfma_f32_16x16x32_bf16 v[48:51], v[8:11], a[96:99], v[48:51]
    v_mfma_f32_16x16x32_bf16 v[52:55], v[12:15], a[96:99], v[52:55]
    v_mfma_f32_16x16x32_bf16 v[56:59], v[8:11], a[152:155], v[56:59]
    v_mfma_f32_16x16x32_bf16 v[60:63], v[12:15], a[152:155], v[60:63]
    v_mfma_f32_16x16x32_bf16 v[64:67], v[8:11], a[208:211], v[64:67]
    v_mfma_f32_16x16x32_bf16 v[68:71], v[12:15], a[208:211], v[68:71]
    v_mfma_f32_16x16x32_bf16 v[72:75], v[8:11], v[184:187], v[72:75]
    v_mfma_f32_16x16x32_bf16 v[76:79], v[12:15], v[184:187], v[76:79]
    v_mfma_f32_16x16x32_bf16 v[80:83], v[8:11], v[240:243], v[80:83]
    v_mfma_f32_16x16x32_bf16 v[84:87], v[12:15], v[240:243], v[84:87]
    v_mfma_f32_16x16x32_bf16 v[88:91], v[8:11], v[16:19], v[88:91]
    v_mfma_f32_16x16x32_bf16 v[92:95], v[12:15], v[16:19], v[92:95]
    v_mfma_f32_16x16x32_bf16 v[96:99], v[8:11], v[20:23], v[96:99]
    v_mfma_f32_16x16x32_bf16 v[100:103], v[12:15], v[20:23], v[100:103]
    ds_read_b128 v[8:11], v7 offset:24576
    ds_read_b128 v[12:15], v7 offset:25600
    ds_read_b128 v[16:19], v5 offset:12288
    ds_read_b128 v[20:23], v5 offset:26624
    s_waitcnt lgkmcnt(4)
    v_mfma_f32_16x16x32_bf16 v[40:43], v[24:27], a[44:47], v[40:43]
    v_mfma_f32_16x16x32_bf16 v[44:47], v[28:31], a[44:47], v[44:47]
    v_mfma_f32_16x16x32_bf16 v[48:51], v[24:27], a[100:103], v[48:51]
    v_mfma_f32_16x16x32_bf16 v[52:55], v[28:31], a[100:103], v[52:55]
    v_mfma_f32_16x16x32_bf16 v[56:59], v[24:27], a[156:159], v[56:59]
    v_mfma_f32_16x16x32_bf16 v[60:63], v[28:31], a[156:159], v[60:63]
    v_mfma_f32_16x16x32_bf16 v[64:67], v[24:27], a[212:215], v[64:67]
    v_mfma_f32_16x16x32_bf16 v[68:71], v[28:31], a[212:215], v[68:71]
    v_mfma_f32_16x16x32_bf16 v[72:75], v[24:27], v[188:191], v[72:75]
    v_mfma_f32_16x16x32_bf16 v[76:79], v[28:31], v[188:191], v[76:79]
    v_mfma_f32_16x16x32_bf16 v[80:83], v[24:27], v[244:247], v[80:83]
    v_mfma_f32_16x16x32_bf16 v[84:87], v[28:31], v[244:247], v[84:87]
    v_mfma_f32_16x16x32_bf16 v[88:91], v[24:27], v[32:35], v[88:91]
    v_mfma_f32_16x16x32_bf16 v[92:95], v[28:31], v[32:35], v[92:95]
    v_mfma_f32_16x16x32_bf16 v[96:99], v[24:27], v[36:39], v[96:99]
    v_mfma_f32_16x16x32_bf16 v[100:103], v[28:31], v[36:39], v[100:103]
    ds_read_b128 v[24:27], v7 offset:26624
    ds_read_b128 v[28:31], v7 offset:27648
    ds_read_b128 v[32:35], v5 offset:13312
    ds_read_b128 v[36:39], v5 offset:27648
    s_waitcnt lgkmcnt(4)
    v_mfma_f32_16x16x32_bf16 v[40:43], v[8:11], a[48:51], v[40:43]
    v_mfma_f32_16x16x32_bf16 v[44:47], v[12:15], a[48:51], v[44:47]
    v_mfma_f32_16x16x32_bf16 v[48:51], v[8:11], a[104:107], v[48:51]
    v_mfma_f32_16x16x32_bf16 v[52:55], v[12:15], a[104:107], v[52:55]
    v_mfma_f32_16x16x32_bf16 v[56:59], v[8:11], a[160:163], v[56:59]
    v_mfma_f32_16x16x32_bf16 v[60:63], v[12:15], a[160:163], v[60:63]
    v_mfma_f32_16x16x32_bf16 v[64:67], v[8:11], a[216:219], v[64:67]
    v_mfma_f32_16x16x32_bf16 v[68:71], v[12:15], a[216:219], v[68:71]
    v_mfma_f32_16x16x32_bf16 v[72:75], v[8:11], v[192:195], v[72:75]
    v_mfma_f32_16x16x32_bf16 v[76:79], v[12:15], v[192:195], v[76:79]
    v_mfma_f32_16x16x32_bf16 v[80:83], v[8:11], v[248:251], v[80:83]
    v_mfma_f32_16x16x32_bf16 v[84:87], v[12:15], v[248:251], v[84:87]
    v_mfma_f32_16x16x32_bf16 v[88:91], v[8:11], v[16:19], v[88:91]
    v_mfma_f32_16x16x32_bf16 v[92:95], v[12:15], v[16:19], v[92:95]
    v_mfma_f32_16x16x32_bf16 v[96:99], v[8:11], v[20:23], v[96:99]
    v_mfma_f32_16x16x32_bf16 v[100:103], v[12:15], v[20:23], v[100:103]
    s_waitcnt lgkmcnt(0)
    v_mfma_f32_16x16x32_bf16 v[40:43], v[24:27], a[52:55], v[40:43]
    v_mfma_f32_16x16x32_bf16 v[44:47], v[28:31], a[52:55], v[44:47]
    v_mfma_f32_16x16x32_bf16 v[48:51], v[24:27], a[108:111], v[48:51]
    v_mfma_f32_16x16x32_bf16 v[52:55], v[28:31], a[108:111], v[52:55]
    v_mfma_f32_16x16x32_bf16 v[56:59], v[24:27], a[164:167], v[56:59]
    v_mfma_f32_16x16x32_bf16 v[60:63], v[28:31], a[164:167], v[60:63]
    v_mfma_f32_16x16x32_bf16 v[64:67], v[24:27], a[220:223], v[64:67]
    v_mfma_f32_16x16x32_bf16 v[68:71], v[28:31], a[220:223], v[68:71]
    v_mfma_f32_16x16x32_bf16 v[72:75], v[24:27], v[196:199], v[72:75]
    v_mfma_f32_16x16x32_bf16 v[76:79], v[28:31], v[196:199], v[76:79]
    v_mfma_f32_16x16x32_bf16 v[80:83], v[24:27], v[252:255], v[80:83]
    v_mfma_f32_16x16x32_bf16 v[84:87], v[28:31], v[252:255], v[84:87]
    v_mfma_f32_16x16x32_bf16 v[88:91], v[24:27], v[32:35], v[88:91]
    v_mfma_f32_16x16x32_bf16 v[92:95], v[28:31], v[32:35], v[92:95]
    v_mfma_f32_16x16x32_bf16 v[96:99], v[24:27], v[36:39], v[96:99]
    v_mfma_f32_16x16x32_bf16 v[100:103], v[28:31], v[36:39], v[100:103]
    s_barrier
    s_add_u32 s41, s40, 4
    s_cmp_ge_u32 s41, 64
    s_cbranch_scc1 HB_nodma
    s_mul_i32 s58, s41, 28672
    s_mul_i32 s59, s3, 7168
    s_add_u32 m0, s59, 114688
    s_add_u32 s58, s58, 53706752
    s_add_u32 s56, s12, s58
    s_addc_u32 s57, s13, 0
    global_load_lds_dwordx4 v6, s[56:57] offset:0
    global_load_lds_dwordx4 v6, s[56:57] offset:1024
    global_load_lds_dwordx4 v6, s[56:57] offset:2048
    global_load_lds_dwordx4 v6, s[56:57] offset:3072
    s_add_u32 m0, m0, 4096
    s_add_u32 s56, s56, 4096
    s_addc_u32 s57, s57, 0
    global_load_lds_dwordx4 v6, s[56:57] offset:0
    global_load_lds_dwordx4 v6, s[56:57] offset:1024
    global_load_lds_dwordx4 v6, s[56:57] offset:2048
HB_nodma:
    s_mul_i32 s27, s40, 14
    s_add_u32 s27, s27, s26
    s_lshl_b32 s27, s27, 15
    s_lshl_b32 s28, s3, 13
    s_add_u32 s27, s27, s28
    s_add_u32 s27, s27, 24350720
    s_add_u32 s32, s12, s27
    s_addc_u32 s33, s13, 0
    v_cvt_pk_bf16_f32 v104, v40, v44
    v_cvt_pk_bf16_f32 v105, v56, v60
    v_cvt_pk_bf16_f32 v106, v41, v45
    v_cvt_pk_bf16_f32 v107, v57, v61
    global_store_dwordx4 v1, v[104:107], s[32:33] offset:-4096 sc1
    v_cvt_pk_bf16_f32 v108, v42, v46
    v_cvt_pk_bf16_f32 v109, v58, v62
    v_cvt_pk_bf16_f32 v110, v43, v47
    v_cvt_pk_bf16_f32 v111, v59, v63
    global_store_dwordx4 v1, v[108:111], s[32:33] offset:-3072 sc1
    v_cvt_pk_bf16_f32 v112, v48, v52
    v_cvt_pk_bf16_f32 v113, v64, v68
    v_cvt_pk_bf16_f32 v114, v49, v53
    v_cvt_pk_bf16_f32 v115, v65, v69
    global_store_dwordx4 v1, v[112:115], s[32:33] offset:-2048 sc1
    v_cvt_pk_bf16_f32 v116, v50, v54
    v_cvt_pk_bf16_f32 v117, v66, v70
    v_cvt_pk_bf16_f32 v118, v51, v55
    v_cvt_pk_bf16_f32 v119, v67, v71
    global_store_dwordx4 v1, v[116:119], s[32:33] offset:-1024 sc1
    v_cvt_pk_bf16_f32 v120, v72, v76
    v_cvt_pk_bf16_f32 v121, v88, v92
    v_cvt_pk_bf16_f32 v122, v73, v77
    v_cvt_pk_bf16_f32 v123, v89, v93
    global_store_dwordx4 v1, v[120:123], s[32:33] offset:0 sc1
    v_cvt_pk_bf16_f32 v124, v74, v78
    v_cvt_pk_bf16_f32 v125, v90, v94
    v_cvt_pk_bf16_f32 v126, v75, v79
    v_cvt_pk_bf16_f32 v127, v91, v95
    global_store_dwordx4 v1, v[124:127], s[32:33] offset:1024 sc1
    v_cvt_pk_bf16_f32 v128, v80, v84
    v_cvt_pk_bf16_f32 v129, v96, v100
    v_cvt_pk_bf16_f32 v130, v81, v85
    v_cvt_pk_bf16_f32 v131, v97, v101
    global_store_dwordx4 v1, v[128:131], s[32:33] offset:2048 sc1
    v_cvt_pk_bf16_f32 v132, v82, v86
    v_cvt_pk_bf16_f32 v133, v98, v102
    v_cvt_pk_bf16_f32 v134, v83, v87
    v_cvt_pk_bf16_f32 v135, v99, v103
    global_store_dwordx4 v1, v[132:135], s[32:33] offset:3072 sc1
    s_lshl_b32 s27, s40, 6
    s_lshl_b32 s28, s26, 2
    s_add_u32 s27, s27, s28
    s_waitcnt vmcnt(0)
    s_barrier
    s_cmp_lg_u32 s3, 0
    s_cbranch_scc1 SF_10
    s_mov_b64 exec, 1
    v_mov_b32 v2, 1
    v_mov_b32 v3, s27
    global_store_dword v3, v2, s[18:19] sc1
    s_mov_b64 exec, -1
SF_10:
    s_mov_b32 s40, s41
    s_cmp_lt_u32 s40, 64
    s_cbranch_scc1 HB_vo
    s_mov_b32 s40, s29
    v_lshlrev_b32 v7, 3, v0
    s_lshl_b32 s27, s3, 12
    s_add_u32 s27, s27, 114688
    v_add_u32 v168, s27, v1
    s_lshl_b32 s27, s3, 11
    s_add_u32 s27, s27, 114688
    v_add_u32 v169, s27, v1
    v_and_b32 v2, 15, v0
    v_lshrrev_b32 v3, 4, v0
    v_mul_u32_u24 v170, 1792, v2
    v_lshl_add_u32 v170, v3, 4, v170
    s_mul_i32 s27, s3, 28672
    s_lshl_b32 s28, s26, 6
    s_add_u32 s27, s27, s28
    s_add_u32 s27, s27, 896
    v_add_u32 v170, s27, v170
HB_out:
    s_mul_i32 s27, s40, 14
    s_add_u32 s27, s27, s26
    s_lshl_b32 s27, s27, 15
    s_lshl_b32 s28, s3, 13
    s_add_u32 s27, s27, s28
    s_add_u32 s27, s27, 24350720
    s_add_u32 s32, s12, s27
    s_addc_u32 s33, s13, 0
    s_mul_i32 s27, s40, 7168
    s_add_u32 s27, s27, 13765632
    s_add_u32 s30, s12, s27
    s_addc_u32 s31, s13, 0
    s_lshl_b32 s27, s40, 4
    s_lshl_b32 s28, s3, 2
    s_add_u32 s27, s27, s28
    s_lshl_b32 s28, s27, 2
    s_add_u32 s28, s28, 4096
    v_mov_b32 v171, s28
    s_mul_i32 s27, s27, 3072
    s_add_u32 s27, s27, 15371264
    s_add_u32 s34, s12, s27
    s_addc_u32 s35, s13, 0
    s_add_u32 s36, s34, 6144
    s_addc_u32 s37, s35, 0
    s_mul_i32 s27, s40, 57344
    s_add_u32 s38, s14, s27
    s_addc_u32 s39, s15, 0
    global_load_dwordx4 v[84:87], v1, s[32:33] offset:-4096 sc1
    global_load_dwordx4 v[88:91], v1, s[32:33] offset:-3072 sc1
    global_load_dwordx4 v[92:95], v1, s[32:33] offset:-2048 sc1
    global_load_dwordx4 v[96:99], v1, s[32:33] offset:-1024 sc1
    global_load_dwordx4 v[100:103], v1, s[32:33] offset:0 sc1
    global_load_dwordx4 v[104:107], v1, s[32:33] offset:1024 sc1
    global_load_dwordx4 v[108:111], v1, s[32:33] offset:2048 sc1
    global_load_dwordx4 v[112:115], v1, s[32:33] offset:3072 sc1
    v_mov_b64 v[36:37], 0
    v_mov_b64 v[38:39], 0
    v_mov_b64 v[40:41], 0
    v_mov_b64 v[42:43], 0
    v_mov_b64 v[44:45], 0
    v_mov_b64 v[46:47], 0
    v_mov_b64 v[48:49], 0
    v_mov_b64 v[50:51], 0
    v_mov_b64 v[52:53], 0
    v_mov_b64 v[54:55], 0
    v_mov_b64 v[56:57], 0
    v_mov_b64 v[58:59], 0
    v_mov_b64 v[60:61], 0
    v_mov_b64 v[62:63], 0
    v_mov_b64 v[64:65], 0
    v_mov_b64 v[66:67], 0
    s_mov_b32 s41, 524288
HB_pm:
    global_load_dwordx4 v[8:11], v1, s[30:31] offset:-3072 sc1
    global_load_dwordx4 v[12:15], v1, s[30:31] offset:-2048 sc1
    global_load_dwordx4 v[16:19], v1, s[30:31] offset:-1024 sc1
    global_load_dwordx4 v[20:23], v1, s[30:31] offset:0 sc1
    global_load_dwordx4 v[24:27], v1, s[30:31] offset:1024 sc1
    global_load_dwordx4 v[28:31], v1, s[30:31] offset:2048 sc1
    global_load_dwordx4 v[32:35], v1, s[30:31] offset:3072 sc1
    s_sub_u32 s41, s41, 1
    s_cbranch_scc1 BAIL_6
    s_waitcnt vmcnt(0)
    v_max3_u32 v2, v8, v9, v10
    v_max3_u32 v2, v2, v11, v12
    v_max3_u32 v2, v2, v13, v14
    v_max3_u32 v2, v2, v15, v16
    v_max3_u32 v2, v2, v17, v18
    v_max3_u32 v2, v2, v19, v20
    v_max3_u32 v2, v2, v21, v22
    v_max3_u32 v2, v2, v23, v24
    v_max3_u32 v2, v2, v25, v26
    v_max3_u32 v2, v2, v27, v28
    v_max3_u32 v2, v2, v29, v30
    v_max3_u32 v2, v2, v31, v32
    v_max3_u32 v2, v2, v33, v34
    v_max_u32 v2, v2, v35
    v_cmp_eq_u32 vcc, -1, v2
    s_cbranch_vccz HB_pm_ok
    s_sleep 2
    s_cmp_ge_u32 s40, 63
    s_cbranch_scc1 HB_pm
    s_sleep 16
    s_branch HB_pm
HB_pm_ok:
    ds_read_b128 v[68:71], v5 offset:0
    ds_read_b128 v[72:75], v5 offset:1024
    ds_read_b128 v[76:79], v5 offset:14336
    ds_read_b128 v[80:83], v5 offset:15360
    s_waitcnt lgkmcnt(2)
    v_smfmac_f32_16x16x64_bf16 v[60:63], v[8:11], v[68:75], v4
    ds_read_b128 v[68:71], v5 offset:2048
    v_smfmac_f32_16x16x64_bf16 v[36:39], v[8:11], a[0:7], v4
    ds_read_b128 v[72:75], v5 offset:3072
    v_smfmac_f32_16x16x64_bf16 v[44:47], v[8:11], a[112:119], v4
    v_smfmac_f32_16x16x64_bf16 v[52:55], v[8:11], a[224:231], v4
    s_waitcnt lgkmcnt(2)
    v_smfmac_f32_16x16x64_bf16 v[64:67], v[8:11], v[76:83], v4
    ds_read_b128 v[76:79], v5 offset:16384
    v_smfmac_f32_16x16x64_bf16 v[40:43], v[8:11], a[56:63], v4
    ds_read_b128 v[80:83], v5 offset:17408
    v_smfmac_f32_16x16x64_bf16 v[48:51], v[8:11], a[168:175], v4
    v_smfmac_f32_16x16x64_bf16 v[56:59], v[8:11], v[200:207], v4
    s_waitcnt lgkmcnt(2)
    v_smfmac_f32_16x16x64_bf16 v[60:63], v[12:15], v[68:75], v4
    ds_read_b128 v[68:71], v5 offset:4096
    v_smfmac_f32_16x16x64_bf16 v[36:39], v[12:15], a[8:15], v4
    ds_read_b128 v[72:75], v5 offset:5120
    v_smfmac_f32_16x16x64_bf16 v[44:47], v[12:15], a[120:127], v4
    v_smfmac_f32_16x16x64_bf16 v[52:55], v[12:15], a[232:239], v4
    s_waitcnt lgkmcnt(2)
    v_smfmac_f32_16x16x64_bf16 v[64:67], v[12:15], v[76:83], v4
    ds_read_b128 v[76:79], v5 offset:18432
    v_smfmac_f32_16x16x64_bf16 v[40:43], v[12:15], a[64:71], v4
    ds_read_b128 v[80:83], v5 offset:19456
    v_smfmac_f32_16x16x64_bf16 v[48:51], v[12:15], a[176:183], v4
    v_smfmac_f32_16x16x64_bf16 v[56:59], v[12:15], v[208:215], v4
    s_waitcnt lgkmcnt(2)
    v_smfmac_f32_16x16x64_bf16 v[60:63], v[16:19], v[68:75], v4
    ds_read_b128 v[68:71], v5 offset:6144
    v_smfmac_f32_16x16x64_bf16 v[36:39], v[16:19], a[16:23], v4
    ds_read_b128 v[72:75], v5 offset:7168
    v_smfmac_f32_16x16x64_bf16 v[44:47], v[16:19], a[128:135], v4
    v_smfmac_f32_16x16x64_bf16 v[52:55], v[16:19], a[240:247], v4
    s_waitcnt lgkmcnt(2)
    v_smfmac_f32_16x16x64_bf16 v[64:67], v[16:19], v[76:83], v4
    ds_read_b128 v[76:79], v5 offset:20480
    v_smfmac_f32_16x16x64_bf16 v[40:43], v[16:19], a[72:79], v4
    ds_read_b128 v[80:83], v5 offset:21504
    v_smfmac_f32_16x16x64_bf16 v[48:51], v[16:19], a[184:191], v4
    v_smfmac_f32_16x16x64_bf16 v[56:59], v[16:19], v[216:223], v4
    s_waitcnt lgkmcnt(2)
    v_smfmac_f32_16x16x64_bf16 v[60:63], v[20:23], v[68:75], v4
    ds_read_b128 v[68:71], v5 offset:8192
    v_smfmac_f32_16x16x64_bf16 v[36:39], v[20:23], a[24:31], v4
    ds_read_b128 v[72:75], v5 offset:9216
    v_smfmac_f32_16x16x64_bf16 v[44:47], v[20:23], a[136:143], v4
    v_smfmac_f32_16x16x64_bf16 v[52:55], v[20:23], a[248:255], v4
    s_waitcnt lgkmcnt(2)
    v_smfmac_f32_16x16x64_bf16 v[64:67], v[20:23], v[76:83], v4
    ds_read_b128 v[76:79], v5 offset:22528
    v_smfmac_f32_16x16x64_bf16 v[40:43], v[20:23], a[80:87], v4
    ds_read_b128 v[80:83], v5 offset:23552
    v_smfmac_f32_16x16x64_bf16 v[48:51], v[20:23], a[192:199], v4
    v_smfmac_f32_16x16x64_bf16 v[56:59], v[20:23], v[224:231], v4
    s_waitcnt lgkmcnt(2)
    v_smfmac_f32_16x16x64_bf16 v[60:63], v[24:27], v[68:75], v4
    ds_read_b128 v[68:71], v5 offset:10240
    v_smfmac_f32_16x16x64_bf16 v[36:39], v[24:27], a[32:39], v4
    ds_read_b128 v[72:75], v5 offset:11264
    v_smfmac_f32_16x16x64_bf16 v[44:47], v[24:27], a[144:151], v4
    v_smfmac_f32_16x16x64_bf16 v[52:55], v[24:27], v[176:183], v4
    s_waitcnt lgkmcnt(2)
    v_smfmac_f32_16x16x64_bf16 v[64:67], v[24:27], v[76:83], v4
    ds_read_b128 v[76:79], v5 offset:24576
    v_smfmac_f32_16x16x64_bf16 v[40:43], v[24:27], a[88:95], v4
    ds_read_b128 v[80:83], v5 offset:25600
    v_smfmac_f32_16x16x64_bf16 v[48:51], v[24:27], a[200:207], v4
    v_smfmac_f32_16x16x64_bf16 v[56:59], v[24:27], v[232:239], v4
    s_waitcnt lgkmcnt(2)
    v_smfmac_f32_16x16x64_bf16 v[60:63], v[28:31], v[68:75], v4
    ds_read_b128 v[68:71], v5 offset:12288
    v_smfmac_f32_16x16x64_bf16 v[36:39], v[28:31], a[40:47], v4
    ds_read_b128 v[72:75], v5 offset:13312
    v_smfmac_f32_16x16x64_bf16 v[44:47], v[28:31], a[152:159], v4
    v_smfmac_f32_16x16x64_bf16 v[52:55], v[28:31], v[184:191], v4
    s_waitcnt lgkmcnt(2)
    v_smfmac_f32_16x16x64_bf16 v[64:67], v[28:31], v[76:83], v4
    ds_read_b128 v[76:79], v5 offset:26624
    v_smfmac_f32_16x16x64_bf16 v[40:43], v[28:31], a[96:103], v4
    ds_read_b128 v[80:83], v5 offset:27648
    v_smfmac_f32_16x16x64_bf16 v[48:51], v[28:31], a[208:215], v4
    v_smfmac_f32_16x16x64_bf16 v[56:59], v[28:31], v[240:247], v4
    s_waitcnt lgkmcnt(2)
    v_smfmac_f32_16x16x64_bf16 v[60:63], v[32:35], v[68:75], v4
    v_smfmac_f32_16x16x64_bf16 v[36:39], v[32:35], a[48:55], v4
    v_smfmac_f32_16x16x64_bf16 v[44:47], v[32:35], a[160:167], v4
    v_smfmac_f32_16x16x64_bf16 v[52:55], v[32:35], v[192:199], v4
    s_waitcnt lgkmcnt(0)
    v_smfmac_f32_16x16x64_bf16 v[64:67], v[32:35], v[76:83], v4
    v_smfmac_f32_16x16x64_bf16 v[40:43], v[32:35], a[104:111], v4
    v_smfmac_f32_16x16x64_bf16 v[48:51], v[32:35], a[216:223], v4
    v_smfmac_f32_16x16x64_bf16 v[56:59], v[32:35], v[248:255], v4
    v_swap_b32 v85, v86
    v_swap_b32 v86, v88
    v_swap_b32 v87, v90
    v_swap_b32 v89, v90
    v_swap_b32 v93, v94
    v_swap_b32 v94, v96
    v_swap_b32 v95, v98
    v_swap_b32 v97, v98
    v_swap_b32 v101, v102
    v_swap_b32 v102, v104
    v_swap_b32 v103, v106
    v_swap_b32 v105, v106
    v_swap_b32 v109, v110
    v_swap_b32 v110, v112
    v_swap_b32 v111, v114
    v_swap_b32 v113, v114
    v_cvt_pk_bf16_f32 v68, v36, v37
    v_cvt_pk_bf16_f32 v69, v38, v39
    v_cvt_pk_bf16_f32 v70, v44, v45
    v_cvt_pk_bf16_f32 v71, v46, v47
    v_cvt_pk_bf16_f32 v72, v52, v53
    v_cvt_pk_bf16_f32 v73, v54, v55
    v_cvt_pk_bf16_f32 v74, v60, v61
    v_cvt_pk_bf16_f32 v75, v62, v63
    v_cvt_pk_bf16_f32 v76, v40, v41
    v_cvt_pk_bf16_f32 v77, v42, v43
    v_cvt_pk_bf16_f32 v78, v48, v49
    v_cvt_pk_bf16_f32 v79, v50, v51
    v_cvt_pk_bf16_f32 v80, v56, v57
    v_cvt_pk_bf16_f32 v81, v58, v59
    v_cvt_pk_bf16_f32 v82, v64, v65
    v_cvt_pk_bf16_f32 v83, v66, v67
HB_pf:
    global_load_dwordx4 v[160:163], v171, s[18:19] sc1
    s_sub_u32 s41, s41, 1
    s_cbranch_scc1 BAIL_6
    s_waitcnt vmcnt(0)
    v_and_b32 v2, v160, v161
    v_and_b32 v3, v162, v163
    v_and_b32 v2, v2, v3
    v_cmp_eq_u32 vcc, 0, v2
    s_cbranch_vccz HB_pf_ok
    s_sleep 4
    s_branch HB_pf
HB_pf_ok:
    global_load_dwordx4 v[116:119], v1, s[34:35] offset:-3072 sc1
    global_load_dwordx2 v[148:149], v7, s[34:35] offset:-2048 sc1
    global_load_dwordx4 v[120:123], v1, s[34:35] offset:-1536 sc1
    global_load_dwordx2 v[152:153], v7, s[34:35] offset:-512 sc1
    global_load_dwordx4 v[124:127], v1, s[34:35] offset:0 sc1
    global_load_dwordx2 v[150:151], v7, s[34:35] offset:1024 sc1
    global_load_dwordx4 v[128:131], v1, s[34:35] offset:1536 sc1
    global_load_dwordx2 v[154:155], v7, s[34:35] offset:2560 sc1
    global_load_dwordx4 v[132:135], v1, s[36:37] offset:-3072 sc1
    global_load_dwordx2 v[156:157], v7, s[36:37] offset:-2048 sc1
    global_load_dwordx4 v[136:139], v1, s[36:37] offset:-1536 sc1
    global_load_dwordx2 v[160:161], v7, s[36:37] offset:-512 sc1
    global_load_dwordx4 v[140:143], v1, s[36:37] offset:0 sc1
    global_load_dwordx2 v[158:159], v7, s[36:37] offset:1024 sc1
    global_load_dwordx4 v[144:147], v1, s[36:37] offset:1536 sc1
    global_load_dwordx2 v[162:163], v7, s[36:37] offset:2560 sc1
    s_waitcnt vmcnt(8)
    v_mfma_f32_16x16x32_bf16 v[8:11], v[84:87], v[116:119], 0
    v_mfma_f32_16x16x32_bf16 v[16:19], v[84:87], v[120:123], 0
    v_mfma_f32_16x16x32_bf16 v[12:15], v[92:95], v[116:119], 0
    v_mfma_f32_16x16x32_bf16 v[20:23], v[92:95], v[120:123], 0
    v_mfma_f32_16x16x32_bf16 v[8:11], v[88:91], v[124:127], v[8:11]
    v_mfma_f32_16x16x32_bf16 v[16:19], v[88:91], v[128:131], v[16:19]
    v_mfma_f32_16x16x32_bf16 v[12:15], v[96:99], v[124:127], v[12:15]
    v_mfma_f32_16x16x32_bf16 v[20:23], v[96:99], v[128:131], v[20:23]
    v_mfma_f32_16x16x32_bf16 v[8:11], v[68:71], v[148:151], v[8:11]
    v_mfma_f32_16x16x32_bf16 v[16:19], v[68:71], v[152:155], v[16:19]
    v_mfma_f32_16x16x32_bf16 v[12:15], v[76:79], v[148:151], v[12:15]
    v_mfma_f32_16x16x32_bf16 v[20:23], v[76:79], v[152:155], v[20:23]
    s_waitcnt vmcnt(0)
    v_mfma_f32_16x16x32_bf16 v[8:11], v[100:103], v[132:135], v[8:11]
    v_mfma_f32_16x16x32_bf16 v[16:19], v[100:103], v[136:139], v[16:19]
    v_mfma_f32_16x16x32_bf16 v[12:15], v[108:111], v[132:135], v[12:15]
    v_mfma_f32_16x16x32_bf16 v[20:23], v[108:111], v[136:139], v[20:23]
    v_mfma_f32_16x16x32_bf16 v[8:11], v[104:107], v[140:143], v[8:11]
    v_mfma_f32_16x16x32_bf16 v[16:19], v[104:107], v[144:147], v[16:19]
    v_mfma_f32_16x16x32_bf16 v[12:15], v[112:115], v[140:143], v[12:15]
    v_mfma_f32_16x16x32_bf16 v[20:23], v[112:115], v[144:147], v[20:23]
    v_mfma_f32_16x16x32_bf16 v[8:11], v[72:75], v[156:159], v[8:11]
    v_mfma_f32_16x16x32_bf16 v[16:19], v[72:75], v[160:163], v[16:19]
    v_mfma_f32_16x16x32_bf16 v[12:15], v[80:83], v[156:159], v[12:15]
    v_mfma_f32_16x16x32_bf16 v[20:23], v[80:83], v[160:163], v[20:23]
    ds_write_b128 v168, v[8:11] offset:0
    s_nop 2
    ds_write_b128 v168, v[12:15] offset:1024
    ds_write_b128 v168, v[16:19] offset:2048
    s_nop 1
    ds_write_b128 v168, v[20:23] offset:3072
    s_waitcnt lgkmcnt(0)
    s_barrier
    s_cmp_ge_u32 s3, 2
    s_cbranch_scc1 HB_ost
    ds_read_b128 v[8:11], v169 offset:0
    ds_read_b128 v[12:15], v169 offset:1024
    ds_read_b128 v[16:19], v169 offset:4096
    ds_read_b128 v[20:23], v169 offset:5120
    ds_read_b128 v[24:27], v169 offset:8192
    ds_read_b128 v[28:31], v169 offset:9216
    ds_read_b128 v[32:35], v169 offset:12288
    ds_read_b128 v[36:39], v169 offset:13312
    s_waitcnt lgkmcnt(4)
    v_pk_add_f32 v[8:9], v[8:9], v[16:17]
    v_pk_add_f32 v[10:11], v[10:11], v[18:19]
    v_pk_add_f32 v[12:13], v[12:13], v[20:21]
    v_pk_add_f32 v[14:15], v[14:15], v[22:23]
    s_waitcnt lgkmcnt(2)
    v_pk_add_f32 v[8:9], v[8:9], v[24:25]
    v_pk_add_f32 v[10:11], v[10:11], v[26:27]
    v_pk_add_f32 v[12:13], v[12:13], v[28:29]
    v_pk_add_f32 v[14:15], v[14:15], v[30:31]
    s_waitcnt lgkmcnt(0)
    v_pk_add_f32 v[8:9], v[8:9], v[32:33]
    v_pk_add_f32 v[10:11], v[10:11], v[34:35]
    v_pk_add_f32 v[12:13], v[12:13], v[36:37]
    v_pk_add_f32 v[14:15], v[14:15], v[38:39]
    v_cvt_pk_bf16_f32 v16, v8, v9
    v_cvt_pk_bf16_f32 v17, v10, v11
    v_cvt_pk_bf16_f32 v18, v12, v13
    v_cvt_pk_bf16_f32 v19, v14, v15
    global_store_dwordx4 v170, v[16:19], s[38:39]
HB_ost:
    s_barrier
    s_add_u32 s40, s40, 4
    s_cmp_lt_u32 s40, 64
    s_cbranch_scc1 HB_out
    s_endpgm
HA_start:
    s_mul_i32 s27, s3, 7168
    v_add_u32 v6, s27, v1
    s_mov_b32 s40, s29
    s_mul_i32 s58, s40, 28672
    s_mul_i32 s59, s3, 7168
    s_add_u32 m0, s59, 0
    s_add_u32 s58, s58, 53706752
    s_add_u32 s56, s12, s58
    s_addc_u32 s57, s13, 0
    global_load_lds_dwordx4 v6, s[56:57] offset:0
    global_load_lds_dwordx4 v6, s[56:57] offset:1024
    global_load_lds_dwordx4 v6, s[56:57] offset:2048
    global_load_lds_dwordx4 v6, s[56:57] offset:3072
    s_add_u32 m0, m0, 4096
    s_add_u32 s56, s56, 4096
    s_addc_u32 s57, s57, 0
    global_load_lds_dwordx4 v6, s[56:57] offset:0
    global_load_lds_dwordx4 v6, s[56:57] offset:1024
    global_load_lds_dwordx4 v6, s[56:57] offset:2048
    v_and_b32 v2, 15, v0
    v_lshrrev_b32 v3, 4, v0
    s_mul_i32 s27, s3, 14
    v_lshl_add_u32 v8, v3, 1, s27
    v_lshlrev_b32 v9, 1, v3
    v_min_u32 v9, 5, v9
    v_add3_u32 v9, v9, s27, 8
    v_and_b32 v10, 1, v3
    v_lshlrev_b32 v10, 1, v10
    v_add3_u32 v10, v10, s27, 9
    v_and_b32 v11, 7, v2
    v_lshlrev_b32 v11, 4, v11
    v_lshrrev_b32 v12, 1, v3
    v_lshrrev_b32 v14, 2, v8
    v_and_b32 v15, 3, v8
    v_lshlrev_b32 v5, 11, v14
    v_lshl_add_u32 v5, v15, 8, v5
    v_lshl_add_u32 v5, v2, 4, v5
    v_lshrrev_b32 v14, 1, v8
    v_lshl_add_u32 v118, v14, 8, v11
    v_and_b32 v14, 1, v8
    v_lshl_add_u32 v118, v14, 3, v118
    v_lshrrev_b32 v14, 2, v9
    v_and_b32 v15, 3, v9
    v_lshlrev_b32 v7, 11, v14
    v_lshl_add_u32 v7, v15, 8, v7
    v_lshl_add_u32 v7, v2, 4, v7
    v_lshrrev_b32 v14, 1, v9
    v_lshl_add_u32 v119, v14, 8, v11
    v_and_b32 v14, 1, v9
    v_lshl_add_u32 v119, v14, 3, v119
    v_lshrrev_b32 v14, 2, v10
    v_and_b32 v15, 3, v10
    v_lshlrev_b32 v116, 11, v14
    v_lshl_add_u32 v116, v15, 8, v116
    v_lshl_add_u32 v116, v2, 4, v116
    v_lshrrev_b32 v14, 1, v10
    v_lshl_add_u32 v117, v14, 8, v11
    v_and_b32 v14, 1, v10
    v_lshl_add_u32 v117, v14, 3, v117
    v_lshl_add_u32 v116, v12, 2, v116
    v_lshl_add_u32 v117, v12, 7, v117
    s_mul_i32 s27, s3, 6144
    s_add_u32 s27, s27, 65536
    v_add_u32 v4, s27, v1
    s_lshl_b32 s27, s3, 4
    v_lshlrev_b32 v3, 2, v3
    v_sub_u32 v0, v2, v3
    v_add_u32 v0, s27, v0
    s_mov_b32 s42, 0
    s_mov_b32 s45, 4048155338
    s_waitcnt vmcnt(0)
    s_barrier
HA_job:
    s_add_u32 s41, s40, 4
    s_xor_b32 s43, s42, 32768
    s_cmp_ge_u32 s41, 64
    s_cbranch_scc1 HA_nodma
    s_mul_i32 s58, s41, 28672
    s_mul_i32 s59, s3, 7168
    s_add_u32 m0, s59, s43
    s_add_u32 s58, s58, 53706752
    s_add_u32 s56, s12, s58
    s_addc_u32 s57, s13, 0
    global_load_lds_dwordx4 v6, s[56:57] offset:0
    global_load_lds_dwordx4 v6, s[56:57] offset:1024
    global_load_lds_dwordx4 v6, s[56:57] offset:2048
    global_load_lds_dwordx4 v6, s[56:57] offset:3072
    s_add_u32 m0, m0, 4096
    s_add_u32 s56, s56, 4096
    s_addc_u32 s57, s57, 0
    global_load_lds_dwordx4 v6, s[56:57] offset:0
    global_load_lds_dwordx4 v6, s[56:57] offset:1024
    global_load_lds_dwordx4 v6, s[56:57] offset:2048
HA_nodma:
    v_add_u32 v2, s42, v1
    ds_read_b128 v[64:67], v2 offset:0
    ds_read_b128 v[68:71], v2 offset:1024
    ds_read_b128 v[72:75], v2 offset:2048
    ds_read_b128 v[76:79], v2 offset:3072
    s_waitcnt lgkmcnt(2)
    v_mfma_f32_16x16x32_bf16 v[8:11], a[0:3], v[64:67], 0
    v_mfma_f32_16x16x32_bf16 v[36:39], a[0:3], v[68:71], 0
    v_mfma_f32_16x16x32_bf16 v[12:15], a[56:59], v[64:67], 0
    v_mfma_f32_16x16x32_bf16 v[40:43], a[56:59], v[68:71], 0
    v_mfma_f32_16x16x32_bf16 v[16:19], a[112:115], v[64:67], 0
    v_mfma_f32_16x16x32_bf16 v[44:47], a[112:115], v[68:71], 0
    v_mfma_f32_16x16x32_bf16 v[20:23], a[168:171], v[64:67], 0
    v_mfma_f32_16x16x32_bf16 v[48:51], a[168:171], v[68:71], 0
    v_mfma_f32_16x16x32_bf16 v[24:27], a[224:227], v[64:67], 0
    v_mfma_f32_16x16x32_bf16 v[52:55], a[224:227], v[68:71], 0
    v_mfma_f32_16x16x32_bf16 v[28:31], v[144:147], v[64:67], 0
    v_mfma_f32_16x16x32_bf16 v[56:59], v[144:147], v[68:71], 0
    v_mfma_f32_16x16x32_bf16 v[32:35], v[200:203], v[64:67], 0
    v_mfma_f32_16x16x32_bf16 v[60:63], v[200:203], v[68:71], 0
    ds_read_b128 v[64:67], v2 offset:4096
    ds_read_b128 v[68:71], v2 offset:5120
    s_waitcnt lgkmcnt(2)
    v_mfma_f32_16x16x32_bf16 v[8:11], a[4:7], v[72:75], v[8:11]
    v_mfma_f32_16x16x32_bf16 v[36:39], a[4:7], v[76:79], v[36:39]
    v_mfma_f32_16x16x32_bf16 v[12:15], a[60:63], v[72:75], v[12:15]
    v_mfma_f32_16x16x32_bf16 v[40:43], a[60:63], v[76:79], v[40:43]
    v_mfma_f32_16x16x32_bf16 v[16:19], a[116:119], v[72:75], v[16:19]
    v_mfma_f32_16x16x32_bf16 v[44:47], a[116:119], v[76:79], v[44:47]
    v_mfma_f32_16x16x32_bf16 v[20:23], a[172:175], v[72:75], v[20:23]
    v_mfma_f32_16x16x32_bf16 v[48:51], a[172:175], v[76:79], v[48:51]
    v_mfma_f32_16x16x32_bf16 v[24:27], a[228:231], v[72:75], v[24:27]
    v_mfma_f32_16x16x32_bf16 v[52:55], a[228:231], v[76:79], v[52:55]
    v_mfma_f32_16x16x32_bf16 v[28:31], v[148:151], v[72:75], v[28:31]
    v_mfma_f32_16x16x32_bf16 v[56:59], v[148:151], v[76:79], v[56:59]
    v_mfma_f32_16x16x32_bf16 v[32:35], v[204:207], v[72:75], v[32:35]
    v_mfma_f32_16x16x32_bf16 v[60:63], v[204:207], v[76:79], v[60:63]
    ds_read_b128 v[72:75], v2 offset:6144
    ds_read_b128 v[76:79], v2 offset:7168
    s_waitcnt lgkmcnt(2)
    v_mfma_f32_16x16x32_bf16 v[8:11], a[8:11], v[64:67], v[8:11]
    v_mfma_f32_16x16x32_bf16 v[36:39], a[8:11], v[68:71], v[36:39]
    v_mfma_f32_16x16x32_bf16 v[12:15], a[64:67], v[64:67], v[12:15]
    v_mfma_f32_16x16x32_bf16 v[40:43], a[64:67], v[68:71], v[40:43]
    v_mfma_f32_16x16x32_bf16 v[16:19], a[120:123], v[64:67], v[16:19]
    v_mfma_f32_16x16x32_bf16 v[44:47], a[120:123], v[68:71], v[44:47]
    v_mfma_f32_16x16x32_bf16 v[20:23], a[176:179], v[64:67], v[20:23]
    v_mfma_f32_16x16x32_bf16 v[48:51], a[176:179], v[68:71], v[48:51]
    v_mfma_f32_16x16x32_bf16 v[24:27], a[232:235], v[64:67], v[24:27]
    v_mfma_f32_16x16x32_bf16 v[52:55], a[232:235], v[68:71], v[52:55]
    v_mfma_f32_16x16x32_bf16 v[28:31], v[152:155], v[64:67], v[28:31]
    v_mfma_f32_16x16x32_bf16 v[56:59], v[152:155], v[68:71], v[56:59]
    v_mfma_f32_16x16x32_bf16 v[32:35], v[208:211], v[64:67], v[32:35]
    v_mfma_f32_16x16x32_bf16 v[60:63], v[208:211], v[68:71], v[60:63]
    ds_read_b128 v[64:67], v2 offset:8192
    ds_read_b128 v[68:71], v2 offset:9216
    s_waitcnt lgkmcnt(2)
    v_mfma_f32_16x16x32_bf16 v[8:11], a[12:15], v[72:75], v[8:11]
    v_mfma_f32_16x16x32_bf16 v[36:39], a[12:15], v[76:79], v[36:39]
    v_mfma_f32_16x16x32_bf16 v[12:15], a[68:71], v[72:75], v[12:15]
    v_mfma_f32_16x16x32_bf16 v[40:43], a[68:71], v[76:79], v[40:43]
    v_mfma_f32_16x16x32_bf16 v[16:19], a[124:127], v[72:75], v[16:19]
    v_mfma_f32_16x16x32_bf16 v[44:47], a[124:127], v[76:79], v[44:47]
    v_mfma_f32_16x16x32_bf16 v[20:23], a[180:183], v[72:75], v[20:23]
    v_mfma_f32_16x16x32_bf16 v[48:51], a[180:183], v[76:79], v[48:51]
    v_mfma_f32_16x16x32_bf16 v[24:27], a[236:239], v[72:75], v[24:27]
    v_mfma_f32_16x16x32_bf16 v[52:55], a[236:239], v[76:79], v[52:55]
    v_mfma_f32_16x16x32_bf16 v[28:31], v[156:159], v[72:75], v[28:31]
    v_mfma_f32_16x16x32_bf16 v[56:59], v[156:159], v[76:79], v[56:59]
    v_mfma_f32_16x16x32_bf16 v[32:35], v[212:215], v[72:75], v[32:35]
    v_mfma_f32_16x16x32_bf16 v[60:63], v[212:215], v[76:79], v[60:63]
    ds_read_b128 v[72:75], v2 offset:10240
    ds_read_b128 v[76:79], v2 offset:11264
    s_waitcnt lgkmcnt(2)
    v_mfma_f32_16x16x32_bf16 v[8:11], a[16:19], v[64:67], v[8:11]
    v_mfma_f32_16x16x32_bf16 v[36:39], a[16:19], v[68:71], v[36:39]
    v_mfma_f32_16x16x32_bf16 v[12:15], a[72:75], v[64:67], v[12:15]
    v_mfma_f32_16x16x32_bf16 v[40:43], a[72:75], v[68:71], v[40:43]
    v_mfma_f32_16x16x32_bf16 v[16:19], a[128:131], v[64:67], v[16:19]
    v_mfma_f32_16x16x32_bf16 v[44:47], a[128:131], v[68:71], v[44:47]
    v_mfma_f32_16x16x32_bf16 v[20:23], a[184:187], v[64:67], v[20:23]
    v_mfma_f32_16x16x32_bf16 v[48:51], a[184:187], v[68:71], v[48:51]
    v_mfma_f32_16x16x32_bf16 v[24:27], a[240:243], v[64:67], v[24:27]
    v_mfma_f32_16x16x32_bf16 v[52:55], a[240:243], v[68:71], v[52:55]
    v_mfma_f32_16x16x32_bf16 v[28:31], v[160:163], v[64:67], v[28:31]
    v_mfma_f32_16x16x32_bf16 v[56:59], v[160:163], v[68:71], v[56:59]
    v_mfma_f32_16x16x32_bf16 v[32:35], v[216:219], v[64:67], v[32:35]
    v_mfma_f32_16x16x32_bf16 v[60:63], v[216:219], v[68:71], v[60:63]
    ds_read_b128 v[64:67], v2 offset:12288
    ds_read_b128 v[68:71], v2 offset:13312
    s_waitcnt lgkmcnt(2)
    v_mfma_f32_16x16x32_bf16 v[8:11], a[20:23], v[72:75], v[8:11]
    v_mfma_f32_16x16x32_bf16 v[36:39], a[20:23], v[76:79], v[36:39]
    v_mfma_f32_16x16x32_bf16 v[12:15], a[76:79], v[72:75], v[12:15]
    v_mfma_f32_16x16x32_bf16 v[40:43], a[76:79], v[76:79], v[40:43]
    v_mfma_f32_16x16x32_bf16 v[16:19], a[132:135], v[72:75], v[16:19]
    v_mfma_f32_16x16x32_bf16 v[44:47], a[132:135], v[76:79], v[44:47]
    v_mfma_f32_16x16x32_bf16 v[20:23], a[188:191], v[72:75], v[20:23]
    v_mfma_f32_16x16x32_bf16 v[48:51], a[188:191], v[76:79], v[48:51]
    v_mfma_f32_16x16x32_bf16 v[24:27], a[244:247], v[72:75], v[24:27]
    v_mfma_f32_16x16x32_bf16 v[52:55], a[244:247], v[76:79], v[52:55]
    v_mfma_f32_16x16x32_bf16 v[28:31], v[164:167], v[72:75], v[28:31]
    v_mfma_f32_16x16x32_bf16 v[56:59], v[164:167], v[76:79], v[56:59]
    v_mfma_f32_16x16x32_bf16 v[32:35], v[220:223], v[72:75], v[32:35]
    v_mfma_f32_16x16x32_bf16 v[60:63], v[220:223], v[76:79], v[60:63]
    ds_read_b128 v[72:75], v2 offset:14336
    ds_read_b128 v[76:79], v2 offset:15360
    s_waitcnt lgkmcnt(2)
    v_mfma_f32_16x16x32_bf16 v[8:11], a[24:27], v[64:67], v[8:11]
    v_mfma_f32_16x16x32_bf16 v[36:39], a[24:27], v[68:71], v[36:39]
    v_mfma_f32_16x16x32_bf16 v[12:15], a[80:83], v[64:67], v[12:15]
    v_mfma_f32_16x16x32_bf16 v[40:43], a[80:83], v[68:71], v[40:43]
    v_mfma_f32_16x16x32_bf16 v[16:19], a[136:139], v[64:67], v[16:19]
    v_mfma_f32_16x16x32_bf16 v[44:47], a[136:139], v[68:71], v[44:47]
    v_mfma_f32_16x16x32_bf16 v[20:23], a[192:195], v[64:67], v[20:23]
    v_mfma_f32_16x16x32_bf16 v[48:51], a[192:195], v[68:71], v[48:51]
    v_mfma_f32_16x16x32_bf16 v[24:27], a[248:251], v[64:67], v[24:27]
    v_mfma_f32_16x16x32_bf16 v[52:55], a[248:251], v[68:71], v[52:55]
    v_mfma_f32_16x16x32_bf16 v[28:31], v[168:171], v[64:67], v[28:31]
    v_mfma_f32_16x16x32_bf16 v[56:59], v[168:171], v[68:71], v[56:59]
    v_mfma_f32_16x16x32_bf16 v[32:35], v[224:227], v[64:67], v[32:35]
    v_mfma_f32_16x16x32_bf16 v[60:63], v[224:227], v[68:71], v[60:63]
    ds_read_b128 v[64:67], v2 offset:16384
    ds_read_b128 v[68:71], v2 offset:17408
    s_waitcnt lgkmcnt(2)
    v_mfma_f32_16x16x32_bf16 v[8:11], a[28:31], v[72:75], v[8:11]
    v_mfma_f32_16x16x32_bf16 v[36:39], a[28:31], v[76:79], v[36:39]
    v_mfma_f32_16x16x32_bf16 v[12:15], a[84:87], v[72:75], v[12:15]
    v_mfma_f32_16x16x32_bf16 v[40:43], a[84:87], v[76:79], v[40:43]
    v_mfma_f32_16x16x32_bf16 v[16:19], a[140:143], v[72:75], v[16:19]
    v_mfma_f32_16x16x32_bf16 v[44:47], a[140:143], v[76:79], v[44:47]
    v_mfma_f32_16x16x32_bf16 v[20:23], a[196:199], v[72:75], v[20:23]
    v_mfma_f32_16x16x32_bf16 v[48:51], a[196:199], v[76:79], v[48:51]
    v_mfma_f32_16x16x32_bf16 v[24:27], a[252:255], v[72:75], v[24:27]
    v_mfma_f32_16x16x32_bf16 v[52:55], a[252:255], v[76:79], v[52:55]
    v_mfma_f32_16x16x32_bf16 v[28:31], v[172:175], v[72:75], v[28:31]
    v_mfma_f32_16x16x32_bf16 v[56:59], v[172:175], v[76:79], v[56:59]
    v_mfma_f32_16x16x32_bf16 v[32:35], v[228:231], v[72:75], v[32:35]
    v_mfma_f32_16x16x32_bf16 v[60:63], v[228:231], v[76:79], v[60:63]
    ds_read_b128 v[72:75], v2 offset:18432
    ds_read_b128 v[76:79], v2 offset:19456
    s_waitcnt lgkmcnt(2)
    v_mfma_f32_16x16x32_bf16 v[8:11], a[32:35], v[64:67], v[8:11]
    v_mfma_f32_16x16x32_bf16 v[36:39], a[32:35], v[68:71], v[36:39]
    v_mfma_f32_16x16x32_bf16 v[12:15], a[88:91], v[64:67], v[12:15]
    v_mfma_f32_16x16x32_bf16 v[40:43], a[88:91], v[68:71], v[40:43]
    v_mfma_f32_16x16x32_bf16 v[16:19], a[144:147], v[64:67], v[16:19]
    v_mfma_f32_16x16x32_bf16 v[44:47], a[144:147], v[68:71], v[44:47]
    v_mfma_f32_16x16x32_bf16 v[20:23], a[200:203], v[64:67], v[20:23]
    v_mfma_f32_16x16x32_bf16 v[48:51], a[200:203], v[68:71], v[48:51]
    v_mfma_f32_16x16x32_bf16 v[24:27], v[120:123], v[64:67], v[24:27]
    v_mfma_f32_16x16x32_bf16 v[52:55], v[120:123], v[68:71], v[52:55]
    v_mfma_f32_16x16x32_bf16 v[28:31], v[176:179], v[64:67], v[28:31]
    v_mfma_f32_16x16x32_bf16 v[56:59], v[176:179], v[68:71], v[56:59]
    v_mfma_f32_16x16x32_bf16 v[32:35], v[232:235], v[64:67], v[32:35]
    v_mfma_f32_16x16x32_bf16 v[60:63], v[232:235], v[68:71], v[60:63]
    ds_read_b128 v[64:67], v2 offset:20480
    ds_read_b128 v[68:71], v2 offset:21504
    s_waitcnt lgkmcnt(2)
    v_mfma_f32_16x16x32_bf16 v[8:11], a[36:39], v[72:75], v[8:11]
    v_mfma_f32_16x16x32_bf16 v[36:39], a[36:39], v[76:79], v[36:39]
    v_mfma_f32_16x16x32_bf16 v[12:15], a[92:95], v[72:75], v[12:15]
    v_mfma_f32_16x16x32_bf16 v[40:43], a[92:95], v[76:79], v[40:43]
    v_mfma_f32_16x16x32_bf16 v[16:19], a[148:151], v[72:75], v[16:19]
    v_mfma_f32_16x16x32_bf16 v[44:47], a[148:151], v[76:79], v[44:47]
    v_mfma_f32_16x16x32_bf16 v[20:23], a[204:207], v[72:75], v[20:23]
    v_mfma_f32_16x16x32_bf16 v[48:51], a[204:207], v[76:79], v[48:51]
    v_mfma_f32_16x16x32_bf16 v[24:27], v[124:127], v[72:75], v[24:27]
    v_mfma_f32_16x16x32_bf16 v[52:55], v[124:127], v[76:79], v[52:55]
    v_mfma_f32_16x16x32_bf16 v[28:31], v[180:183], v[72:75], v[28:31]
    v_mfma_f32_16x16x32_bf16 v[56:59], v[180:183], v[76:79], v[56:59]
    v_mfma_f32_16x16x32_bf16 v[32:35], v[236:239], v[72:75], v[32:35]
    v_mfma_f32_16x16x32_bf16 v[60:63], v[236:239], v[76:79], v[60:63]
    ds_read_b128 v[72:75], v2 offset:22528
    ds_read_b128 v[76:79], v2 offset:23552
    s_waitcnt lgkmcnt(2)
    v_mfma_f32_16x16x32_bf16 v[8:11], a[40:43], v[64:67], v[8:11]
    v_mfma_f32_16x16x32_bf16 v[36:39], a[40:43], v[68:71], v[36:39]
    v_mfma_f32_16x16x32_bf16 v[12:15], a[96:99], v[64:67], v[12:15]
    v_mfma_f32_16x16x32_bf16 v[40:43], a[96:99], v[68:71], v[40:43]
    v_mfma_f32_16x16x32_bf16 v[16:19], a[152:155], v[64:67], v[16:19]
    v_mfma_f32_16x16x32_bf16 v[44:47], a[152:155], v[68:71], v[44:47]
    v_mfma_f32_16x16x32_bf16 v[20:23], a[208:211], v[64:67], v[20:23]
    v_mfma_f32_16x16x32_bf16 v[48:51], a[208:211], v[68:71], v[48:51]
    v_mfma_f32_16x16x32_bf16 v[24:27], v[128:131], v[64:67], v[24:27]
    v_mfma_f32_16x16x32_bf16 v[52:55], v[128:131], v[68:71], v[52:55]
    v_mfma_f32_16x16x32_bf16 v[28:31], v[184:187], v[64:67], v[28:31]
    v_mfma_f32_16x16x32_bf16 v[56:59], v[184:187], v[68:71], v[56:59]
    v_mfma_f32_16x16x32_bf16 v[32:35], v[240:243], v[64:67], v[32:35]
    v_mfma_f32_16x16x32_bf16 v[60:63], v[240:243], v[68:71], v[60:63]
    ds_read_b128 v[64:67], v2 offset:24576
    ds_read_b128 v[68:71], v2 offset:25600
    s_waitcnt lgkmcnt(2)
    v_mfma_f32_16x16x32_bf16 v[8:11], a[44:47], v[72:75], v[8:11]
    v_mfma_f32_16x16x32_bf16 v[36:39], a[44:47], v[76:79], v[36:39]
    v_mfma_f32_16x16x32_bf16 v[12:15], a[100:103], v[72:75], v[12:15]
    v_mfma_f32_16x16x32_bf16 v[40:43], a[100:103], v[76:79], v[40:43]
    v_mfma_f32_16x16x32_bf16 v[16:19], a[156:159], v[72:75], v[16:19]
    v_mfma_f32_16x16x32_bf16 v[44:47], a[156:159], v[76:79], v[44:47]
    v_mfma_f32_16x16x32_bf16 v[20:23], a[212:215], v[72:75], v[20:23]
    v_mfma_f32_16x16x32_bf16 v[48:51], a[212:215], v[76:79], v[48:51]
    v_mfma_f32_16x16x32_bf16 v[24:27], v[132:135], v[72:75], v[24:27]
    v_mfma_f32_16x16x32_bf16 v[52:55], v[132:135], v[76:79], v[52:55]
    v_mfma_f32_16x16x32_bf16 v[28:31], v[188:191], v[72:75], v[28:31]
    v_mfma_f32_16x16x32_bf16 v[56:59], v[188:191], v[76:79], v[56:59]
    v_mfma_f32_16x16x32_bf16 v[32:35], v[244:247], v[72:75], v[32:35]
    v_mfma_f32_16x16x32_bf16 v[60:63], v[244:247], v[76:79], v[60:63]
    ds_read_b128 v[72:75], v2 offset:26624
    ds_read_b128 v[76:79], v2 offset:27648
    s_waitcnt lgkmcnt(2)
    v_mfma_f32_16x16x32_bf16 v[8:11], a[48:51], v[64:67], v[8:11]
    v_mfma_f32_16x16x32_bf16 v[36:39], a[48:51], v[68:71], v[36:39]
    v_mfma_f32_16x16x32_bf16 v[12:15], a[104:107], v[64:67], v[12:15]
    v_mfma_f32_16x16x32_bf16 v[40:43], a[104:107], v[68:71], v[40:43]
    v_mfma_f32_16x16x32_bf16 v[16:19], a[160:163], v[64:67], v[16:19]
    v_mfma_f32_16x16x32_bf16 v[44:47], a[160:163], v[68:71], v[44:47]
    v_mfma_f32_16x16x32_bf16 v[20:23], a[216:219], v[64:67], v[20:23]
    v_mfma_f32_16x16x32_bf16 v[48:51], a[216:219], v[68:71], v[48:51]
    v_mfma_f32_16x16x32_bf16 v[24:27], v[136:139], v[64:67], v[24:27]
    v_mfma_f32_16x16x32_bf16 v[52:55], v[136:139], v[68:71], v[52:55]
    v_mfma_f32_16x16x32_bf16 v[28:31], v[192:195], v[64:67], v[28:31]
    v_mfma_f32_16x16x32_bf16 v[56:59], v[192:195], v[68:71], v[56:59]
    v_mfma_f32_16x16x32_bf16 v[32:35], v[248:251], v[64:67], v[32:35]
    v_mfma_f32_16x16x32_bf16 v[60:63], v[248:251], v[68:71], v[60:63]
    s_waitcnt lgkmcnt(0)
    v_mfma_f32_16x16x32_bf16 v[8:11], a[52:55], v[72:75], v[8:11]
    v_mfma_f32_16x16x32_bf16 v[36:39], a[52:55], v[76:79], v[36:39]
    v_mfma_f32_16x16x32_bf16 v[12:15], a[108:111], v[72:75], v[12:15]
    v_mfma_f32_16x16x32_bf16 v[40:43], a[108:111], v[76:79], v[40:43]
    v_mfma_f32_16x16x32_bf16 v[16:19], a[164:167], v[72:75], v[16:19]
    v_mfma_f32_16x16x32_bf16 v[44:47], a[164:167], v[76:79], v[44:47]
    v_mfma_f32_16x16x32_bf16 v[20:23], a[220:223], v[72:75], v[20:23]
    v_mfma_f32_16x16x32_bf16 v[48:51], a[220:223], v[76:79], v[48:51]
    v_mfma_f32_16x16x32_bf16 v[24:27], v[140:143], v[72:75], v[24:27]
    v_mfma_f32_16x16x32_bf16 v[52:55], v[140:143], v[76:79], v[52:55]
    v_mfma_f32_16x16x32_bf16 v[28:31], v[196:199], v[72:75], v[28:31]
    v_mfma_f32_16x16x32_bf16 v[56:59], v[196:199], v[76:79], v[56:59]
    v_mfma_f32_16x16x32_bf16 v[32:35], v[252:255], v[72:75], v[32:35]
    v_mfma_f32_16x16x32_bf16 v[60:63], v[252:255], v[76:79], v[60:63]
    v_cvt_pk_bf16_f32 v64, v8, v9
    v_cvt_pk_bf16_f32 v65, v12, v13
    v_cvt_pk_bf16_f32 v66, v10, v11
    v_cvt_pk_bf16_f32 v67, v14, v15
    v_cvt_pk_bf16_f32 v68, v16, v17
    v_cvt_pk_bf16_f32 v69, v20, v21
    v_cvt_pk_bf16_f32 v70, v18, v19
    v_cvt_pk_bf16_f32 v71, v22, v23
    v_cvt_pk_bf16_f32 v72, v24, v25
    v_cvt_pk_bf16_f32 v73, v28, v29
    v_cvt_pk_bf16_f32 v74, v26, v27
    v_cvt_pk_bf16_f32 v75, v30, v31
    v_cvt_pk_bf16_f32 v76, v32, v33
    v_cvt_pk_bf16_f32 v77, v34, v35
    v_cvt_pk_bf16_f32 v78, v36, v37
    v_cvt_pk_bf16_f32 v79, v40, v41
    v_cvt_pk_bf16_f32 v80, v38, v39
    v_cvt_pk_bf16_f32 v81, v42, v43
    v_cvt_pk_bf16_f32 v82, v44, v45
    v_cvt_pk_bf16_f32 v83, v48, v49
    v_cvt_pk_bf16_f32 v84, v46, v47
    v_cvt_pk_bf16_f32 v85, v50, v51
    v_cvt_pk_bf16_f32 v86, v52, v53
    v_cvt_pk_bf16_f32 v87, v56, v57
    v_cvt_pk_bf16_f32 v88, v54, v55
    v_cvt_pk_bf16_f32 v89, v58, v59
    v_cvt_pk_bf16_f32 v90, v60, v61
    v_cvt_pk_bf16_f32 v91, v62, v63
    s_mul_i32 s27, s40, 7168
    s_add_u32 s27, s27, 13762560
    s_add_u32 s30, s12, s27
    s_addc_u32 s31, s13, 0
    s_mov_b32 s44, 524288
    global_load_dwordx2 v[40:41], v118, s[30:31] sc1
    global_load_dwordx2 v[42:43], v118, s[30:31] offset:128 sc1
    global_load_dwordx2 v[44:45], v118, s[30:31] offset:8 sc1
    global_load_dwordx2 v[46:47], v118, s[30:31] offset:136 sc1
    global_load_dwordx2 v[48:49], v119, s[30:31] sc1
    global_load_dwordx2 v[50:51], v119, s[30:31] offset:128 sc1
    global_load_dwordx2 v[52:53], v117, s[30:31] sc1
    v_add_u32 v2, s42, v5
    v_add_u32 v3, s42, v7
    v_add_u32 v62, s42, v116
    ds_read_b128 v[8:11], v2 offset:0
    ds_read_b128 v[12:15], v2 offset:256
    ds_read_b128 v[16:19], v3 offset:0
    ds_read_b32 v20, v62 offset:0
    ds_read_b32 v21, v62 offset:8
    ds_read_b128 v[24:27], v2 offset:1024
    ds_read_b128 v[28:31], v2 offset:1280
    ds_read_b128 v[32:35], v3 offset:1024
    ds_read_b32 v36, v62 offset:1024
    ds_read_b32 v37, v62 offset:1032
    s_waitcnt lgkmcnt(5)
    v_mfma_f32_16x16x32_bf16 v[92:95], v[8:11], v[64:67], 0
    v_mfma_f32_16x16x32_bf16 v[104:107], v[8:11], v[78:81], 0
    v_mfma_f32_16x16x32_bf16 v[92:95], v[12:15], v[68:71], v[92:95]
    v_mfma_f32_16x16x32_bf16 v[104:107], v[12:15], v[82:85], v[104:107]
    v_mfma_f32_16x16x32_bf16 v[92:95], v[16:19], v[72:75], v[92:95]
    v_mfma_f32_16x16x32_bf16 v[104:107], v[16:19], v[86:89], v[104:107]
    v_mfma_f32_16x16x16_bf16 v[92:95], v[20:21], v[76:77], v[92:95]
    v_mfma_f32_16x16x16_bf16 v[104:107], v[20:21], v[90:91], v[104:107]
    s_waitcnt lgkmcnt(0)
    v_mfma_f32_16x16x32_bf16 v[96:99], v[24:27], v[64:67], 0
    v_mfma_f32_16x16x32_bf16 v[108:111], v[24:27], v[78:81], 0
    v_mfma_f32_16x16x32_bf16 v[96:99], v[28:31], v[68:71], v[96:99]
    v_mfma_f32_16x16x32_bf16 v[108:111], v[28:31], v[82:85], v[108:111]
    v_mfma_f32_16x16x32_bf16 v[96:99], v[32:35], v[72:75], v[96:99]
    v_mfma_f32_16x16x32_bf16 v[108:111], v[32:35], v[86:89], v[108:111]
    v_mfma_f32_16x16x16_bf16 v[96:99], v[36:37], v[76:77], v[96:99]
    v_mfma_f32_16x16x16_bf16 v[108:111], v[36:37], v[90:91], v[108:111]
HA_pm:
    s_waitcnt vmcnt(0)
    v_max3_u32 v2, v40, v41, v42
    v_max3_u32 v2, v2, v43, v44
    v_max3_u32 v2, v2, v45, v46
    v_max3_u32 v2, v2, v47, v48
    v_max3_u32 v2, v2, v49, v50
    v_max3_u32 v2, v2, v51, v52
    v_max_u32 v2, v2, v53
    v_cmp_eq_u32 vcc, -1, v2
    s_cbranch_vccz HA_pm_ok
    s_sleep 2
    s_cmp_ge_u32 s40, 63
    s_cbranch_scc1 HA_pm1
    s_sleep 16
HA_pm1:
    global_load_dwordx2 v[40:41], v118, s[30:31] sc1
    global_load_dwordx2 v[42:43], v118, s[30:31] offset:128 sc1
    global_load_dwordx2 v[44:45], v118, s[30:31] offset:8 sc1
    global_load_dwordx2 v[46:47], v118, s[30:31] offset:136 sc1
    global_load_dwordx2 v[48:49], v119, s[30:31] sc1
    global_load_dwordx2 v[50:51], v119, s[30:31] offset:128 sc1
    global_load_dwordx2 v[52:53], v117, s[30:31] sc1
    s_sub_u32 s44, s44, 1
    s_cbranch_scc1 BAIL_7
    s_branch HA_pm
HA_pm_ok:
    v_swap_b32 v41, v42
    v_swap_b32 v45, v46
    v_swap_b32 v49, v50
    v_mfma_f32_16x16x32_bf16 v[100:103], v[40:43], v[64:67], 0
    v_mfma_f32_16x16x32_bf16 v[112:115], v[40:43], v[78:81], 0
    v_mfma_f32_16x16x32_bf16 v[100:103], v[44:47], v[68:71], v[100:103]
    v_mfma_f32_16x16x32_bf16 v[112:115], v[44:47], v[82:85], v[112:115]
    v_mfma_f32_16x16x32_bf16 v[100:103], v[48:51], v[72:75], v[100:103]
    v_mfma_f32_16x16x32_bf16 v[112:115], v[48:51], v[86:89], v[112:115]
    v_mfma_f32_16x16x16_bf16 v[100:103], v[52:53], v[76:77], v[100:103]
    v_mfma_f32_16x16x16_bf16 v[112:115], v[52:53], v[90:91], v[112:115]
    ds_write_b128 v4, v[92:95] offset:0
    ds_write_b128 v4, v[96:99] offset:1024
    s_nop 3
    ds_write_b128 v4, v[100:103] offset:2048
    ds_write_b128 v4, v[104:107] offset:3072
    ds_write_b128 v4, v[108:111] offset:4096
    ds_write_b128 v4, v[112:115] offset:5120
    s_lshl_b32 s27, s40, 4
    s_add_u32 s27, s27, s26
    s_lshl_b32 s46, s27, 2
    s_add_u32 s46, s46, 4096
    s_lshl_b32 s27, s27, 1
    s_add_u32 s27, s27, s3
    s_mul_i32 s27, s27, 1536
    s_add_u32 s27, s27, 15368192
    s_add_u32 s32, s12, s27
    s_addc_u32 s33, s13, 0
    s_mul_i32 s27, s3, 3072
    s_add_u32 s27, s27, 65536
    v_add_u32 v2, s27, v1
    s_waitcnt lgkmcnt(0)
    s_barrier
    s_cmp_ge_u32 s3, 2
    s_cbranch_scc1 HA_sm_done
    ds_read_b128 v[8:11], v2 offset:0
    ds_read_b128 v[12:15], v2 offset:1024
    ds_read_b128 v[16:19], v2 offset:2048
    ds_read_b128 v[20:23], v2 offset:6144
    ds_read_b128 v[24:27], v2 offset:7168
    ds_read_b128 v[28:31], v2 offset:8192
    ds_read_b128 v[32:35], v2 offset:12288
    ds_read_b128 v[36:39], v2 offset:13312
    ds_read_b128 v[40:43], v2 offset:14336
    ds_read_b128 v[44:47], v2 offset:18432
    ds_read_b128 v[48:51], v2 offset:19456
    ds_read_b128 v[52:55], v2 offset:20480
    s_waitcnt lgkmcnt(6)
    v_pk_add_f32 v[8:9], v[8:9], v[20:21]
    v_pk_add_f32 v[10:11], v[10:11], v[22:23]
    v_pk_add_f32 v[12:13], v[12:13], v[24:25]
    v_pk_add_f32 v[14:15], v[14:15], v[26:27]
    v_pk_add_f32 v[16:17], v[16:17], v[28:29]
    v_pk_add_f32 v[18:19], v[18:19], v[30:31]
    s_waitcnt lgkmcnt(3)
    v_pk_add_f32 v[8:9], v[8:9], v[32:33]
    v_pk_add_f32 v[10:11], v[10:11], v[34:35]
    v_pk_add_f32 v[12:13], v[12:13], v[36:37]
    v_pk_add_f32 v[14:15], v[14:15], v[38:39]
    v_pk_add_f32 v[16:17], v[16:17], v[40:41]
    v_pk_add_f32 v[18:19], v[18:19], v[42:43]
    s_waitcnt lgkmcnt(0)
    v_pk_add_f32 v[8:9], v[8:9], v[44:45]
    v_pk_add_f32 v[10:11], v[10:11], v[46:47]
    v_pk_add_f32 v[12:13], v[12:13], v[48:49]
    v_pk_add_f32 v[14:15], v[14:15], v[50:51]
    v_pk_add_f32 v[16:17], v[16:17], v[52:53]
    v_pk_add_f32 v[18:19], v[18:19], v[54:55]
    v_mov_b32 v3, s45
    v_cmp_le_i32 vcc, 0, v0
    s_nop 1
    v_cndmask_b32 v8, v3, v8, vcc
    v_cmp_le_i32 vcc, 1, v0
    s_nop 1
    v_cndmask_b32 v9, v3, v9, vcc
    v_cmp_le_i32 vcc, 2, v0
    s_nop 1
    v_cndmask_b32 v10, v3, v10, vcc
    v_cmp_le_i32 vcc, 3, v0
    s_nop 1
    v_cndmask_b32 v11, v3, v11, vcc
    v_cmp_le_i32 vcc, 16, v0
    s_nop 1
    v_cndmask_b32 v12, v3, v12, vcc
    v_cmp_le_i32 vcc, 17, v0
    s_nop 1
    v_cndmask_b32 v13, v3, v13, vcc
    v_cmp_le_i32 vcc, 18, v0
    s_nop 1
    v_cndmask_b32 v14, v3, v14, vcc
    v_cmp_le_i32 vcc, 19, v0
    s_nop 1
    v_cndmask_b32 v15, v3, v15, vcc
    v_max3_f32 v2, v8, v9, v10
    v_max3_f32 v2, v2, v11, v12
    v_max3_f32 v2, v2, v13, v14
    v_max3_f32 v2, v2, v15, v16
    v_max3_f32 v2, v2, v17, v18
    v_max_f32 v2, v2, v19
    v_mov_b32 v3, v2
    s_nop 1
    v_permlane32_swap_b32 v2, v3
    v_max_f32 v2, v2, v3
    v_mov_b32 v3, v2
    s_nop 1
    v_permlane16_swap_b32 v2, v3
    v_max_f32 v2, v2, v3
    v_sub_f32 v8, v8, v2
    v_sub_f32 v9, v9, v2
    v_sub_f32 v10, v10, v2
    v_sub_f32 v11, v11, v2
    v_sub_f32 v12, v12, v2
    v_sub_f32 v13, v13, v2
    v_sub_f32 v14, v14, v2
    v_sub_f32 v15, v15, v2
    v_sub_f32 v16, v16, v2
    v_sub_f32 v17, v17, v2
    v_sub_f32 v18, v18, v2
    v_sub_f32 v19, v19, v2
    v_exp_f32 v8, v8
    v_exp_f32 v9, v9
    v_exp_f32 v10, v10
    v_exp_f32 v11, v11
    v_exp_f32 v12, v12
    v_exp_f32 v13, v13
    v_exp_f32 v14, v14
    v_exp_f32 v15, v15
    v_exp_f32 v16, v16
    v_exp_f32 v17, v17
    v_exp_f32 v18, v18
    v_exp_f32 v19, v19
    v_add_f32 v2, v16, v17
    v_add_f32 v3, v18, v19
    v_add_f32 v2, v2, v3
    v_mul_f32 v2, 0.5, v2
    v_add_f32 v2, v2, v8
    v_add_f32 v2, v2, v9
    v_add_f32 v2, v2, v10
    v_add_f32 v2, v2, v11
    v_add_f32 v2, v2, v12
    v_add_f32 v2, v2, v13
    v_add_f32 v2, v2, v14
    v_add_f32 v2, v2, v15
    v_mov_b32 v3, v2
    s_nop 1
    v_permlane32_swap_b32 v2, v3
    v_add_f32 v2, v2, v3
    v_mov_b32 v3, v2
    s_nop 1
    v_permlane16_swap_b32 v2, v3
    v_add_f32 v2, v2, v3
    v_rcp_f32 v2, v2
    s_nop 0
    v_mul_f32 v8, v8, v2
    v_mul_f32 v9, v9, v2
    v_mul_f32 v10, v10, v2
    v_mul_f32 v11, v11, v2
    v_mul_f32 v12, v12, v2
    v_mul_f32 v13, v13, v2
    v_mul_f32 v14, v14, v2
    v_mul_f32 v15, v15, v2
    v_mul_f32 v16, v16, v2
    v_mul_f32 v17, v17, v2
    v_mul_f32 v18, v18, v2
    v_mul_f32 v19, v19, v2
    v_cvt_pk_bf16_f32 v20, v8, v12
    v_cvt_pk_bf16_f32 v21, v9, v13
    v_cvt_pk_bf16_f32 v22, v10, v14
    v_cvt_pk_bf16_f32 v23, v11, v15
    v_cvt_pk_bf16_f32 v24, v16, v17
    v_cvt_pk_bf16_f32 v25, v18, v19
    v_lshrrev_b32 v3, 1, v1
    global_store_dwordx4 v1, v[20:23], s[32:33] sc1
    global_store_dwordx2 v3, v[24:25], s[32:33] offset:1024 sc1
HA_sm_done:
    s_waitcnt vmcnt(0)
    s_barrier
    s_cmp_lg_u32 s3, 0
    s_cbranch_scc1 SF_11
    s_mov_b64 exec, 1
    v_mov_b32 v2, 1
    v_mov_b32 v3, s46
    global_store_dword v3, v2, s[18:19] sc1
    s_mov_b64 exec, -1
SF_11:
    s_mov_b32 s40, s41
    s_mov_b32 s42, s43
    s_cmp_lt_u32 s40, 64
    s_cbranch_scc1 HA_job
    s_endpgm
ROLE_FFT:
    v_and_b32 v4, 15, v0
    v_lshrrev_b32 v5, 4, v0
    v_cvt_f32_u32 v6, v4
    v_cvt_f32_u32 v7, v5
P1_loop:
    s_cmp_lg_u32 s3, 0
    s_cbranch_scc1 BC_12
    s_mov_b64 exec, 1
    v_mov_b32 v3, 15360
    v_mov_b32 v2, 1
    global_atomic_add v2, v3, v2, s[18:19] sc0 sc1
    s_waitcnt vmcnt(0)
    v_mov_b32 v3, 163588
    ds_write_b32 v3, v2
    s_mov_b64 exec, -1
    s_waitcnt lgkmcnt(0)
BC_12:
    s_barrier
    v_mov_b32 v3, 163588
    ds_read_b32 v2, v3
    s_waitcnt lgkmcnt(0)
    v_readfirstlane_b32 s26, v2
    s_cmp_ge_u32 s26, 96
    s_cbranch_scc1 P2_start
    s_cmp_ge_u32 s26, 64
    s_cbranch_scc1 P1_wt
    s_and_b32 s27, s26, 1
    s_lshl_b32 s27, s27, 2
    s_add_u32 s27, s27, s3
    s_lshr_b32 s28, s26, 1
    v_mul_u32_u24 v8, 57344, v4
    v_lshl_add_u32 v8, v5, 4, v8
    s_mul_i32 s29, s28, 1792
    v_add_u32 v8, s29, v8
    v_add_u32 v9, 0, v8
    global_load_dwordx4 v[32:35], v9, s[4:5] offset:0
    global_load_dwordx4 v[36:39], v9, s[4:5] offset:64
    global_load_dwordx4 v[40:43], v9, s[4:5] offset:128
    global_load_dwordx4 v[44:47], v9, s[4:5] offset:192
    global_load_dwordx4 v[48:51], v9, s[4:5] offset:256
    global_load_dwordx4 v[52:55], v9, s[4:5] offset:320
    global_load_dwordx4 v[56:59], v9, s[4:5] offset:384
    global_load_dwordx4 v[60:63], v9, s[4:5] offset:448
    global_load_dwordx4 v[64:67], v9, s[4:5] offset:512
    global_load_dwordx4 v[68:71], v9, s[4:5] offset:576
    global_load_dwordx4 v[72:75], v9, s[4:5] offset:640
    global_load_dwordx4 v[76:79], v9, s[4:5] offset:704
    global_load_dwordx4 v[80:83], v9, s[4:5] offset:768
    global_load_dwordx4 v[84:87], v9, s[4:5] offset:832
    v_add_u32 v9, 917504, v8
    global_load_dwordx4 v[88:91], v9, s[4:5] offset:0
    global_load_dwordx4 v[92:95], v9, s[4:5] offset:64
    global_load_dwordx4 v[96:99], v9, s[4:5] offset:128
    global_load_dwordx4 v[100:103], v9, s[4:5] offset:192
    global_load_dwordx4 v[104:107], v9, s[4:5] offset:256
    global_load_dwordx4 v[108:111], v9, s[4:5] offset:320
    global_load_dwordx4 v[112:115], v9, s[4:5] offset:384
    global_load_dwordx4 v[116:119], v9, s[4:5] offset:448
    global_load_dwordx4 v[120:123], v9, s[4:5] offset:512
    global_load_dwordx4 v[124:127], v9, s[4:5] offset:576
    global_load_dwordx4 v[128:131], v9, s[4:5] offset:640
    global_load_dwordx4 v[132:135], v9, s[4:5] offset:704
    global_load_dwordx4 v[136:139], v9, s[4:5] offset:768
    global_load_dwordx4 v[140:143], v9, s[4:5] offset:832
    v_add_u32 v9, 896, v8
    global_load_dwordx4 v[144:147], v9, s[4:5] offset:0
    global_load_dwordx4 v[148:151], v9, s[4:5] offset:64
    global_load_dwordx4 v[152:155], v9, s[4:5] offset:128
    global_load_dwordx4 v[156:159], v9, s[4:5] offset:192
    global_load_dwordx4 v[160:163], v9, s[4:5] offset:256
    global_load_dwordx4 v[164:167], v9, s[4:5] offset:320
    global_load_dwordx4 v[168:171], v9, s[4:5] offset:384
    global_load_dwordx4 v[172:175], v9, s[4:5] offset:448
    global_load_dwordx4 v[176:179], v9, s[4:5] offset:512
    global_load_dwordx4 v[180:183], v9, s[4:5] offset:576
    global_load_dwordx4 v[184:187], v9, s[4:5] offset:640
    global_load_dwordx4 v[188:191], v9, s[4:5] offset:704
    global_load_dwordx4 v[192:195], v9, s[4:5] offset:768
    global_load_dwordx4 v[196:199], v9, s[4:5] offset:832
    v_add_u32 v9, 918400, v8
    global_load_dwordx4 v[200:203], v9, s[4:5] offset:0
    global_load_dwordx4 v[204:207], v9, s[4:5] offset:64
    global_load_dwordx4 v[208:211], v9, s[4:5] offset:128
    global_load_dwordx4 v[212:215], v9, s[4:5] offset:192
    global_load_dwordx4 v[216:219], v9, s[4:5] offset:256
    global_load_dwordx4 v[220:223], v9, s[4:5] offset:320
    global_load_dwordx4 v[224:227], v9, s[4:5] offset:384
    global_load_dwordx4 v[228:231], v9, s[4:5] offset:448
    global_load_dwordx4 v[232:235], v9, s[4:5] offset:512
    global_load_dwordx4 v[236:239], v9, s[4:5] offset:576
    global_load_dwordx4 v[240:243], v9, s[4:5] offset:640
    global_load_dwordx4 v[244:247], v9, s[4:5] offset:704
    global_load_dwordx4 v[248:251], v9, s[4:5] offset:768
    global_load_dwordx4 v[252:255], v9, s[4:5] offset:832
    s_lshl_b32 s29, s27, 5
    s_add_u32 s29, s29, 0
    v_add_u32 v8, s29, v4
    v_cvt_f32_u32 v8, v8
    v_mul_f32 v8, 0x3b124925, v8
    v_mul_f32 v9, 0x41000000, v7
    v_mul_f32 v9, v9, v8
    v_fmamk_f32 v10, v8, 0x0, v9
    v_fmamk_f32 v11, v8, 0x3f800000, v9
    v_cos_f32 v12, v10
    v_cos_f32 v13, v11
    v_sin_f32 v14, v10
    v_sin_f32 v15, v11
    v_cvt_pk_bf16_f32 v12, v12, v13
    v_cvt_pk_bf16_f32 v14, -v14, -v15
    v_accvgpr_write_b32 a0, v12
    v_accvgpr_write_b32 a56, v14
    v_fmamk_f32 v10, v8, 0x40000000, v9
    v_fmamk_f32 v11, v8, 0x40400000, v9
    v_cos_f32 v12, v10
    v_cos_f32 v13, v11
    v_sin_f32 v14, v10
    v_sin_f32 v15, v11
    v_cvt_pk_bf16_f32 v12, v12, v13
    v_cvt_pk_bf16_f32 v14, -v14, -v15
    v_accvgpr_write_b32 a1, v12
    v_accvgpr_write_b32 a57, v14
    v_fmamk_f32 v10, v8, 0x40800000, v9
    v_fmamk_f32 v11, v8, 0x40a00000, v9
    v_cos_f32 v12, v10
    v_cos_f32 v13, v11
    v_sin_f32 v14, v10
    v_sin_f32 v15, v11
    v_cvt_pk_bf16_f32 v12, v12, v13
    v_cvt_pk_bf16_f32 v14, -v14, -v15
    v_accvgpr_write_b32 a2, v12
    v_accvgpr_write_b32 a58, v14
    v_fmamk_f32 v10, v8, 0x40c00000, v9
    v_fmamk_f32 v11, v8, 0x40e00000, v9
    v_cos_f32 v12, v10
    v_cos_f32 v13, v11
    v_sin_f32 v14, v10
    v_sin_f32 v15, v11
    v_cvt_pk_bf16_f32 v12, v12, v13
    v_cvt_pk_bf16_f32 v14, -v14, -v15
    v_accvgpr_write_b32 a3, v12
    v_accvgpr_write_b32 a59, v14
    v_fmamk_f32 v10, v8, 0x42000000, v9
    v_fmamk_f32 v11, v8, 0x42040000, v9
    v_cos_f32 v12, v10
    v_cos_f32 v13, v11
    v_sin_f32 v14, v10
    v_sin_f32 v15, v11
    v_cvt_pk_bf16_f32 v12, v12, v13
    v_cvt_pk_bf16_f32 v14, -v14, -v15
    v_accvgpr_write_b32 a4, v12
    v_accvgpr_write_b32 a60, v14
    v_fmamk_f32 v10, v8, 0x42080000, v9
    v_fmamk_f32 v11, v8, 0x420c0000, v9
    v_cos_f32 v12, v10
    v_cos_f32 v13, v11
    v_sin_f32 v14, v10
    v_sin_f32 v15, v11
    v_cvt_pk_bf16_f32 v12, v12, v13
    v_cvt_pk_bf16_f32 v14, -v14, -v15
    v_accvgpr_write_b32 a5, v12
    v_accvgpr_write_b32 a61, v14
    v_fmamk_f32 v10, v8, 0x42100000, v9
    v_fmamk_f32 v11, v8, 0x42140000, v9
    v_cos_f32 v12, v10
    v_cos_f32 v13, v11
    v_sin_f32 v14, v10
    v_sin_f32 v15, v11
    v_cvt_pk_bf16_f32 v12, v12, v13
    v_cvt_pk_bf16_f32 v14, -v14, -v15
    v_accvgpr_write_b32 a6, v12
    v_accvgpr_write_b32 a62, v14
    v_fmamk_f32 v10, v8, 0x42180000, v9
    v_fmamk_f32 v11, v8, 0x421c0000, v9
    v_cos_f32 v12, v10
    v_cos_f32 v13, v11
    v_sin_f32 v14, v10
    v_sin_f32 v15, v11
    v_cvt_pk_bf16_f32 v12, v12, v13
    v_cvt_pk_bf16_f32 v14, -v14, -v15
    v_accvgpr_write_b32 a7, v12
    v_accvgpr_write_b32 a63, v14
    v_fmamk_f32 v10, v8, 0x42800000, v9
    v_fmamk_f32 v11, v8, 0x42820000, v9
    v_cos_f32 v12, v10
    v_cos_f32 v13, v11
    v_sin_f32 v14, v10
    v_sin_f32 v15, v11
    v_cvt_pk_bf16_f32 v12, v12, v13
    v_cvt_pk_bf16_f32 v14, -v14, -v15
    v_accvgpr_write_b32 a8, v12
    v_accvgpr_write_b32 a64, v14
    v_fmamk_f32 v10, v8, 0x42840000, v9
    v_fmamk_f32 v11, v8, 0x42860000, v9
    v_cos_f32 v12, v10
    v_cos_f32 v13, v11
    v_sin_f32 v14, v10
    v_sin_f32 v15, v11
    v_cvt_pk_bf16_f32 v12, v12, v13
    v_cvt_pk_bf16_f32 v14, -v14, -v15
    v_accvgpr_write_b32 a9, v12
    v_accvgpr_write_b32 a65, v14
    v_fmamk_f32 v10, v8, 0x42880000, v9
    v_fmamk_f32 v11, v8, 0x428a0000, v9
    v_cos_f32 v12, v10
    v_cos_f32 v13, v11
    v_sin_f32 v14, v10
    v_sin_f32 v15, v11
    v_cvt_pk_bf16_f32 v12, v12, v13
    v_cvt_pk_bf16_f32 v14, -v14, -v15
    v_accvgpr_write_b32 a10, v12
    v_accvgpr_write_b32 a66, v14
    v_fmamk_f32 v10, v8, 0x428c0000, v9
    v_fmamk_f32 v11, v8, 0x428e0000, v9
    v_cos_f32 v12, v10
    v_cos_f32 v13, v11
    v_sin_f32 v14, v10
    v_sin_f32 v15, v11
    v_cvt_pk_bf16_f32 v12, v12, v13
    v_cvt_pk_bf16_f32 v14, -v14, -v15
    v_accvgpr_write_b32 a11, v12
    v_accvgpr_write_b32 a67, v14
    v_fmamk_f32 v10, v8, 0x42c00000, v9
    v_fmamk_f32 v11, v8, 0x42c20000, v9
    v_cos_f32 v12, v10
    v_cos_f32 v13, v11
    v_sin_f32 v14, v10
    v_sin_f32 v15, v11
    v_cvt_pk_bf16_f32 v12, v12, v13
    v_cvt_pk_bf16_f32 v14, -v14, -v15
    v_accvgpr_write_b32 a12, v12
    v_accvgpr_write_b32 a68, v14
    v_fmamk_f32 v10, v8, 0x42c40000, v9
    v_fmamk_f32 v11, v8, 0x42c60000, v9
    v_cos_f32 v12, v10
    v_cos_f32 v13, v11
    v_sin_f32 v14, v10
    v_sin_f32 v15, v11
    v_cvt_pk_bf16_f32 v12, v12, v13
    v_cvt_pk_bf16_f32 v14, -v14, -v15
    v_accvgpr_write_b32 a13, v12
    v_accvgpr_write_b32 a69, v14
    v_fmamk_f32 v10, v8, 0x42c80000, v9
    v_fmamk_f32 v11, v8, 0x42ca0000, v9
    v_cos_f32 v12, v10
    v_cos_f32 v13, v11
    v_sin_f32 v14, v10
    v_sin_f32 v15, v11
    v_cvt_pk_bf16_f32 v12, v12, v13
    v_cvt_pk_bf16_f32 v14, -v14, -v15
    v_accvgpr_write_b32 a14, v12
    v_accvgpr_write_b32 a70, v14
    v_fmamk_f32 v10, v8, 0x42cc0000, v9
    v_fmamk_f32 v11, v8, 0x42ce0000, v9
    v_cos_f32 v12, v10
    v_cos_f32 v13, v11
    v_sin_f32 v14, v10
    v_sin_f32 v15, v11
    v_cvt_pk_bf16_f32 v12, v12, v13
    v_cvt_pk_bf16_f32 v14, -v14, -v15
    v_accvgpr_write_b32 a15, v12
    v_accvgpr_write_b32 a71, v14
    v_fmamk_f32 v10, v8, 0x43000000, v9
    v_fmamk_f32 v11, v8, 0x43010000, v9
    v_cos_f32 v12, v10
    v_cos_f32 v13, v11
    v_sin_f32 v14, v10
    v_sin_f32 v15, v11
    v_cvt_pk_bf16_f32 v12, v12, v13
    v_cvt_pk_bf16_f32 v14, -v14, -v15
    v_accvgpr_write_b32 a16, v12
    v_accvgpr_write_b32 a72, v14
    v_fmamk_f32 v10, v8, 0x43020000, v9
    v_fmamk_f32 v11, v8, 0x43030000, v9
    v_cos_f32 v12, v10
    v_cos_f32 v13, v11
    v_sin_f32 v14, v10
    v_sin_f32 v15, v11
    v_cvt_pk_bf16_f32 v12, v12, v13
    v_cvt_pk_bf16_f32 v14, -v14, -v15
    v_accvgpr_write_b32 a17, v12
    v_accvgpr_write_b32 a73, v14
    v_fmamk_f32 v10, v8, 0x43040000, v9
    v_fmamk_f32 v11, v8, 0x43050000, v9
    v_cos_f32 v12, v10
    v_cos_f32 v13, v11
    v_sin_f32 v14, v10
    v_sin_f32 v15, v11
    v_cvt_pk_bf16_f32 v12, v12, v13
    v_cvt_pk_bf16_f32 v14, -v14, -v15
    v_accvgpr_write_b32 a18, v12
    v_accvgpr_write_b32 a74, v14
    v_fmamk_f32 v10, v8, 0x43060000, v9
    v_fmamk_f32 v11, v8, 0x43070000, v9
    v_cos_f32 v12, v10
    v_cos_f32 v13, v11
    v_sin_f32 v14, v10
    v_sin_f32 v15, v11
    v_cvt_pk_bf16_f32 v12, v12, v13
    v_cvt_pk_bf16_f32 v14, -v14, -v15
    v_accvgpr_write_b32 a19, v12
    v_accvgpr_write_b32 a75, v14
    v_fmamk_f32 v10, v8, 0x43200000, v9
    v_fmamk_f32 v11, v8, 0x43210000, v9
    v_cos_f32 v12, v10
    v_cos_f32 v13, v11
    v_sin_f32 v14, v10
    v_sin_f32 v15, v11
    v_cvt_pk_bf16_f32 v12, v12, v13
    v_cvt_pk_bf16_f32 v14, -v14, -v15
    v_accvgpr_write_b32 a20, v12
    v_accvgpr_write_b32 a76, v14
    v_fmamk_f32 v10, v8, 0x43220000, v9
    v_fmamk_f32 v11, v8, 0x43230000, v9
    v_cos_f32 v12, v10
    v_cos_f32 v13, v11
    v_sin_f32 v14, v10
    v_sin_f32 v15, v11
    v_cvt_pk_bf16_f32 v12, v12, v13
    v_cvt_pk_bf16_f32 v14, -v14, -v15
    v_accvgpr_write_b32 a21, v12
    v_accvgpr_write_b32 a77, v14
    v_fmamk_f32 v10, v8, 0x43240000, v9
    v_fmamk_f32 v11, v8, 0x43250000, v9
    v_cos_f32 v12, v10
    v_cos_f32 v13, v11
    v_sin_f32 v14, v10
    v_sin_f32 v15, v11
    v_cvt_pk_bf16_f32 v12, v12, v13
    v_cvt_pk_bf16_f32 v14, -v14, -v15
    v_accvgpr_write_b32 a22, v12
    v_accvgpr_write_b32 a78, v14
    v_fmamk_f32 v10, v8, 0x43260000, v9
    v_fmamk_f32 v11, v8, 0x43270000, v9
    v_cos_f32 v12, v10
    v_cos_f32 v13, v11
    v_sin_f32 v14, v10
    v_sin_f32 v15, v11
    v_cvt_pk_bf16_f32 v12, v12, v13
    v_cvt_pk_bf16_f32 v14, -v14, -v15
    v_accvgpr_write_b32 a23, v12
    v_accvgpr_write_b32 a79, v14
    v_fmamk_f32 v10, v8, 0x43400000, v9
    v_fmamk_f32 v11, v8, 0x43410000, v9
    v_cos_f32 v12, v10
    v_cos_f32 v13, v11
    v_sin_f32 v14, v10
    v_sin_f32 v15, v11
    v_cvt_pk_bf16_f32 v12, v12, v13
    v_cvt_pk_bf16_f32 v14, -v14, -v15
    v_accvgpr_write_b32 a24, v12
    v_accvgpr_write_b32 a80, v14
    v_fmamk_f32 v10, v8, 0x43420000, v9
    v_fmamk_f32 v11, v8, 0x43430000, v9
    v_cos_f32 v12, v10
    v_cos_f32 v13, v11
    v_sin_f32 v14, v10
    v_sin_f32 v15, v11
    v_cvt_pk_bf16_f32 v12, v12, v13
    v_cvt_pk_bf16_f32 v14, -v14, -v15
    v_accvgpr_write_b32 a25, v12
    v_accvgpr_write_b32 a81, v14
    v_fmamk_f32 v10, v8, 0x43440000, v9
    v_fmamk_f32 v11, v8, 0x43450000, v9
    v_cos_f32 v12, v10
    v_cos_f32 v13, v11
    v_sin_f32 v14, v10
    v_sin_f32 v15, v11
    v_cvt_pk_bf16_f32 v12, v12, v13
    v_cvt_pk_bf16_f32 v14, -v14, -v15
    v_accvgpr_write_b32 a26, v12
    v_accvgpr_write_b32 a82, v14
    v_fmamk_f32 v10, v8, 0x43460000, v9
    v_fmamk_f32 v11, v8, 0x43470000, v9
    v_cos_f32 v12, v10
    v_cos_f32 v13, v11
    v_sin_f32 v14, v10
    v_sin_f32 v15, v11
    v_cvt_pk_bf16_f32 v12, v12, v13
    v_cvt_pk_bf16_f32 v14, -v14, -v15
    v_accvgpr_write_b32 a27, v12
    v_accvgpr_write_b32 a83, v14
    v_fmamk_f32 v10, v8, 0x43600000, v9
    v_fmamk_f32 v11, v8, 0x43610000, v9
    v_cos_f32 v12, v10
    v_cos_f32 v13, v11
    v_sin_f32 v14, v10
    v_sin_f32 v15, v11
    v_cvt_pk_bf16_f32 v12, v12, v13
    v_cvt_pk_bf16_f32 v14, -v14, -v15
    v_accvgpr_write_b32 a28, v12
    v_accvgpr_write_b32 a84, v14
    v_fmamk_f32 v10, v8, 0x43620000, v9
    v_fmamk_f32 v11, v8, 0x43630000, v9
    v_cos_f32 v12, v10
    v_cos_f32 v13, v11
    v_sin_f32 v14, v10
    v_sin_f32 v15, v11
    v_cvt_pk_bf16_f32 v12, v12, v13
    v_cvt_pk_bf16_f32 v14, -v14, -v15
    v_accvgpr_write_b32 a29, v12
    v_accvgpr_write_b32 a85, v14
    v_fmamk_f32 v10, v8, 0x43640000, v9
    v_fmamk_f32 v11, v8, 0x43650000, v9
    v_cos_f32 v12, v10
    v_cos_f32 v13, v11
    v_sin_f32 v14, v10
    v_sin_f32 v15, v11
    v_cvt_pk_bf16_f32 v12, v12, v13
    v_cvt_pk_bf16_f32 v14, -v14, -v15
    v_accvgpr_write_b32 a30, v12
    v_accvgpr_write_b32 a86, v14
    v_fmamk_f32 v10, v8, 0x43660000, v9
    v_fmamk_f32 v11, v8, 0x43670000, v9
    v_cos_f32 v12, v10
    v_cos_f32 v13, v11
    v_sin_f32 v14, v10
    v_sin_f32 v15, v11
    v_cvt_pk_bf16_f32 v12, v12, v13
    v_cvt_pk_bf16_f32 v14, -v14, -v15
    v_accvgpr_write_b32 a31, v12
    v_accvgpr_write_b32 a87, v14
    v_fmamk_f32 v10, v8, 0x43800000, v9
    v_fmamk_f32 v11, v8, 0x43808000, v9
    v_cos_f32 v12, v10
    v_cos_f32 v13, v11
    v_sin_f32 v14, v10
    v_sin_f32 v15, v11
    v_cvt_pk_bf16_f32 v12, v12, v13
    v_cvt_pk_bf16_f32 v14, -v14, -v15
    v_accvgpr_write_b32 a32, v12
    v_accvgpr_write_b32 a88, v14
    v_fmamk_f32 v10, v8, 0x43810000, v9
    v_fmamk_f32 v11, v8, 0x43818000, v9
    v_cos_f32 v12, v10
    v_cos_f32 v13, v11
    v_sin_f32 v14, v10
    v_sin_f32 v15, v11
    v_cvt_pk_bf16_f32 v12, v12, v13
    v_cvt_pk_bf16_f32 v14, -v14, -v15
    v_accvgpr_write_b32 a33, v12
    v_accvgpr_write_b32 a89, v14
    v_fmamk_f32 v10, v8, 0x43820000, v9
    v_fmamk_f32 v11, v8, 0x43828000, v9
    v_cos_f32 v12, v10
    v_cos_f32 v13, v11
    v_sin_f32 v14, v10
    v_sin_f32 v15, v11
    v_cvt_pk_bf16_f32 v12, v12, v13
    v_cvt_pk_bf16_f32 v14, -v14, -v15
    v_accvgpr_write_b32 a34, v12
    v_accvgpr_write_b32 a90, v14
    v_fmamk_f32 v10, v8, 0x43830000, v9
    v_fmamk_f32 v11, v8, 0x43838000, v9
    v_cos_f32 v12, v10
    v_cos_f32 v13, v11
    v_sin_f32 v14, v10
    v_sin_f32 v15, v11
    v_cvt_pk_bf16_f32 v12, v12, v13
    v_cvt_pk_bf16_f32 v14, -v14, -v15
    v_accvgpr_write_b32 a35, v12
    v_accvgpr_write_b32 a91, v14
    v_fmamk_f32 v10, v8, 0x43900000, v9
    v_fmamk_f32 v11, v8, 0x43908000, v9
    v_cos_f32 v12, v10
    v_cos_f32 v13, v11
    v_sin_f32 v14, v10
    v_sin_f32 v15, v11
    v_cvt_pk_bf16_f32 v12, v12, v13
    v_cvt_pk_bf16_f32 v14, -v14, -v15
    v_accvgpr_write_b32 a36, v12
    v_accvgpr_write_b32 a92, v14
    v_fmamk_f32 v10, v8, 0x43910000, v9
    v_fmamk_f32 v11, v8, 0x43918000, v9
    v_cos_f32 v12, v10
    v_cos_f32 v13, v11
    v_sin_f32 v14, v10
    v_sin_f32 v15, v11
    v_cvt_pk_bf16_f32 v12, v12, v13
    v_cvt_pk_bf16_f32 v14, -v14, -v15
    v_accvgpr_write_b32 a37, v12
    v_accvgpr_write_b32 a93, v14
    v_fmamk_f32 v10, v8, 0x43920000, v9
    v_fmamk_f32 v11, v8, 0x43928000, v9
    v_cos_f32 v12, v10
    v_cos_f32 v13, v11
    v_sin_f32 v14, v10
    v_sin_f32 v15, v11
    v_cvt_pk_bf16_f32 v12, v12, v13
    v_cvt_pk_bf16_f32 v14, -v14, -v15
    v_accvgpr_write_b32 a38, v12
    v_accvgpr_write_b32 a94, v14
    v_fmamk_f32 v10, v8, 0x43930000, v9
    v_fmamk_f32 v11, v8, 0x43938000, v9
    v_cos_f32 v12, v10
    v_cos_f32 v13, v11
    v_sin_f32 v14, v10
    v_sin_f32 v15, v11
    v_cvt_pk_bf16_f32 v12, v12, v13
    v_cvt_pk_bf16_f32 v14, -v14, -v15
    v_accvgpr_write_b32 a39, v12
    v_accvgpr_write_b32 a95, v14
    v_fmamk_f32 v10, v8, 0x43a00000, v9
    v_fmamk_f32 v11, v8, 0x43a08000, v9
    v_cos_f32 v12, v10
    v_cos_f32 v13, v11
    v_sin_f32 v14, v10
    v_sin_f32 v15, v11
    v_cvt_pk_bf16_f32 v12, v12, v13
    v_cvt_pk_bf16_f32 v14, -v14, -v15
    v_accvgpr_write_b32 a40, v12
    v_accvgpr_write_b32 a96, v14
    v_fmamk_f32 v10, v8, 0x43a10000, v9
    v_fmamk_f32 v11, v8, 0x43a18000, v9
    v_cos_f32 v12, v10
    v_cos_f32 v13, v11
    v_sin_f32 v14, v10
    v_sin_f32 v15, v11
    v_cvt_pk_bf16_f32 v12, v12, v13
    v_cvt_pk_bf16_f32 v14, -v14, -v15
    v_accvgpr_write_b32 a41, v12
    v_accvgpr_write_b32 a97, v14
    v_fmamk_f32 v10, v8, 0x43a20000, v9
    v_fmamk_f32 v11, v8, 0x43a28000, v9
    v_cos_f32 v12, v10
    v_cos_f32 v13, v11
    v_sin_f32 v14, v10
    v_sin_f32 v15, v11
    v_cvt_pk_bf16_f32 v12, v12, v13
    v_cvt_pk_bf16_f32 v14, -v14, -v15
    v_accvgpr_write_b32 a42, v12
    v_accvgpr_write_b32 a98, v14
    v_fmamk_f32 v10, v8, 0x43a30000, v9
    v_fmamk_f32 v11, v8, 0x43a38000, v9
    v_cos_f32 v12, v10
    v_cos_f32 v13, v11
    v_sin_f32 v14, v10
    v_sin_f32 v15, v11
    v_cvt_pk_bf16_f32 v12, v12, v13
    v_cvt_pk_bf16_f32 v14, -v14, -v15
    v_accvgpr_write_b32 a43, v12
    v_accvgpr_write_b32 a99, v14
    v_fmamk_f32 v10, v8, 0x43b00000, v9
    v_fmamk_f32 v11, v8, 0x43b08000, v9
    v_cos_f32 v12, v10
    v_cos_f32 v13, v11
    v_sin_f32 v14, v10
    v_sin_f32 v15, v11
    v_cvt_pk_bf16_f32 v12, v12, v13
    v_cvt_pk_bf16_f32 v14, -v14, -v15
    v_accvgpr_write_b32 a44, v12
    v_accvgpr_write_b32 a100, v14
    v_fmamk_f32 v10, v8, 0x43b10000, v9
    v_fmamk_f32 v11, v8, 0x43b18000, v9
    v_cos_f32 v12, v10
    v_cos_f32 v13, v11
    v_sin_f32 v14, v10
    v_sin_f32 v15, v11
    v_cvt_pk_bf16_f32 v12, v12, v13
    v_cvt_pk_bf16_f32 v14, -v14, -v15
    v_accvgpr_write_b32 a45, v12
    v_accvgpr_write_b32 a101, v14
    v_fmamk_f32 v10, v8, 0x43b20000, v9
    v_fmamk_f32 v11, v8, 0x43b28000, v9
    v_cos_f32 v12, v10
    v_cos_f32 v13, v11
    v_sin_f32 v14, v10
    v_sin_f32 v15, v11
    v_cvt_pk_bf16_f32 v12, v12, v13
    v_cvt_pk_bf16_f32 v14, -v14, -v15
    v_accvgpr_write_b32 a46, v12
    v_accvgpr_write_b32 a102, v14
    v_fmamk_f32 v10, v8, 0x43b30000, v9
    v_fmamk_f32 v11, v8, 0x43b38000, v9
    v_cos_f32 v12, v10
    v_cos_f32 v13, v11
    v_sin_f32 v14, v10
    v_sin_f32 v15, v11
    v_cvt_pk_bf16_f32 v12, v12, v13
    v_cvt_pk_bf16_f32 v14, -v14, -v15
    v_accvgpr_write_b32 a47, v12
    v_accvgpr_write_b32 a103, v14
    v_fmamk_f32 v10, v8, 0x43c00000, v9
    v_fmamk_f32 v11, v8, 0x43c08000, v9
    v_cos_f32 v12, v10
    v_cos_f32 v13, v11
    v_sin_f32 v14, v10
    v_sin_f32 v15, v11
    v_cvt_pk_bf16_f32 v12, v12, v13
    v_cvt_pk_bf16_f32 v14, -v14, -v15
    v_accvgpr_write_b32 a48, v12
    v_accvgpr_write_b32 a104, v14
    v_fmamk_f32 v10, v8, 0x43c10000, v9
    v_fmamk_f32 v11, v8, 0x43c18000, v9
    v_cos_f32 v12, v10
    v_cos_f32 v13, v11
    v_sin_f32 v14, v10
    v_sin_f32 v15, v11
    v_cvt_pk_bf16_f32 v12, v12, v13
    v_cvt_pk_bf16_f32 v14, -v14, -v15
    v_accvgpr_write_b32 a49, v12
    v_accvgpr_write_b32 a105, v14
    v_fmamk_f32 v10, v8, 0x43c20000, v9
    v_fmamk_f32 v11, v8, 0x43c28000, v9
    v_cos_f32 v12, v10
    v_cos_f32 v13, v11
    v_sin_f32 v14, v10
    v_sin_f32 v15, v11
    v_cvt_pk_bf16_f32 v12, v12, v13
    v_cvt_pk_bf16_f32 v14, -v14, -v15
    v_accvgpr_write_b32 a50, v12
    v_accvgpr_write_b32 a106, v14
    v_fmamk_f32 v10, v8, 0x43c30000, v9
    v_fmamk_f32 v11, v8, 0x43c38000, v9
    v_cos_f32 v12, v10
    v_cos_f32 v13, v11
    v_sin_f32 v14, v10
    v_sin_f32 v15, v11
    v_cvt_pk_bf16_f32 v12, v12, v13
    v_cvt_pk_bf16_f32 v14, -v14, -v15
    v_accvgpr_write_b32 a51, v12
    v_accvgpr_write_b32 a107, v14
    v_fmamk_f32 v10, v8, 0x43d00000, v9
    v_fmamk_f32 v11, v8, 0x43d08000, v9
    v_cos_f32 v12, v10
    v_cos_f32 v13, v11
    v_sin_f32 v14, v10
    v_sin_f32 v15, v11
    v_cvt_pk_bf16_f32 v12, v12, v13
    v_cvt_pk_bf16_f32 v14, -v14, -v15
    v_accvgpr_write_b32 a52, v12
    v_accvgpr_write_b32 a108, v14
    v_fmamk_f32 v10, v8, 0x43d10000, v9
    v_fmamk_f32 v11, v8, 0x43d18000, v9
    v_cos_f32 v12, v10
    v_cos_f32 v13, v11
    v_sin_f32 v14, v10
    v_sin_f32 v15, v11
    v_cvt_pk_bf16_f32 v12, v12, v13
    v_cvt_pk_bf16_f32 v14, -v14, -v15
    v_accvgpr_write_b32 a53, v12
    v_accvgpr_write_b32 a109, v14
    v_fmamk_f32 v10, v8, 0x43d20000, v9
    v_fmamk_f32 v11, v8, 0x43d28000, v9
    v_cos_f32 v12, v10
    v_cos_f32 v13, v11
    v_sin_f32 v14, v10
    v_sin_f32 v15, v11
    v_cvt_pk_bf16_f32 v12, v12, v13
    v_cvt_pk_bf16_f32 v14, -v14, -v15
    v_accvgpr_write_b32 a54, v12
    v_accvgpr_write_b32 a110, v14
    v_fmamk_f32 v10, v8, 0x43d30000, v9
    v_fmamk_f32 v11, v8, 0x43d38000, v9
    v_cos_f32 v12, v10
    v_cos_f32 v13, v11
    v_sin_f32 v14, v10
    v_sin_f32 v15, v11
    v_cvt_pk_bf16_f32 v12, v12, v13
    v_cvt_pk_bf16_f32 v14, -v14, -v15
    v_accvgpr_write_b32 a55, v12
    v_accvgpr_write_b32 a111, v14
    s_lshl_b32 s29, s27, 5
    s_add_u32 s29, s29, 16
    v_add_u32 v8, s29, v4
    v_cvt_f32_u32 v8, v8
    v_mul_f32 v8, 0x3b124925, v8
    v_mul_f32 v9, 0x41000000, v7
    v_mul_f32 v9, v9, v8
    v_fmamk_f32 v10, v8, 0x0, v9
    v_fmamk_f32 v11, v8, 0x3f800000, v9
    v_cos_f32 v12, v10
    v_cos_f32 v13, v11
    v_sin_f32 v14, v10
    v_sin_f32 v15, v11
    v_cvt_pk_bf16_f32 v12, v12, v13
    v_cvt_pk_bf16_f32 v14, -v14, -v15
    v_accvgpr_write_b32 a112, v12
    v_accvgpr_write_b32 a168, v14
    v_fmamk_f32 v10, v8, 0x40000000, v9
    v_fmamk_f32 v11, v8, 0x40400000, v9
    v_cos_f32 v12, v10
    v_cos_f32 v13, v11
    v_sin_f32 v14, v10
    v_sin_f32 v15, v11
    v_cvt_pk_bf16_f32 v12, v12, v13
    v_cvt_pk_bf16_f32 v14, -v14, -v15
    v_accvgpr_write_b32 a113, v12
    v_accvgpr_write_b32 a169, v14
    v_fmamk_f32 v10, v8, 0x40800000, v9
    v_fmamk_f32 v11, v8, 0x40a00000, v9
    v_cos_f32 v12, v10
    v_cos_f32 v13, v11
    v_sin_f32 v14, v10
    v_sin_f32 v15, v11
    v_cvt_pk_bf16_f32 v12, v12, v13
    v_cvt_pk_bf16_f32 v14, -v14, -v15
    v_accvgpr_write_b32 a114, v12
    v_accvgpr_write_b32 a170, v14
    v_fmamk_f32 v10, v8, 0x40c00000, v9
    v_fmamk_f32 v11, v8, 0x40e00000, v9
    v_cos_f32 v12, v10
    v_cos_f32 v13, v11
    v_sin_f32 v14, v10
    v_sin_f32 v15, v11
    v_cvt_pk_bf16_f32 v12, v12, v13
    v_cvt_pk_bf16_f32 v14, -v14, -v15
    v_accvgpr_write_b32 a115, v12
    v_accvgpr_write_b32 a171, v14
    v_fmamk_f32 v10, v8, 0x42000000, v9
    v_fmamk_f32 v11, v8, 0x42040000, v9
    v_cos_f32 v12, v10
    v_cos_f32 v13, v11
    v_sin_f32 v14, v10
    v_sin_f32 v15, v11
    v_cvt_pk_bf16_f32 v12, v12, v13
    v_cvt_pk_bf16_f32 v14, -v14, -v15
    v_accvgpr_write_b32 a116, v12
    v_accvgpr_write_b32 a172, v14
    v_fmamk_f32 v10, v8, 0x42080000, v9
    v_fmamk_f32 v11, v8, 0x420c0000, v9
    v_cos_f32 v12, v10
    v_cos_f32 v13, v11
    v_sin_f32 v14, v10
    v_sin_f32 v15, v11
    v_cvt_pk_bf16_f32 v12, v12, v13
    v_cvt_pk_bf16_f32 v14, -v14, -v15
    v_accvgpr_write_b32 a117, v12
    v_accvgpr_write_b32 a173, v14
    v_fmamk_f32 v10, v8, 0x42100000, v9
    v_fmamk_f32 v11, v8, 0x42140000, v9
    v_cos_f32 v12, v10
    v_cos_f32 v13, v11
    v_sin_f32 v14, v10
    v_sin_f32 v15, v11
    v_cvt_pk_bf16_f32 v12, v12, v13
    v_cvt_pk_bf16_f32 v14, -v14, -v15
    v_accvgpr_write_b32 a118, v12
    v_accvgpr_write_b32 a174, v14
    v_fmamk_f32 v10, v8, 0x42180000, v9
    v_fmamk_f32 v11, v8, 0x421c0000, v9
    v_cos_f32 v12, v10
    v_cos_f32 v13, v11
    v_sin_f32 v14, v10
    v_sin_f32 v15, v11
    v_cvt_pk_bf16_f32 v12, v12, v13
    v_cvt_pk_bf16_f32 v14, -v14, -v15
    v_accvgpr_write_b32 a119, v12
    v_accvgpr_write_b32 a175, v14
    v_fmamk_f32 v10, v8, 0x42800000, v9
    v_fmamk_f32 v11, v8, 0x42820000, v9
    v_cos_f32 v12, v10
    v_cos_f32 v13, v11
    v_sin_f32 v14, v10
    v_sin_f32 v15, v11
    v_cvt_pk_bf16_f32 v12, v12, v13
    v_cvt_pk_bf16_f32 v14, -v14, -v15
    v_accvgpr_write_b32 a120, v12
    v_accvgpr_write_b32 a176, v14
    v_fmamk_f32 v10, v8, 0x42840000, v9
    v_fmamk_f32 v11, v8, 0x42860000, v9
    v_cos_f32 v12, v10
    v_cos_f32 v13, v11
    v_sin_f32 v14, v10
    v_sin_f32 v15, v11
    v_cvt_pk_bf16_f32 v12, v12, v13
    v_cvt_pk_bf16_f32 v14, -v14, -v15
    v_accvgpr_write_b32 a121, v12
    v_accvgpr_write_b32 a177, v14
    v_fmamk_f32 v10, v8, 0x42880000, v9
    v_fmamk_f32 v11, v8, 0x428a0000, v9
    v_cos_f32 v12, v10
    v_cos_f32 v13, v11
    v_sin_f32 v14, v10
    v_sin_f32 v15, v11
    v_cvt_pk_bf16_f32 v12, v12, v13
    v_cvt_pk_bf16_f32 v14, -v14, -v15
    v_accvgpr_write_b32 a122, v12
    v_accvgpr_write_b32 a178, v14
    v_fmamk_f32 v10, v8, 0x428c0000, v9
    v_fmamk_f32 v11, v8, 0x428e0000, v9
    v_cos_f32 v12, v10
    v_cos_f32 v13, v11
    v_sin_f32 v14, v10
    v_sin_f32 v15, v11
    v_cvt_pk_bf16_f32 v12, v12, v13
    v_cvt_pk_bf16_f32 v14, -v14, -v15
    v_accvgpr_write_b32 a123, v12
    v_accvgpr_write_b32 a179, v14
    v_fmamk_f32 v10, v8, 0x42c00000, v9
    v_fmamk_f32 v11, v8, 0x42c20000, v9
    v_cos_f32 v12, v10
    v_cos_f32 v13, v11
    v_sin_f32 v14, v10
    v_sin_f32 v15, v11
    v_cvt_pk_bf16_f32 v12, v12, v13
    v_cvt_pk_bf16_f32 v14, -v14, -v15
    v_accvgpr_write_b32 a124, v12
    v_accvgpr_write_b32 a180, v14
    v_fmamk_f32 v10, v8, 0x42c40000, v9
    v_fmamk_f32 v11, v8, 0x42c60000, v9
    v_cos_f32 v12, v10
    v_cos_f32 v13, v11
    v_sin_f32 v14, v10
    v_sin_f32 v15, v11
    v_cvt_pk_bf16_f32 v12, v12, v13
    v_cvt_pk_bf16_f32 v14, -v14, -v15
    v_accvgpr_write_b32 a125, v12
    v_accvgpr_write_b32 a181, v14
    v_fmamk_f32 v10, v8, 0x42c80000, v9
    v_fmamk_f32 v11, v8, 0x42ca0000, v9
    v_cos_f32 v12, v10
    v_cos_f32 v13, v11
    v_sin_f32 v14, v10
    v_sin_f32 v15, v11
    v_cvt_pk_bf16_f32 v12, v12, v13
    v_cvt_pk_bf16_f32 v14, -v14, -v15
    v_accvgpr_write_b32 a126, v12
    v_accvgpr_write_b32 a182, v14
    v_fmamk_f32 v10, v8, 0x42cc0000, v9
    v_fmamk_f32 v11, v8, 0x42ce0000, v9
    v_cos_f32 v12, v10
    v_cos_f32 v13, v11
    v_sin_f32 v14, v10
    v_sin_f32 v15, v11
    v_cvt_pk_bf16_f32 v12, v12, v13
    v_cvt_pk_bf16_f32 v14, -v14, -v15
    v_accvgpr_write_b32 a127, v12
    v_accvgpr_write_b32 a183, v14
    v_fmamk_f32 v10, v8, 0x43000000, v9
    v_fmamk_f32 v11, v8, 0x43010000, v9
    v_cos_f32 v12, v10
    v_cos_f32 v13, v11
    v_sin_f32 v14, v10
    v_sin_f32 v15, v11
    v_cvt_pk_bf16_f32 v12, v12, v13
    v_cvt_pk_bf16_f32 v14, -v14, -v15
    v_accvgpr_write_b32 a128, v12
    v_accvgpr_write_b32 a184, v14
    v_fmamk_f32 v10, v8, 0x43020000, v9
    v_fmamk_f32 v11, v8, 0x43030000, v9
    v_cos_f32 v12, v10
    v_cos_f32 v13, v11
    v_sin_f32 v14, v10
    v_sin_f32 v15, v11
    v_cvt_pk_bf16_f32 v12, v12, v13
    v_cvt_pk_bf16_f32 v14, -v14, -v15
    v_accvgpr_write_b32 a129, v12
    v_accvgpr_write_b32 a185, v14
    v_fmamk_f32 v10, v8, 0x43040000, v9
    v_fmamk_f32 v11, v8, 0x43050000, v9
    v_cos_f32 v12, v10
    v_cos_f32 v13, v11
    v_sin_f32 v14, v10
    v_sin_f32 v15, v11
    v_cvt_pk_bf16_f32 v12, v12, v13
    v_cvt_pk_bf16_f32 v14, -v14, -v15
    v_accvgpr_write_b32 a130, v12
    v_accvgpr_write_b32 a186, v14
    v_fmamk_f32 v10, v8, 0x43060000, v9
    v_fmamk_f32 v11, v8, 0x43070000, v9
    v_cos_f32 v12, v10
    v_cos_f32 v13, v11
    v_sin_f32 v14, v10
    v_sin_f32 v15, v11
    v_cvt_pk_bf16_f32 v12, v12, v13
    v_cvt_pk_bf16_f32 v14, -v14, -v15
    v_accvgpr_write_b32 a131, v12
    v_accvgpr_write_b32 a187, v14
    v_fmamk_f32 v10, v8, 0x43200000, v9
    v_fmamk_f32 v11, v8, 0x43210000, v9
    v_cos_f32 v12, v10
    v_cos_f32 v13, v11
    v_sin_f32 v14, v10
    v_sin_f32 v15, v11
    v_cvt_pk_bf16_f32 v12, v12, v13
    v_cvt_pk_bf16_f32 v14, -v14, -v15
    v_accvgpr_write_b32 a132, v12
    v_accvgpr_write_b32 a188, v14
    v_fmamk_f32 v10, v8, 0x43220000, v9
    v_fmamk_f32 v11, v8, 0x43230000, v9
    v_cos_f32 v12, v10
    v_cos_f32 v13, v11
    v_sin_f32 v14, v10
    v_sin_f32 v15, v11
    v_cvt_pk_bf16_f32 v12, v12, v13
    v_cvt_pk_bf16_f32 v14, -v14, -v15
    v_accvgpr_write_b32 a133, v12
    v_accvgpr_write_b32 a189, v14
    v_fmamk_f32 v10, v8, 0x43240000, v9
    v_fmamk_f32 v11, v8, 0x43250000, v9
    v_cos_f32 v12, v10
    v_cos_f32 v13, v11
    v_sin_f32 v14, v10
    v_sin_f32 v15, v11
    v_cvt_pk_bf16_f32 v12, v12, v13
    v_cvt_pk_bf16_f32 v14, -v14, -v15
    v_accvgpr_write_b32 a134, v12
    v_accvgpr_write_b32 a190, v14
    v_fmamk_f32 v10, v8, 0x43260000, v9
    v_fmamk_f32 v11, v8, 0x43270000, v9
    v_cos_f32 v12, v10
    v_cos_f32 v13, v11
    v_sin_f32 v14, v10
    v_sin_f32 v15, v11
    v_cvt_pk_bf16_f32 v12, v12, v13
    v_cvt_pk_bf16_f32 v14, -v14, -v15
    v_accvgpr_write_b32 a135, v12
    v_accvgpr_write_b32 a191, v14
    v_fmamk_f32 v10, v8, 0x43400000, v9
    v_fmamk_f32 v11, v8, 0x43410000, v9
    v_cos_f32 v12, v10
    v_cos_f32 v13, v11
    v_sin_f32 v14, v10
    v_sin_f32 v15, v11
    v_cvt_pk_bf16_f32 v12, v12, v13
    v_cvt_pk_bf16_f32 v14, -v14, -v15
    v_accvgpr_write_b32 a136, v12
    v_accvgpr_write_b32 a192, v14
    v_fmamk_f32 v10, v8, 0x43420000, v9
    v_fmamk_f32 v11, v8, 0x43430000, v9
    v_cos_f32 v12, v10
    v_cos_f32 v13, v11
    v_sin_f32 v14, v10
    v_sin_f32 v15, v11
    v_cvt_pk_bf16_f32 v12, v12, v13
    v_cvt_pk_bf16_f32 v14, -v14, -v15
    v_accvgpr_write_b32 a137, v12
    v_accvgpr_write_b32 a193, v14
    v_fmamk_f32 v10, v8, 0x43440000, v9
    v_fmamk_f32 v11, v8, 0x43450000, v9
    v_cos_f32 v12, v10
    v_cos_f32 v13, v11
    v_sin_f32 v14, v10
    v_sin_f32 v15, v11
    v_cvt_pk_bf16_f32 v12, v12, v13
    v_cvt_pk_bf16_f32 v14, -v14, -v15
    v_accvgpr_write_b32 a138, v12
    v_accvgpr_write_b32 a194, v14
    v_fmamk_f32 v10, v8, 0x43460000, v9
    v_fmamk_f32 v11, v8, 0x43470000, v9
    v_cos_f32 v12, v10
    v_cos_f32 v13, v11
    v_sin_f32 v14, v10
    v_sin_f32 v15, v11
    v_cvt_pk_bf16_f32 v12, v12, v13
    v_cvt_pk_bf16_f32 v14, -v14, -v15
    v_accvgpr_write_b32 a139, v12
    v_accvgpr_write_b32 a195, v14
    v_fmamk_f32 v10, v8, 0x43600000, v9
    v_fmamk_f32 v11, v8, 0x43610000, v9
    v_cos_f32 v12, v10
    v_cos_f32 v13, v11
    v_sin_f32 v14, v10
    v_sin_f32 v15, v11
    v_cvt_pk_bf16_f32 v12, v12, v13
    v_cvt_pk_bf16_f32 v14, -v14, -v15
    v_accvgpr_write_b32 a140, v12
    v_accvgpr_write_b32 a196, v14
    v_fmamk_f32 v10, v8, 0x43620000, v9
    v_fmamk_f32 v11, v8, 0x43630000, v9
    v_cos_f32 v12, v10
    v_cos_f32 v13, v11
    v_sin_f32 v14, v10
    v_sin_f32 v15, v11
    v_cvt_pk_bf16_f32 v12, v12, v13
    v_cvt_pk_bf16_f32 v14, -v14, -v15
    v_accvgpr_write_b32 a141, v12
    v_accvgpr_write_b32 a197, v14
    v_fmamk_f32 v10, v8, 0x43640000, v9
    v_fmamk_f32 v11, v8, 0x43650000, v9
    v_cos_f32 v12, v10
    v_cos_f32 v13, v11
    v_sin_f32 v14, v10
    v_sin_f32 v15, v11
    v_cvt_pk_bf16_f32 v12, v12, v13
    v_cvt_pk_bf16_f32 v14, -v14, -v15
    v_accvgpr_write_b32 a142, v12
    v_accvgpr_write_b32 a198, v14
    v_fmamk_f32 v10, v8, 0x43660000, v9
    v_fmamk_f32 v11, v8, 0x43670000, v9
    v_cos_f32 v12, v10
    v_cos_f32 v13, v11
    v_sin_f32 v14, v10
    v_sin_f32 v15, v11
    v_cvt_pk_bf16_f32 v12, v12, v13
    v_cvt_pk_bf16_f32 v14, -v14, -v15
    v_accvgpr_write_b32 a143, v12
    v_accvgpr_write_b32 a199, v14
    v_fmamk_f32 v10, v8, 0x43800000, v9
    v_fmamk_f32 v11, v8, 0x43808000, v9
    v_cos_f32 v12, v10
    v_cos_f32 v13, v11
    v_sin_f32 v14, v10
    v_sin_f32 v15, v11
    v_cvt_pk_bf16_f32 v12, v12, v13
    v_cvt_pk_bf16_f32 v14, -v14, -v15
    v_accvgpr_write_b32 a144, v12
    v_accvgpr_write_b32 a200, v14
    v_fmamk_f32 v10, v8, 0x43810000, v9
    v_fmamk_f32 v11, v8, 0x43818000, v9
    v_cos_f32 v12, v10
    v_cos_f32 v13, v11
    v_sin_f32 v14, v10
    v_sin_f32 v15, v11
    v_cvt_pk_bf16_f32 v12, v12, v13
    v_cvt_pk_bf16_f32 v14, -v14, -v15
    v_accvgpr_write_b32 a145, v12
    v_accvgpr_write_b32 a201, v14
    v_fmamk_f32 v10, v8, 0x43820000, v9
    v_fmamk_f32 v11, v8, 0x43828000, v9
    v_cos_f32 v12, v10
    v_cos_f32 v13, v11
    v_sin_f32 v14, v10
    v_sin_f32 v15, v11
    v_cvt_pk_bf16_f32 v12, v12, v13
    v_cvt_pk_bf16_f32 v14, -v14, -v15
    v_accvgpr_write_b32 a146, v12
    v_accvgpr_write_b32 a202, v14
    v_fmamk_f32 v10, v8, 0x43830000, v9
    v_fmamk_f32 v11, v8, 0x43838000, v9
    v_cos_f32 v12, v10
    v_cos_f32 v13, v11
    v_sin_f32 v14, v10
    v_sin_f32 v15, v11
    v_cvt_pk_bf16_f32 v12, v12, v13
    v_cvt_pk_bf16_f32 v14, -v14, -v15
    v_accvgpr_write_b32 a147, v12
    v_accvgpr_write_b32 a203, v14
    v_fmamk_f32 v10, v8, 0x43900000, v9
    v_fmamk_f32 v11, v8, 0x43908000, v9
    v_cos_f32 v12, v10
    v_cos_f32 v13, v11
    v_sin_f32 v14, v10
    v_sin_f32 v15, v11
    v_cvt_pk_bf16_f32 v12, v12, v13
    v_cvt_pk_bf16_f32 v14, -v14, -v15
    v_accvgpr_write_b32 a148, v12
    v_accvgpr_write_b32 a204, v14
    v_fmamk_f32 v10, v8, 0x43910000, v9
    v_fmamk_f32 v11, v8, 0x43918000, v9
    v_cos_f32 v12, v10
    v_cos_f32 v13, v11
    v_sin_f32 v14, v10
    v_sin_f32 v15, v11
    v_cvt_pk_bf16_f32 v12, v12, v13
    v_cvt_pk_bf16_f32 v14, -v14, -v15
    v_accvgpr_write_b32 a149, v12
    v_accvgpr_write_b32 a205, v14
    v_fmamk_f32 v10, v8, 0x43920000, v9
    v_fmamk_f32 v11, v8, 0x43928000, v9
    v_cos_f32 v12, v10
    v_cos_f32 v13, v11
    v_sin_f32 v14, v10
    v_sin_f32 v15, v11
    v_cvt_pk_bf16_f32 v12, v12, v13
    v_cvt_pk_bf16_f32 v14, -v14, -v15
    v_accvgpr_write_b32 a150, v12
    v_accvgpr_write_b32 a206, v14
    v_fmamk_f32 v10, v8, 0x43930000, v9
    v_fmamk_f32 v11, v8, 0x43938000, v9
    v_cos_f32 v12, v10
    v_cos_f32 v13, v11
    v_sin_f32 v14, v10
    v_sin_f32 v15, v11
    v_cvt_pk_bf16_f32 v12, v12, v13
    v_cvt_pk_bf16_f32 v14, -v14, -v15
    v_accvgpr_write_b32 a151, v12
    v_accvgpr_write_b32 a207, v14
    v_fmamk_f32 v10, v8, 0x43a00000, v9
    v_fmamk_f32 v11, v8, 0x43a08000, v9
    v_cos_f32 v12, v10
    v_cos_f32 v13, v11
    v_sin_f32 v14, v10
    v_sin_f32 v15, v11
    v_cvt_pk_bf16_f32 v12, v12, v13
    v_cvt_pk_bf16_f32 v14, -v14, -v15
    v_accvgpr_write_b32 a152, v12
    v_accvgpr_write_b32 a208, v14
    v_fmamk_f32 v10, v8, 0x43a10000, v9
    v_fmamk_f32 v11, v8, 0x43a18000, v9
    v_cos_f32 v12, v10
    v_cos_f32 v13, v11
    v_sin_f32 v14, v10
    v_sin_f32 v15, v11
    v_cvt_pk_bf16_f32 v12, v12, v13
    v_cvt_pk_bf16_f32 v14, -v14, -v15
    v_accvgpr_write_b32 a153, v12
    v_accvgpr_write_b32 a209, v14
    v_fmamk_f32 v10, v8, 0x43a20000, v9
    v_fmamk_f32 v11, v8, 0x43a28000, v9
    v_cos_f32 v12, v10
    v_cos_f32 v13, v11
    v_sin_f32 v14, v10
    v_sin_f32 v15, v11
    v_cvt_pk_bf16_f32 v12, v12, v13
    v_cvt_pk_bf16_f32 v14, -v14, -v15
    v_accvgpr_write_b32 a154, v12
    v_accvgpr_write_b32 a210, v14
    v_fmamk_f32 v10, v8, 0x43a30000, v9
    v_fmamk_f32 v11, v8, 0x43a38000, v9
    v_cos_f32 v12, v10
    v_cos_f32 v13, v11
    v_sin_f32 v14, v10
    v_sin_f32 v15, v11
    v_cvt_pk_bf16_f32 v12, v12, v13
    v_cvt_pk_bf16_f32 v14, -v14, -v15
    v_accvgpr_write_b32 a155, v12
    v_accvgpr_write_b32 a211, v14
    v_fmamk_f32 v10, v8, 0x43b00000, v9
    v_fmamk_f32 v11, v8, 0x43b08000, v9
    v_cos_f32 v12, v10
    v_cos_f32 v13, v11
    v_sin_f32 v14, v10
    v_sin_f32 v15, v11
    v_cvt_pk_bf16_f32 v12, v12, v13
    v_cvt_pk_bf16_f32 v14, -v14, -v15
    v_accvgpr_write_b32 a156, v12
    v_accvgpr_write_b32 a212, v14
    v_fmamk_f32 v10, v8, 0x43b10000, v9
    v_fmamk_f32 v11, v8, 0x43b18000, v9
    v_cos_f32 v12, v10
    v_cos_f32 v13, v11
    v_sin_f32 v14, v10
    v_sin_f32 v15, v11
    v_cvt_pk_bf16_f32 v12, v12, v13
    v_cvt_pk_bf16_f32 v14, -v14, -v15
    v_accvgpr_write_b32 a157, v12
    v_accvgpr_write_b32 a213, v14
    v_fmamk_f32 v10, v8, 0x43b20000, v9
    v_fmamk_f32 v11, v8, 0x43b28000, v9
    v_cos_f32 v12, v10
    v_cos_f32 v13, v11
    v_sin_f32 v14, v10
    v_sin_f32 v15, v11
    v_cvt_pk_bf16_f32 v12, v12, v13
    v_cvt_pk_bf16_f32 v14, -v14, -v15
    v_accvgpr_write_b32 a158, v12
    v_accvgpr_write_b32 a214, v14
    v_fmamk_f32 v10, v8, 0x43b30000, v9
    v_fmamk_f32 v11, v8, 0x43b38000, v9
    v_cos_f32 v12, v10
    v_cos_f32 v13, v11
    v_sin_f32 v14, v10
    v_sin_f32 v15, v11
    v_cvt_pk_bf16_f32 v12, v12, v13
    v_cvt_pk_bf16_f32 v14, -v14, -v15
    v_accvgpr_write_b32 a159, v12
    v_accvgpr_write_b32 a215, v14
    v_fmamk_f32 v10, v8, 0x43c00000, v9
    v_fmamk_f32 v11, v8, 0x43c08000, v9
    v_cos_f32 v12, v10
    v_cos_f32 v13, v11
    v_sin_f32 v14, v10
    v_sin_f32 v15, v11
    v_cvt_pk_bf16_f32 v12, v12, v13
    v_cvt_pk_bf16_f32 v14, -v14, -v15
    v_accvgpr_write_b32 a160, v12
    v_accvgpr_write_b32 a216, v14
    v_fmamk_f32 v10, v8, 0x43c10000, v9
    v_fmamk_f32 v11, v8, 0x43c18000, v9
    v_cos_f32 v12, v10
    v_cos_f32 v13, v11
    v_sin_f32 v14, v10
    v_sin_f32 v15, v11
    v_cvt_pk_bf16_f32 v12, v12, v13
    v_cvt_pk_bf16_f32 v14, -v14, -v15
    v_accvgpr_write_b32 a161, v12
    v_accvgpr_write_b32 a217, v14
    v_fmamk_f32 v10, v8, 0x43c20000, v9
    v_fmamk_f32 v11, v8, 0x43c28000, v9
    v_cos_f32 v12, v10
    v_cos_f32 v13, v11
    v_sin_f32 v14, v10
    v_sin_f32 v15, v11
    v_cvt_pk_bf16_f32 v12, v12, v13
    v_cvt_pk_bf16_f32 v14, -v14, -v15
    v_accvgpr_write_b32 a162, v12
    v_accvgpr_write_b32 a218, v14
    v_fmamk_f32 v10, v8, 0x43c30000, v9
    v_fmamk_f32 v11, v8, 0x43c38000, v9
    v_cos_f32 v12, v10
    v_cos_f32 v13, v11
    v_sin_f32 v14, v10
    v_sin_f32 v15, v11
    v_cvt_pk_bf16_f32 v12, v12, v13
    v_cvt_pk_bf16_f32 v14, -v14, -v15
    v_accvgpr_write_b32 a163, v12
    v_accvgpr_write_b32 a219, v14
    v_fmamk_f32 v10, v8, 0x43d00000, v9
    v_fmamk_f32 v11, v8, 0x43d08000, v9
    v_cos_f32 v12, v10
    v_cos_f32 v13, v11
    v_sin_f32 v14, v10
    v_sin_f32 v15, v11
    v_cvt_pk_bf16_f32 v12, v12, v13
    v_cvt_pk_bf16_f32 v14, -v14, -v15
    v_accvgpr_write_b32 a164, v12
    v_accvgpr_write_b32 a220, v14
    v_fmamk_f32 v10, v8, 0x43d10000, v9
    v_fmamk_f32 v11, v8, 0x43d18000, v9
    v_cos_f32 v12, v10
    v_cos_f32 v13, v11
    v_sin_f32 v14, v10
    v_sin_f32 v15, v11
    v_cvt_pk_bf16_f32 v12, v12, v13
    v_cvt_pk_bf16_f32 v14, -v14, -v15
    v_accvgpr_write_b32 a165, v12
    v_accvgpr_write_b32 a221, v14
    v_fmamk_f32 v10, v8, 0x43d20000, v9
    v_fmamk_f32 v11, v8, 0x43d28000, v9
    v_cos_f32 v12, v10
    v_cos_f32 v13, v11
    v_sin_f32 v14, v10
    v_sin_f32 v15, v11
    v_cvt_pk_bf16_f32 v12, v12, v13
    v_cvt_pk_bf16_f32 v14, -v14, -v15
    v_accvgpr_write_b32 a166, v12
    v_accvgpr_write_b32 a222, v14
    v_fmamk_f32 v10, v8, 0x43d30000, v9
    v_fmamk_f32 v11, v8, 0x43d38000, v9
    v_cos_f32 v12, v10
    v_cos_f32 v13, v11
    v_sin_f32 v14, v10
    v_sin_f32 v15, v11
    v_cvt_pk_bf16_f32 v12, v12, v13
    v_cvt_pk_bf16_f32 v14, -v14, -v15
    v_accvgpr_write_b32 a167, v12
    v_accvgpr_write_b32 a223, v14
    s_lshr_b32 s29, s28, 3
    s_lshl_b32 s29, s29, 19
    s_and_b32 s30, s28, 7
    s_lshl_b32 s30, s30, 13
    s_add_u32 s29, s29, s30
    s_lshl_b32 s30, s27, 9
    s_add_u32 s29, s29, s30
    s_add_u32 s29, s29, 18513920
    v_lshlrev_b32 v8, 16, v5
    v_lshl_add_u32 v8, v4, 4, v8
    v_add_u32 v8, s29, v8
    s_waitcnt vmcnt(42)
    v_mfma_f32_16x16x32_bf16 v[16:19], v[32:35], a[0:3], 0
    v_mfma_f32_16x16x32_bf16 v[20:23], v[32:35], a[56:59], 0
    v_mfma_f32_16x16x32_bf16 v[24:27], v[32:35], a[112:115], 0
    v_mfma_f32_16x16x32_bf16 v[28:31], v[32:35], a[168:171], 0
    v_mfma_f32_16x16x32_bf16 v[16:19], v[36:39], a[4:7], v[16:19]
    v_mfma_f32_16x16x32_bf16 v[20:23], v[36:39], a[60:63], v[20:23]
    v_mfma_f32_16x16x32_bf16 v[24:27], v[36:39], a[116:119], v[24:27]
    v_mfma_f32_16x16x32_bf16 v[28:31], v[36:39], a[172:175], v[28:31]
    v_mfma_f32_16x16x32_bf16 v[16:19], v[40:43], a[8:11], v[16:19]
    v_mfma_f32_16x16x32_bf16 v[20:23], v[40:43], a[64:67], v[20:23]
    v_mfma_f32_16x16x32_bf16 v[24:27], v[40:43], a[120:123], v[24:27]
    v_mfma_f32_16x16x32_bf16 v[28:31], v[40:43], a[176:179], v[28:31]
    v_mfma_f32_16x16x32_bf16 v[16:19], v[44:47], a[12:15], v[16:19]
    v_mfma_f32_16x16x32_bf16 v[20:23], v[44:47], a[68:71], v[20:23]
    v_mfma_f32_16x16x32_bf16 v[24:27], v[44:47], a[124:127], v[24:27]
    v_mfma_f32_16x16x32_bf16 v[28:31], v[44:47], a[180:183], v[28:31]
    v_mfma_f32_16x16x32_bf16 v[16:19], v[48:51], a[16:19], v[16:19]
    v_mfma_f32_16x16x32_bf16 v[20:23], v[48:51], a[72:75], v[20:23]
    v_mfma_f32_16x16x32_bf16 v[24:27], v[48:51], a[128:131], v[24:27]
    v_mfma_f32_16x16x32_bf16 v[28:31], v[48:51], a[184:187], v[28:31]
    v_mfma_f32_16x16x32_bf16 v[16:19], v[52:55], a[20:23], v[16:19]
    v_mfma_f32_16x16x32_bf16 v[20:23], v[52:55], a[76:79], v[20:23]
    v_mfma_f32_16x16x32_bf16 v[24:27], v[52:55], a[132:135], v[24:27]
    v_mfma_f32_16x16x32_bf16 v[28:31], v[52:55], a[188:191], v[28:31]
    v_mfma_f32_16x16x32_bf16 v[16:19], v[56:59], a[24:27], v[16:19]
    v_mfma_f32_16x16x32_bf16 v[20:23], v[56:59], a[80:83], v[20:23]
    v_mfma_f32_16x16x32_bf16 v[24:27], v[56:59], a[136:139], v[24:27]
    v_mfma_f32_16x16x32_bf16 v[28:31], v[56:59], a[192:195], v[28:31]
    v_mfma_f32_16x16x32_bf16 v[16:19], v[60:63], a[28:31], v[16:19]
    v_mfma_f32_16x16x32_bf16 v[20:23], v[60:63], a[84:87], v[20:23]
    v_mfma_f32_16x16x32_bf16 v[24:27], v[60:63], a[140:143], v[24:27]
    v_mfma_f32_16x16x32_bf16 v[28:31], v[60:63], a[196:199], v[28:31]
    v_mfma_f32_16x16x32_bf16 v[16:19], v[64:67], a[32:35], v[16:19]
    v_mfma_f32_16x16x32_bf16 v[20:23], v[64:67], a[88:91], v[20:23]
    v_mfma_f32_16x16x32_bf16 v[24:27], v[64:67], a[144:147], v[24:27]
    v_mfma_f32_16x16x32_bf16 v[28:31], v[64:67], a[200:203], v[28:31]
    v_mfma_f32_16x16x32_bf16 v[16:19], v[68:71], a[36:39], v[16:19]
    v_mfma_f32_16x16x32_bf16 v[20:23], v[68:71], a[92:95], v[20:23]
    v_mfma_f32_16x16x32_bf16 v[24:27], v[68:71], a[148:151], v[24:27]
    v_mfma_f32_16x16x32_bf16 v[28:31], v[68:71], a[204:207], v[28:31]
    v_mfma_f32_16x16x32_bf16 v[16:19], v[72:75], a[40:43], v[16:19]
    v_mfma_f32_16x16x32_bf16 v[20:23], v[72:75], a[96:99], v[20:23]
    v_mfma_f32_16x16x32_bf16 v[24:27], v[72:75], a[152:155], v[24:27]
    v_mfma_f32_16x16x32_bf16 v[28:31], v[72:75], a[208:211], v[28:31]
    v_mfma_f32_16x16x32_bf16 v[16:19], v[76:79], a[44:47], v[16:19]
    v_mfma_f32_16x16x32_bf16 v[20:23], v[76:79], a[100:103], v[20:23]
    v_mfma_f32_16x16x32_bf16 v[24:27], v[76:79], a[156:159], v[24:27]
    v_mfma_f32_16x16x32_bf16 v[28:31], v[76:79], a[212:215], v[28:31]
    v_mfma_f32_16x16x32_bf16 v[16:19], v[80:83], a[48:51], v[16:19]
    v_mfma_f32_16x16x32_bf16 v[20:23], v[80:83], a[104:107], v[20:23]
    v_mfma_f32_16x16x32_bf16 v[24:27], v[80:83], a[160:163], v[24:27]
    v_mfma_f32_16x16x32_bf16 v[28:31], v[80:83], a[216:219], v[28:31]
    v_mfma_f32_16x16x32_bf16 v[16:19], v[84:87], a[52:55], v[16:19]
    v_mfma_f32_16x16x32_bf16 v[20:23], v[84:87], a[108:111], v[20:23]
    v_mfma_f32_16x16x32_bf16 v[24:27], v[84:87], a[164:167], v[24:27]
    v_mfma_f32_16x16x32_bf16 v[28:31], v[84:87], a[220:223], v[28:31]
    v_add_u32 v9, 0, v8
    v_cvt_pk_bf16_f32 v32, v16, v17
    v_cvt_pk_bf16_f32 v33, v18, v19
    v_cvt_pk_bf16_f32 v34, v20, v21
    v_cvt_pk_bf16_f32 v35, v22, v23
    global_store_dwordx4 v9, v[32:35], s[12:13] offset:0 sc1
    v_cvt_pk_bf16_f32 v36, v24, v25
    v_cvt_pk_bf16_f32 v37, v26, v27
    v_cvt_pk_bf16_f32 v38, v28, v29
    v_cvt_pk_bf16_f32 v39, v30, v31
    global_store_dwordx4 v9, v[36:39], s[12:13] offset:256 sc1
    s_waitcnt vmcnt(30)
    v_mfma_f32_16x16x32_bf16 v[16:19], v[88:91], a[0:3], 0
    v_mfma_f32_16x16x32_bf16 v[20:23], v[88:91], a[56:59], 0
    v_mfma_f32_16x16x32_bf16 v[24:27], v[88:91], a[112:115], 0
    v_mfma_f32_16x16x32_bf16 v[28:31], v[88:91], a[168:171], 0
    v_mfma_f32_16x16x32_bf16 v[16:19], v[92:95], a[4:7], v[16:19]
    v_mfma_f32_16x16x32_bf16 v[20:23], v[92:95], a[60:63], v[20:23]
    v_mfma_f32_16x16x32_bf16 v[24:27], v[92:95], a[116:119], v[24:27]
    v_mfma_f32_16x16x32_bf16 v[28:31], v[92:95], a[172:175], v[28:31]
    v_mfma_f32_16x16x32_bf16 v[16:19], v[96:99], a[8:11], v[16:19]
    v_mfma_f32_16x16x32_bf16 v[20:23], v[96:99], a[64:67], v[20:23]
    v_mfma_f32_16x16x32_bf16 v[24:27], v[96:99], a[120:123], v[24:27]
    v_mfma_f32_16x16x32_bf16 v[28:31], v[96:99], a[176:179], v[28:31]
    v_mfma_f32_16x16x32_bf16 v[16:19], v[100:103], a[12:15], v[16:19]
    v_mfma_f32_16x16x32_bf16 v[20:23], v[100:103], a[68:71], v[20:23]
    v_mfma_f32_16x16x32_bf16 v[24:27], v[100:103], a[124:127], v[24:27]
    v_mfma_f32_16x16x32_bf16 v[28:31], v[100:103], a[180:183], v[28:31]
    v_mfma_f32_16x16x32_bf16 v[16:19], v[104:107], a[16:19], v[16:19]
    v_mfma_f32_16x16x32_bf16 v[20:23], v[104:107], a[72:75], v[20:23]
    v_mfma_f32_16x16x32_bf16 v[24:27], v[104:107], a[128:131], v[24:27]
    v_mfma_f32_16x16x32_bf16 v[28:31], v[104:107], a[184:187], v[28:31]
    v_mfma_f32_16x16x32_bf16 v[16:19], v[108:111], a[20:23], v[16:19]
    v_mfma_f32_16x16x32_bf16 v[20:23], v[108:111], a[76:79], v[20:23]
    v_mfma_f32_16x16x32_bf16 v[24:27], v[108:111], a[132:135], v[24:27]
    v_mfma_f32_16x16x32_bf16 v[28:31], v[108:111], a[188:191], v[28:31]
    v_mfma_f32_16x16x32_bf16 v[16:19], v[112:115], a[24:27], v[16:19]
    v_mfma_f32_16x16x32_bf16 v[20:23], v[112:115], a[80:83], v[20:23]
    v_mfma_f32_16x16x32_bf16 v[24:27], v[112:115], a[136:139], v[24:27]
    v_mfma_f32_16x16x32_bf16 v[28:31], v[112:115], a[192:195], v[28:31]
    v_mfma_f32_16x16x32_bf16 v[16:19], v[116:119], a[28:31], v[16:19]
    v_mfma_f32_16x16x32_bf16 v[20:23], v[116:119], a[84:87], v[20:23]
    v_mfma_f32_16x16x32_bf16 v[24:27], v[116:119], a[140:143], v[24:27]
    v_mfma_f32_16x16x32_bf16 v[28:31], v[116:119], a[196:199], v[28:31]
    v_mfma_f32_16x16x32_bf16 v[16:19], v[120:123], a[32:35], v[16:19]
    v_mfma_f32_16x16x32_bf16 v[20:23], v[120:123], a[88:91], v[20:23]
    v_mfma_f32_16x16x32_bf16 v[24:27], v[120:123], a[144:147], v[24:27]
    v_mfma_f32_16x16x32_bf16 v[28:31], v[120:123], a[200:203], v[28:31]
    v_mfma_f32_16x16x32_bf16 v[16:19], v[124:127], a[36:39], v[16:19]
    v_mfma_f32_16x16x32_bf16 v[20:23], v[124:127], a[92:95], v[20:23]
    v_mfma_f32_16x16x32_bf16 v[24:27], v[124:127], a[148:151], v[24:27]
    v_mfma_f32_16x16x32_bf16 v[28:31], v[124:127], a[204:207], v[28:31]
    v_mfma_f32_16x16x32_bf16 v[16:19], v[128:131], a[40:43], v[16:19]
    v_mfma_f32_16x16x32_bf16 v[20:23], v[128:131], a[96:99], v[20:23]
    v_mfma_f32_16x16x32_bf16 v[24:27], v[128:131], a[152:155], v[24:27]
    v_mfma_f32_16x16x32_bf16 v[28:31], v[128:131], a[208:211], v[28:31]
    v_mfma_f32_16x16x32_bf16 v[16:19], v[132:135], a[44:47], v[16:19]
    v_mfma_f32_16x16x32_bf16 v[20:23], v[132:135], a[100:103], v[20:23]
    v_mfma_f32_16x16x32_bf16 v[24:27], v[132:135], a[156:159], v[24:27]
    v_mfma_f32_16x16x32_bf16 v[28:31], v[132:135], a[212:215], v[28:31]
    v_mfma_f32_16x16x32_bf16 v[16:19], v[136:139], a[48:51], v[16:19]
    v_mfma_f32_16x16x32_bf16 v[20:23], v[136:139], a[104:107], v[20:23]
    v_mfma_f32_16x16x32_bf16 v[24:27], v[136:139], a[160:163], v[24:27]
    v_mfma_f32_16x16x32_bf16 v[28:31], v[136:139], a[216:219], v[28:31]
    v_mfma_f32_16x16x32_bf16 v[16:19], v[140:143], a[52:55], v[16:19]
    v_mfma_f32_16x16x32_bf16 v[20:23], v[140:143], a[108:111], v[20:23]
    v_mfma_f32_16x16x32_bf16 v[24:27], v[140:143], a[164:167], v[24:27]
    v_mfma_f32_16x16x32_bf16 v[28:31], v[140:143], a[220:223], v[28:31]
    v_add_u32 v9, 262144, v8
    v_cvt_pk_bf16_f32 v88, v16, v17
    v_cvt_pk_bf16_f32 v89, v18, v19
    v_cvt_pk_bf16_f32 v90, v20, v21
    v_cvt_pk_bf16_f32 v91, v22, v23
    global_store_dwordx4 v9, v[88:91], s[12:13] offset:0 sc1
    v_cvt_pk_bf16_f32 v92, v24, v25
    v_cvt_pk_bf16_f32 v93, v26, v27
    v_cvt_pk_bf16_f32 v94, v28, v29
    v_cvt_pk_bf16_f32 v95, v30, v31
    global_store_dwordx4 v9, v[92:95], s[12:13] offset:256 sc1
    s_waitcnt vmcnt(18)
    v_mfma_f32_16x16x32_bf16 v[16:19], v[144:147], a[0:3], 0
    v_mfma_f32_16x16x32_bf16 v[20:23], v[144:147], a[56:59], 0
    v_mfma_f32_16x16x32_bf16 v[24:27], v[144:147], a[112:115], 0
    v_mfma_f32_16x16x32_bf16 v[28:31], v[144:147], a[168:171], 0
    v_mfma_f32_16x16x32_bf16 v[16:19], v[148:151], a[4:7], v[16:19]
    v_mfma_f32_16x16x32_bf16 v[20:23], v[148:151], a[60:63], v[20:23]
    v_mfma_f32_16x16x32_bf16 v[24:27], v[148:151], a[116:119], v[24:27]
    v_mfma_f32_16x16x32_bf16 v[28:31], v[148:151], a[172:175], v[28:31]
    v_mfma_f32_16x16x32_bf16 v[16:19], v[152:155], a[8:11], v[16:19]
    v_mfma_f32_16x16x32_bf16 v[20:23], v[152:155], a[64:67], v[20:23]
    v_mfma_f32_16x16x32_bf16 v[24:27], v[152:155], a[120:123], v[24:27]
    v_mfma_f32_16x16x32_bf16 v[28:31], v[152:155], a[176:179], v[28:31]
    v_mfma_f32_16x16x32_bf16 v[16:19], v[156:159], a[12:15], v[16:19]
    v_mfma_f32_16x16x32_bf16 v[20:23], v[156:159], a[68:71], v[20:23]
    v_mfma_f32_16x16x32_bf16 v[24:27], v[156:159], a[124:127], v[24:27]
    v_mfma_f32_16x16x32_bf16 v[28:31], v[156:159], a[180:183], v[28:31]
    v_mfma_f32_16x16x32_bf16 v[16:19], v[160:163], a[16:19], v[16:19]
    v_mfma_f32_16x16x32_bf16 v[20:23], v[160:163], a[72:75], v[20:23]
    v_mfma_f32_16x16x32_bf16 v[24:27], v[160:163], a[128:131], v[24:27]
    v_mfma_f32_16x16x32_bf16 v[28:31], v[160:163], a[184:187], v[28:31]
    v_mfma_f32_16x16x32_bf16 v[16:19], v[164:167], a[20:23], v[16:19]
    v_mfma_f32_16x16x32_bf16 v[20:23], v[164:167], a[76:79], v[20:23]
    v_mfma_f32_16x16x32_bf16 v[24:27], v[164:167], a[132:135], v[24:27]
    v_mfma_f32_16x16x32_bf16 v[28:31], v[164:167], a[188:191], v[28:31]
    v_mfma_f32_16x16x32_bf16 v[16:19], v[168:171], a[24:27], v[16:19]
    v_mfma_f32_16x16x32_bf16 v[20:23], v[168:171], a[80:83], v[20:23]
    v_mfma_f32_16x16x32_bf16 v[24:27], v[168:171], a[136:139], v[24:27]
    v_mfma_f32_16x16x32_bf16 v[28:31], v[168:171], a[192:195], v[28:31]
    v_mfma_f32_16x16x32_bf16 v[16:19], v[172:175], a[28:31], v[16:19]
    v_mfma_f32_16x16x32_bf16 v[20:23], v[172:175], a[84:87], v[20:23]
    v_mfma_f32_16x16x32_bf16 v[24:27], v[172:175], a[140:143], v[24:27]
    v_mfma_f32_16x16x32_bf16 v[28:31], v[172:175], a[196:199], v[28:31]
    v_mfma_f32_16x16x32_bf16 v[16:19], v[176:179], a[32:35], v[16:19]
    v_mfma_f32_16x16x32_bf16 v[20:23], v[176:179], a[88:91], v[20:23]
    v_mfma_f32_16x16x32_bf16 v[24:27], v[176:179], a[144:147], v[24:27]
    v_mfma_f32_16x16x32_bf16 v[28:31], v[176:179], a[200:203], v[28:31]
    v_mfma_f32_16x16x32_bf16 v[16:19], v[180:183], a[36:39], v[16:19]
    v_mfma_f32_16x16x32_bf16 v[20:23], v[180:183], a[92:95], v[20:23]
    v_mfma_f32_16x16x32_bf16 v[24:27], v[180:183], a[148:151], v[24:27]
    v_mfma_f32_16x16x32_bf16 v[28:31], v[180:183], a[204:207], v[28:31]
    v_mfma_f32_16x16x32_bf16 v[16:19], v[184:187], a[40:43], v[16:19]
    v_mfma_f32_16x16x32_bf16 v[20:23], v[184:187], a[96:99], v[20:23]
    v_mfma_f32_16x16x32_bf16 v[24:27], v[184:187], a[152:155], v[24:27]
    v_mfma_f32_16x16x32_bf16 v[28:31], v[184:187], a[208:211], v[28:31]
    v_mfma_f32_16x16x32_bf16 v[16:19], v[188:191], a[44:47], v[16:19]
    v_mfma_f32_16x16x32_bf16 v[20:23], v[188:191], a[100:103], v[20:23]
    v_mfma_f32_16x16x32_bf16 v[24:27], v[188:191], a[156:159], v[24:27]
    v_mfma_f32_16x16x32_bf16 v[28:31], v[188:191], a[212:215], v[28:31]
    v_mfma_f32_16x16x32_bf16 v[16:19], v[192:195], a[48:51], v[16:19]
    v_mfma_f32_16x16x32_bf16 v[20:23], v[192:195], a[104:107], v[20:23]
    v_mfma_f32_16x16x32_bf16 v[24:27], v[192:195], a[160:163], v[24:27]
    v_mfma_f32_16x16x32_bf16 v[28:31], v[192:195], a[216:219], v[28:31]
    v_mfma_f32_16x16x32_bf16 v[16:19], v[196:199], a[52:55], v[16:19]
    v_mfma_f32_16x16x32_bf16 v[20:23], v[196:199], a[108:111], v[20:23]
    v_mfma_f32_16x16x32_bf16 v[24:27], v[196:199], a[164:167], v[24:27]
    v_mfma_f32_16x16x32_bf16 v[28:31], v[196:199], a[220:223], v[28:31]
    v_add_u32 v9, 4096, v8
    v_cvt_pk_bf16_f32 v144, v16, v17
    v_cvt_pk_bf16_f32 v145, v18, v19
    v_cvt_pk_bf16_f32 v146, v20, v21
    v_cvt_pk_bf16_f32 v147, v22, v23
    global_store_dwordx4 v9, v[144:147], s[12:13] offset:0 sc1
    v_cvt_pk_bf16_f32 v148, v24, v25
    v_cvt_pk_bf16_f32 v149, v26, v27
    v_cvt_pk_bf16_f32 v150, v28, v29
    v_cvt_pk_bf16_f32 v151, v30, v31
    global_store_dwordx4 v9, v[148:151], s[12:13] offset:256 sc1
    s_waitcnt vmcnt(6)
    v_mfma_f32_16x16x32_bf16 v[16:19], v[200:203], a[0:3], 0
    v_mfma_f32_16x16x32_bf16 v[20:23], v[200:203], a[56:59], 0
    v_mfma_f32_16x16x32_bf16 v[24:27], v[200:203], a[112:115], 0
    v_mfma_f32_16x16x32_bf16 v[28:31], v[200:203], a[168:171], 0
    v_mfma_f32_16x16x32_bf16 v[16:19], v[204:207], a[4:7], v[16:19]
    v_mfma_f32_16x16x32_bf16 v[20:23], v[204:207], a[60:63], v[20:23]
    v_mfma_f32_16x16x32_bf16 v[24:27], v[204:207], a[116:119], v[24:27]
    v_mfma_f32_16x16x32_bf16 v[28:31], v[204:207], a[172:175], v[28:31]
    v_mfma_f32_16x16x32_bf16 v[16:19], v[208:211], a[8:11], v[16:19]
    v_mfma_f32_16x16x32_bf16 v[20:23], v[208:211], a[64:67], v[20:23]
    v_mfma_f32_16x16x32_bf16 v[24:27], v[208:211], a[120:123], v[24:27]
    v_mfma_f32_16x16x32_bf16 v[28:31], v[208:211], a[176:179], v[28:31]
    v_mfma_f32_16x16x32_bf16 v[16:19], v[212:215], a[12:15], v[16:19]
    v_mfma_f32_16x16x32_bf16 v[20:23], v[212:215], a[68:71], v[20:23]
    v_mfma_f32_16x16x32_bf16 v[24:27], v[212:215], a[124:127], v[24:27]
    v_mfma_f32_16x16x32_bf16 v[28:31], v[212:215], a[180:183], v[28:31]
    v_mfma_f32_16x16x32_bf16 v[16:19], v[216:219], a[16:19], v[16:19]
    v_mfma_f32_16x16x32_bf16 v[20:23], v[216:219], a[72:75], v[20:23]
    v_mfma_f32_16x16x32_bf16 v[24:27], v[216:219], a[128:131], v[24:27]
    v_mfma_f32_16x16x32_bf16 v[28:31], v[216:219], a[184:187], v[28:31]
    v_mfma_f32_16x16x32_bf16 v[16:19], v[220:223], a[20:23], v[16:19]
    v_mfma_f32_16x16x32_bf16 v[20:23], v[220:223], a[76:79], v[20:23]
    v_mfma_f32_16x16x32_bf16 v[24:27], v[220:223], a[132:135], v[24:27]
    v_mfma_f32_16x16x32_bf16 v[28:31], v[220:223], a[188:191], v[28:31]
    v_mfma_f32_16x16x32_bf16 v[16:19], v[224:227], a[24:27], v[16:19]
    v_mfma_f32_16x16x32_bf16 v[20:23], v[224:227], a[80:83], v[20:23]
    v_mfma_f32_16x16x32_bf16 v[24:27], v[224:227], a[136:139], v[24:27]
    v_mfma_f32_16x16x32_bf16 v[28:31], v[224:227], a[192:195], v[28:31]
    v_mfma_f32_16x16x32_bf16 v[16:19], v[228:231], a[28:31], v[16:19]
    v_mfma_f32_16x16x32_bf16 v[20:23], v[228:231], a[84:87], v[20:23]
    v_mfma_f32_16x16x32_bf16 v[24:27], v[228:231], a[140:143], v[24:27]
    v_mfma_f32_16x16x32_bf16 v[28:31], v[228:231], a[196:199], v[28:31]
    v_mfma_f32_16x16x32_bf16 v[16:19], v[232:235], a[32:35], v[16:19]
    v_mfma_f32_16x16x32_bf16 v[20:23], v[232:235], a[88:91], v[20:23]
    v_mfma_f32_16x16x32_bf16 v[24:27], v[232:235], a[144:147], v[24:27]
    v_mfma_f32_16x16x32_bf16 v[28:31], v[232:235], a[200:203], v[28:31]
    v_mfma_f32_16x16x32_bf16 v[16:19], v[236:239], a[36:39], v[16:19]
    v_mfma_f32_16x16x32_bf16 v[20:23], v[236:239], a[92:95], v[20:23]
    v_mfma_f32_16x16x32_bf16 v[24:27], v[236:239], a[148:151], v[24:27]
    v_mfma_f32_16x16x32_bf16 v[28:31], v[236:239], a[204:207], v[28:31]
    v_mfma_f32_16x16x32_bf16 v[16:19], v[240:243], a[40:43], v[16:19]
    v_mfma_f32_16x16x32_bf16 v[20:23], v[240:243], a[96:99], v[20:23]
    v_mfma_f32_16x16x32_bf16 v[24:27], v[240:243], a[152:155], v[24:27]
    v_mfma_f32_16x16x32_bf16 v[28:31], v[240:243], a[208:211], v[28:31]
    v_mfma_f32_16x16x32_bf16 v[16:19], v[244:247], a[44:47], v[16:19]
    v_mfma_f32_16x16x32_bf16 v[20:23], v[244:247], a[100:103], v[20:23]
    v_mfma_f32_16x16x32_bf16 v[24:27], v[244:247], a[156:159], v[24:27]
    v_mfma_f32_16x16x32_bf16 v[28:31], v[244:247], a[212:215], v[28:31]
    v_mfma_f32_16x16x32_bf16 v[16:19], v[248:251], a[48:51], v[16:19]
    v_mfma_f32_16x16x32_bf16 v[20:23], v[248:251], a[104:107], v[20:23]
    v_mfma_f32_16x16x32_bf16 v[24:27], v[248:251], a[160:163], v[24:27]
    v_mfma_f32_16x16x32_bf16 v[28:31], v[248:251], a[216:219], v[28:31]
    v_mfma_f32_16x16x32_bf16 v[16:19], v[252:255], a[52:55], v[16:19]
    v_mfma_f32_16x16x32_bf16 v[20:23], v[252:255], a[108:111], v[20:23]
    v_mfma_f32_16x16x32_bf16 v[24:27], v[252:255], a[164:167], v[24:27]
    v_mfma_f32_16x16x32_bf16 v[28:31], v[252:255], a[220:223], v[28:31]
    v_add_u32 v9, 266240, v8
    v_cvt_pk_bf16_f32 v200, v16, v17
    v_cvt_pk_bf16_f32 v201, v18, v19
    v_cvt_pk_bf16_f32 v202, v20, v21
    v_cvt_pk_bf16_f32 v203, v22, v23
    global_store_dwordx4 v9, v[200:203], s[12:13] offset:0 sc1
    v_cvt_pk_bf16_f32 v204, v24, v25
    v_cvt_pk_bf16_f32 v205, v26, v27
    v_cvt_pk_bf16_f32 v206, v28, v29
    v_cvt_pk_bf16_f32 v207, v30, v31
    global_store_dwordx4 v9, v[204:207], s[12:13] offset:256 sc1
    s_waitcnt vmcnt(0)
    s_barrier
    s_cmp_lg_u32 s3, 0
    s_cbranch_scc1 SG_13
    s_mov_b64 exec, 1
    v_mov_b32 v3, 15744
    v_mov_b32 v2, 1
    global_atomic_add v3, v2, s[18:19] sc1
    s_mov_b64 exec, -1
SG_13:
    s_branch P1_loop
P1_wt:
    s_sub_u32 s26, s26, 64
    s_lshr_b32 s27, s26, 1
    s_and_b32 s28, s26, 1
    s_lshl_b32 s29, s27, 7
    s_lshl_b32 s30, s28, 4
    s_add_u32 s29, s29, s30
    v_add_u32 v8, s29, v4
    v_mul_u32_u24 v8, 450, v8
    s_lshl_b32 s30, s3, 2
    v_add_u32 v9, s30, v5
    s_lshr_b32 s30, s27, 2
    s_lshl_b32 s30, s30, 1
    s_add_u32 s30, s30, s28
    s_lshl_b32 s30, s30, 10
    s_and_b32 s31, s27, 3
    s_lshl_b32 s31, s31, 8
    s_add_u32 s30, s30, s31
    s_add_u32 s30, s30, 20611072
    v_lshlrev_b32 v10, 4, v4
    v_add_u32 v10, s30, v10
    s_mov_b32 s31, 3
WT_loop:
    v_add_u32 v11, 0, v9
    v_min_u32 v11, 224, v11
    v_lshl_add_u32 v11, v11, 1, v8
    global_load_ushort v32, v11, s[6:7]
    global_load_ushort v36, v11, s[8:9]
    v_add_u32 v11, 14400, v11
    global_load_ushort v33, v11, s[6:7]
    global_load_ushort v37, v11, s[8:9]
    v_add_u32 v11, 14400, v11
    global_load_ushort v34, v11, s[6:7]
    global_load_ushort v38, v11, s[8:9]
    v_add_u32 v11, 14400, v11
    global_load_ushort v35, v11, s[6:7]
    global_load_ushort v39, v11, s[8:9]
    v_add_u32 v11, 16, v9
    v_min_u32 v11, 224, v11
    v_lshl_add_u32 v11, v11, 1, v8
    global_load_ushort v40, v11, s[6:7]
    global_load_ushort v44, v11, s[8:9]
    v_add_u32 v11, 14400, v11
    global_load_ushort v41, v11, s[6:7]
    global_load_ushort v45, v11, s[8:9]
    v_add_u32 v11, 14400, v11
    global_load_ushort v42, v11, s[6:7]
    global_load_ushort v46, v11, s[8:9]
    v_add_u32 v11, 14400, v11
    global_load_ushort v43, v11, s[6:7]
    global_load_ushort v47, v11, s[8:9]
    v_add_u32 v11, 32, v9
    v_min_u32 v11, 224, v11
    v_lshl_add_u32 v11, v11, 1, v8
    global_load_ushort v48, v11, s[6:7]
    global_load_ushort v52, v11, s[8:9]
    v_add_u32 v11, 14400, v11
    global_load_ushort v49, v11, s[6:7]
    global_load_ushort v53, v11, s[8:9]
    v_add_u32 v11, 14400, v11
    global_load_ushort v50, v11, s[6:7]
    global_load_ushort v54, v11, s[8:9]
    v_add_u32 v11, 14400, v11
    global_load_ushort v51, v11, s[6:7]
    global_load_ushort v55, v11, s[8:9]
    v_add_u32 v11, 48, v9
    v_min_u32 v11, 224, v11
    v_lshl_add_u32 v11, v11, 1, v8
    global_load_ushort v56, v11, s[6:7]
    global_load_ushort v60, v11, s[8:9]
    v_add_u32 v11, 14400, v11
    global_load_ushort v57, v11, s[6:7]
    global_load_ushort v61, v11, s[8:9]
    v_add_u32 v11, 14400, v11
    global_load_ushort v58, v11, s[6:7]
    global_load_ushort v62, v11, s[8:9]
    v_add_u32 v11, 14400, v11
    global_load_ushort v59, v11, s[6:7]
    global_load_ushort v63, v11, s[8:9]
    v_add_u32 v11, 64, v9
    v_min_u32 v11, 224, v11
    v_lshl_add_u32 v11, v11, 1, v8
    global_load_ushort v64, v11, s[6:7]
    global_load_ushort v68, v11, s[8:9]
    v_add_u32 v11, 14400, v11
    global_load_ushort v65, v11, s[6:7]
    global_load_ushort v69, v11, s[8:9]
    v_add_u32 v11, 14400, v11
    global_load_ushort v66, v11, s[6:7]
    global_load_ushort v70, v11, s[8:9]
    v_add_u32 v11, 14400, v11
    global_load_ushort v67, v11, s[6:7]
    global_load_ushort v71, v11, s[8:9]
    s_waitcnt vmcnt(0)
    v_add_u32 v11, 0, v9
    v_cmp_gt_u32 vcc, 225, v11
    v_lshl_or_b32 v32, v36, 16, v32
    v_lshl_or_b32 v33, v37, 16, v33
    v_lshl_or_b32 v34, v38, 16, v34
    v_lshl_or_b32 v35, v39, 16, v35
    v_cndmask_b32 v32, 0, v32, vcc
    v_cndmask_b32 v33, 0, v33, vcc
    v_cndmask_b32 v34, 0, v34, vcc
    v_cndmask_b32 v35, 0, v35, vcc
    v_lshl_add_u32 v12, v11, 13, v10
    v_cmp_gt_u32 vcc, 228, v11
    s_and_b64 exec, exec, vcc
    global_store_dwordx4 v12, v[32:35], s[12:13] sc1
    s_mov_b64 exec, -1
    v_add_u32 v11, 16, v9
    v_cmp_gt_u32 vcc, 225, v11
    v_lshl_or_b32 v40, v44, 16, v40
    v_lshl_or_b32 v41, v45, 16, v41
    v_lshl_or_b32 v42, v46, 16, v42
    v_lshl_or_b32 v43, v47, 16, v43
    v_cndmask_b32 v40, 0, v40, vcc
    v_cndmask_b32 v41, 0, v41, vcc
    v_cndmask_b32 v42, 0, v42, vcc
    v_cndmask_b32 v43, 0, v43, vcc
    v_lshl_add_u32 v12, v11, 13, v10
    v_cmp_gt_u32 vcc, 228, v11
    s_and_b64 exec, exec, vcc
    global_store_dwordx4 v12, v[40:43], s[12:13] sc1
    s_mov_b64 exec, -1
    v_add_u32 v11, 32, v9
    v_cmp_gt_u32 vcc, 225, v11
    v_lshl_or_b32 v48, v52, 16, v48
    v_lshl_or_b32 v49, v53, 16, v49
    v_lshl_or_b32 v50, v54, 16, v50
    v_lshl_or_b32 v51, v55, 16, v51
    v_cndmask_b32 v48, 0, v48, vcc
    v_cndmask_b32 v49, 0, v49, vcc
    v_cndmask_b32 v50, 0, v50, vcc
    v_cndmask_b32 v51, 0, v51, vcc
    v_lshl_add_u32 v12, v11, 13, v10
    v_cmp_gt_u32 vcc, 228, v11
    s_and_b64 exec, exec, vcc
    global_store_dwordx4 v12, v[48:51], s[12:13] sc1
    s_mov_b64 exec, -1
    v_add_u32 v11, 48, v9
    v_cmp_gt_u32 vcc, 225, v11
    v_lshl_or_b32 v56, v60, 16, v56
    v_lshl_or_b32 v57, v61, 16, v57
    v_lshl_or_b32 v58, v62, 16, v58
    v_lshl_or_b32 v59, v63, 16, v59
    v_cndmask_b32 v56, 0, v56, vcc
    v_cndmask_b32 v57, 0, v57, vcc
    v_cndmask_b32 v58, 0, v58, vcc
    v_cndmask_b32 v59, 0, v59, vcc
    v_lshl_add_u32 v12, v11, 13, v10
    v_cmp_gt_u32 vcc, 228, v11
    s_and_b64 exec, exec, vcc
    global_store_dwordx4 v12, v[56:59], s[12:13] sc1
    s_mov_b64 exec, -1
    v_add_u32 v11, 64, v9
    v_cmp_gt_u32 vcc, 225, v11
    v_lshl_or_b32 v64, v68, 16, v64
    v_lshl_or_b32 v65, v69, 16, v65
    v_lshl_or_b32 v66, v70, 16, v66
    v_lshl_or_b32 v67, v71, 16, v67
    v_cndmask_b32 v64, 0, v64, vcc
    v_cndmask_b32 v65, 0, v65, vcc
    v_cndmask_b32 v66, 0, v66, vcc
    v_cndmask_b32 v67, 0, v67, vcc
    v_lshl_add_u32 v12, v11, 13, v10
    v_cmp_gt_u32 vcc, 228, v11
    s_and_b64 exec, exec, vcc
    global_store_dwordx4 v12, v[64:67], s[12:13] sc1
    s_mov_b64 exec, -1
    v_add_u32 v9, 80, v9
    s_sub_u32 s31, s31, 1
    s_cmp_lg_u32 s31, 0
    s_cbranch_scc1 WT_loop
    s_waitcnt vmcnt(0)
    s_barrier
    s_cmp_lg_u32 s3, 0
    s_cbranch_scc1 SG_14
    s_mov_b64 exec, 1
    v_mov_b32 v3, 15744
    v_mov_b32 v2, 1
    global_atomic_add v3, v2, s[18:19] sc1
    s_mov_b64 exec, -1
SG_14:
    s_branch P1_loop
P2_start:
    s_mov_b32 s27, 0
P2_loop:
    s_cmp_lg_u32 s3, 0
    s_cbranch_scc1 BC_15
    s_mov_b64 exec, 1
    v_mov_b32 v3, 15488
    v_mov_b32 v2, 1
    global_atomic_add v2, v3, v2, s[18:19] sc0 sc1
    s_waitcnt vmcnt(0)
    v_mov_b32 v3, 163592
    ds_write_b32 v3, v2
    s_mov_b64 exec, -1
    s_waitcnt lgkmcnt(0)
BC_15:
    s_barrier
    v_mov_b32 v3, 163592
    ds_read_b32 v2, v3
    s_waitcnt lgkmcnt(0)
    v_readfirstlane_b32 s26, v2
    s_cmp_ge_u32 s26, 57
    s_cbranch_scc1 P3_loop
    s_cmp_lg_u32 s27, 0
    s_cbranch_scc1 P2_go
    s_mov_b32 s27, 1
    v_add_f32 v8, 0x0, v6
    v_mul_f32 v8, 0x3c800000, v8
    v_mul_f32 v9, 4.0, v7
    v_mul_f32 v9, v9, v8
    v_fmamk_f32 v10, v8, 0x0, v9
    v_fmamk_f32 v11, v8, 0x3f800000, v9
    v_fmamk_f32 v12, v8, 0x40000000, v9
    v_fmamk_f32 v13, v8, 0x40400000, v9
    v_cos_f32 v16, v10
    v_cos_f32 v17, v11
    v_cos_f32 v18, v12
    v_cos_f32 v19, v13
    v_sin_f32 v20, v10
    v_sin_f32 v21, v11
    v_sin_f32 v22, v12
    v_sin_f32 v23, v13
    v_cvt_pk_bf16_f32 v12, v16, v17
    v_cvt_pk_bf16_f32 v13, v18, v19
    v_cvt_pk_bf16_f32 v10, -v20, -v21
    v_cvt_pk_bf16_f32 v11, -v22, -v23
    v_cvt_pk_bf16_f32 v14, v20, v21
    v_cvt_pk_bf16_f32 v15, v22, v23
    v_accvgpr_write_b32 a0, v10
    v_accvgpr_write_b32 a1, v11
    v_accvgpr_write_b32 a2, v12
    v_accvgpr_write_b32 a3, v13
    v_accvgpr_write_b32 a4, v14
    v_accvgpr_write_b32 a5, v15
    v_fmamk_f32 v10, v8, 0x41800000, v9
    v_fmamk_f32 v11, v8, 0x41880000, v9
    v_fmamk_f32 v12, v8, 0x41900000, v9
    v_fmamk_f32 v13, v8, 0x41980000, v9
    v_cos_f32 v16, v10
    v_cos_f32 v17, v11
    v_cos_f32 v18, v12
    v_cos_f32 v19, v13
    v_sin_f32 v20, v10
    v_sin_f32 v21, v11
    v_sin_f32 v22, v12
    v_sin_f32 v23, v13
    v_cvt_pk_bf16_f32 v12, v16, v17
    v_cvt_pk_bf16_f32 v13, v18, v19
    v_cvt_pk_bf16_f32 v10, -v20, -v21
    v_cvt_pk_bf16_f32 v11, -v22, -v23
    v_cvt_pk_bf16_f32 v14, v20, v21
    v_cvt_pk_bf16_f32 v15, v22, v23
    v_accvgpr_write_b32 a6, v10
    v_accvgpr_write_b32 a7, v11
    v_accvgpr_write_b32 a8, v12
    v_accvgpr_write_b32 a9, v13
    v_accvgpr_write_b32 a10, v14
    v_accvgpr_write_b32 a11, v15
    v_fmamk_f32 v10, v8, 0x42000000, v9
    v_fmamk_f32 v11, v8, 0x42040000, v9
    v_fmamk_f32 v12, v8, 0x42080000, v9
    v_fmamk_f32 v13, v8, 0x420c0000, v9
    v_cos_f32 v16, v10
    v_cos_f32 v17, v11
    v_cos_f32 v18, v12
    v_cos_f32 v19, v13
    v_sin_f32 v20, v10
    v_sin_f32 v21, v11
    v_sin_f32 v22, v12
    v_sin_f32 v23, v13
    v_cvt_pk_bf16_f32 v12, v16, v17
    v_cvt_pk_bf16_f32 v13, v18, v19
    v_cvt_pk_bf16_f32 v10, -v20, -v21
    v_cvt_pk_bf16_f32 v11, -v22, -v23
    v_cvt_pk_bf16_f32 v14, v20, v21
    v_cvt_pk_bf16_f32 v15, v22, v23
    v_accvgpr_write_b32 a12, v10
    v_accvgpr_write_b32 a13, v11
    v_accvgpr_write_b32 a14, v12
    v_accvgpr_write_b32 a15, v13
    v_accvgpr_write_b32 a16, v14
    v_accvgpr_write_b32 a17, v15
    v_fmamk_f32 v10, v8, 0x42400000, v9
    v_fmamk_f32 v11, v8, 0x42440000, v9
    v_fmamk_f32 v12, v8, 0x42480000, v9
    v_fmamk_f32 v13, v8, 0x424c0000, v9
    v_cos_f32 v16, v10
    v_cos_f32 v17, v11
    v_cos_f32 v18, v12
    v_cos_f32 v19, v13
    v_sin_f32 v20, v10
    v_sin_f32 v21, v11
    v_sin_f32 v22, v12
    v_sin_f32 v23, v13
    v_cvt_pk_bf16_f32 v12, v16, v17
    v_cvt_pk_bf16_f32 v13, v18, v19
    v_cvt_pk_bf16_f32 v10, -v20, -v21
    v_cvt_pk_bf16_f32 v11, -v22, -v23
    v_cvt_pk_bf16_f32 v14, v20, v21
    v_cvt_pk_bf16_f32 v15, v22, v23
    v_accvgpr_write_b32 a18, v10
    v_accvgpr_write_b32 a19, v11
    v_accvgpr_write_b32 a20, v12
    v_accvgpr_write_b32 a21, v13
    v_accvgpr_write_b32 a22, v14
    v_accvgpr_write_b32 a23, v15
    v_add_f32 v8, 0x41800000, v6
    v_mul_f32 v8, 0x3c800000, v8
    v_mul_f32 v9, 4.0, v7
    v_mul_f32 v9, v9, v8
    v_fmamk_f32 v10, v8, 0x0, v9
    v_fmamk_f32 v11, v8, 0x3f800000, v9
    v_fmamk_f32 v12, v8, 0x40000000, v9
    v_fmamk_f32 v13, v8, 0x40400000, v9
    v_cos_f32 v16, v10
    v_cos_f32 v17, v11
    v_cos_f32 v18, v12
    v_cos_f32 v19, v13
    v_sin_f32 v20, v10
    v_sin_f32 v21, v11
    v_sin_f32 v22, v12
    v_sin_f32 v23, v13
    v_cvt_pk_bf16_f32 v12, v16, v17
    v_cvt_pk_bf16_f32 v13, v18, v19
    v_cvt_pk_bf16_f32 v10, -v20, -v21
    v_cvt_pk_bf16_f32 v11, -v22, -v23
    v_cvt_pk_bf16_f32 v14, v20, v21
    v_cvt_pk_bf16_f32 v15, v22, v23
    v_accvgpr_write_b32 a24, v10
    v_accvgpr_write_b32 a25, v11
    v_accvgpr_write_b32 a26, v12
    v_accvgpr_write_b32 a27, v13
    v_accvgpr_write_b32 a28, v14
    v_accvgpr_write_b32 a29, v15
    v_fmamk_f32 v10, v8, 0x41800000, v9
    v_fmamk_f32 v11, v8, 0x41880000, v9
    v_fmamk_f32 v12, v8, 0x41900000, v9
    v_fmamk_f32 v13, v8, 0x41980000, v9
    v_cos_f32 v16, v10
    v_cos_f32 v17, v11
    v_cos_f32 v18, v12
    v_cos_f32 v19, v13
    v_sin_f32 v20, v10
    v_sin_f32 v21, v11
    v_sin_f32 v22, v12
    v_sin_f32 v23, v13
    v_cvt_pk_bf16_f32 v12, v16, v17
    v_cvt_pk_bf16_f32 v13, v18, v19
    v_cvt_pk_bf16_f32 v10, -v20, -v21
    v_cvt_pk_bf16_f32 v11, -v22, -v23
    v_cvt_pk_bf16_f32 v14, v20, v21
    v_cvt_pk_bf16_f32 v15, v22, v23
    v_accvgpr_write_b32 a30, v10
    v_accvgpr_write_b32 a31, v11
    v_accvgpr_write_b32 a32, v12
    v_accvgpr_write_b32 a33, v13
    v_accvgpr_write_b32 a34, v14
    v_accvgpr_write_b32 a35, v15
    v_fmamk_f32 v10, v8, 0x42000000, v9
    v_fmamk_f32 v11, v8, 0x42040000, v9
    v_fmamk_f32 v12, v8, 0x42080000, v9
    v_fmamk_f32 v13, v8, 0x420c0000, v9
    v_cos_f32 v16, v10
    v_cos_f32 v17, v11
    v_cos_f32 v18, v12
    v_cos_f32 v19, v13
    v_sin_f32 v20, v10
    v_sin_f32 v21, v11
    v_sin_f32 v22, v12
    v_sin_f32 v23, v13
    v_cvt_pk_bf16_f32 v12, v16, v17
    v_cvt_pk_bf16_f32 v13, v18, v19
    v_cvt_pk_bf16_f32 v10, -v20, -v21
    v_cvt_pk_bf16_f32 v11, -v22, -v23
    v_cvt_pk_bf16_f32 v14, v20, v21
    v_cvt_pk_bf16_f32 v15, v22, v23
    v_accvgpr_write_b32 a36, v10
    v_accvgpr_write_b32 a37, v11
    v_accvgpr_write_b32 a38, v12
    v_accvgpr_write_b32 a39, v13
    v_accvgpr_write_b32 a40, v14
    v_accvgpr_write_b32 a41, v15
    v_fmamk_f32 v10, v8, 0x42400000, v9
    v_fmamk_f32 v11, v8, 0x42440000, v9
    v_fmamk_f32 v12, v8, 0x42480000, v9
    v_fmamk_f32 v13, v8, 0x424c0000, v9
    v_cos_f32 v16, v10
    v_cos_f32 v17, v11
    v_cos_f32 v18, v12
    v_cos_f32 v19, v13
    v_sin_f32 v20, v10
    v_sin_f32 v21, v11
    v_sin_f32 v22, v12
    v_sin_f32 v23, v13
    v_cvt_pk_bf16_f32 v12, v16, v17
    v_cvt_pk_bf16_f32 v13, v18, v19
    v_cvt_pk_bf16_f32 v10, -v20, -v21
    v_cvt_pk_bf16_f32 v11, -v22, -v23
    v_cvt_pk_bf16_f32 v14, v20, v21
    v_cvt_pk_bf16_f32 v15, v22, v23
    v_accvgpr_write_b32 a42, v10
    v_accvgpr_write_b32 a43, v11
    v_accvgpr_write_b32 a44, v12
    v_accvgpr_write_b32 a45, v13
    v_accvgpr_write_b32 a46, v14
    v_accvgpr_write_b32 a47, v15
    v_add_f32 v8, 0x42000000, v6
    v_mul_f32 v8, 0x3c800000, v8
    v_mul_f32 v9, 4.0, v7
    v_mul_f32 v9, v9, v8
    v_fmamk_f32 v10, v8, 0x0, v9
    v_fmamk_f32 v11, v8, 0x3f800000, v9
    v_fmamk_f32 v12, v8, 0x40000000, v9
    v_fmamk_f32 v13, v8, 0x40400000, v9
    v_cos_f32 v16, v10
    v_cos_f32 v17, v11
    v_cos_f32 v18, v12
    v_cos_f32 v19, v13
    v_sin_f32 v20, v10
    v_sin_f32 v21, v11
    v_sin_f32 v22, v12
    v_sin_f32 v23, v13
    v_cvt_pk_bf16_f32 v12, v16, v17
    v_cvt_pk_bf16_f32 v13, v18, v19
    v_cvt_pk_bf16_f32 v10, -v20, -v21
    v_cvt_pk_bf16_f32 v11, -v22, -v23
    v_cvt_pk_bf16_f32 v14, v20, v21
    v_cvt_pk_bf16_f32 v15, v22, v23
    v_accvgpr_write_b32 a48, v10
    v_accvgpr_write_b32 a49, v11
    v_accvgpr_write_b32 a50, v12
    v_accvgpr_write_b32 a51, v13
    v_accvgpr_write_b32 a52, v14
    v_accvgpr_write_b32 a53, v15
    v_fmamk_f32 v10, v8, 0x41800000, v9
    v_fmamk_f32 v11, v8, 0x41880000, v9
    v_fmamk_f32 v12, v8, 0x41900000, v9
    v_fmamk_f32 v13, v8, 0x41980000, v9
    v_cos_f32 v16, v10
    v_cos_f32 v17, v11
    v_cos_f32 v18, v12
    v_cos_f32 v19, v13
    v_sin_f32 v20, v10
    v_sin_f32 v21, v11
    v_sin_f32 v22, v12
    v_sin_f32 v23, v13
    v_cvt_pk_bf16_f32 v12, v16, v17
    v_cvt_pk_bf16_f32 v13, v18, v19
    v_cvt_pk_bf16_f32 v10, -v20, -v21
    v_cvt_pk_bf16_f32 v11, -v22, -v23
    v_cvt_pk_bf16_f32 v14, v20, v21
    v_cvt_pk_bf16_f32 v15, v22, v23
    v_accvgpr_write_b32 a54, v10
    v_accvgpr_write_b32 a55, v11
    v_accvgpr_write_b32 a56, v12
    v_accvgpr_write_b32 a57, v13
    v_accvgpr_write_b32 a58, v14
    v_accvgpr_write_b32 a59, v15
    v_fmamk_f32 v10, v8, 0x42000000, v9
    v_fmamk_f32 v11, v8, 0x42040000, v9
    v_fmamk_f32 v12, v8, 0x42080000, v9
    v_fmamk_f32 v13, v8, 0x420c0000, v9
    v_cos_f32 v16, v10
    v_cos_f32 v17, v11
    v_cos_f32 v18, v12
    v_cos_f32 v19, v13
    v_sin_f32 v20, v10
    v_sin_f32 v21, v11
    v_sin_f32 v22, v12
    v_sin_f32 v23, v13
    v_cvt_pk_bf16_f32 v12, v16, v17
    v_cvt_pk_bf16_f32 v13, v18, v19
    v_cvt_pk_bf16_f32 v10, -v20, -v21
    v_cvt_pk_bf16_f32 v11, -v22, -v23
    v_cvt_pk_bf16_f32 v14, v20, v21
    v_cvt_pk_bf16_f32 v15, v22, v23
    v_accvgpr_write_b32 a60, v10
    v_accvgpr_write_b32 a61, v11
    v_accvgpr_write_b32 a62, v12
    v_accvgpr_write_b32 a63, v13
    v_accvgpr_write_b32 a64, v14
    v_accvgpr_write_b32 a65, v15
    v_fmamk_f32 v10, v8, 0x42400000, v9
    v_fmamk_f32 v11, v8, 0x42440000, v9
    v_fmamk_f32 v12, v8, 0x42480000, v9
    v_fmamk_f32 v13, v8, 0x424c0000, v9
    v_cos_f32 v16, v10
    v_cos_f32 v17, v11
    v_cos_f32 v18, v12
    v_cos_f32 v19, v13
    v_sin_f32 v20, v10
    v_sin_f32 v21, v11
    v_sin_f32 v22, v12
    v_sin_f32 v23, v13
    v_cvt_pk_bf16_f32 v12, v16, v17
    v_cvt_pk_bf16_f32 v13, v18, v19
    v_cvt_pk_bf16_f32 v10, -v20, -v21
    v_cvt_pk_bf16_f32 v11, -v22, -v23
    v_cvt_pk_bf16_f32 v14, v20, v21
    v_cvt_pk_bf16_f32 v15, v22, v23
    v_accvgpr_write_b32 a66, v10
    v_accvgpr_write_b32 a67, v11
    v_accvgpr_write_b32 a68, v12
    v_accvgpr_write_b32 a69, v13
    v_accvgpr_write_b32 a70, v14
    v_accvgpr_write_b32 a71, v15
    v_add_f32 v8, 0x42400000, v6
    v_mul_f32 v8, 0x3c800000, v8
    v_mul_f32 v9, 4.0, v7
    v_mul_f32 v9, v9, v8
    v_fmamk_f32 v10, v8, 0x0, v9
    v_fmamk_f32 v11, v8, 0x3f800000, v9
    v_fmamk_f32 v12, v8, 0x40000000, v9
    v_fmamk_f32 v13, v8, 0x40400000, v9
    v_cos_f32 v16, v10
    v_cos_f32 v17, v11
    v_cos_f32 v18, v12
    v_cos_f32 v19, v13
    v_sin_f32 v20, v10
    v_sin_f32 v21, v11
    v_sin_f32 v22, v12
    v_sin_f32 v23, v13
    v_cvt_pk_bf16_f32 v12, v16, v17
    v_cvt_pk_bf16_f32 v13, v18, v19
    v_cvt_pk_bf16_f32 v10, -v20, -v21
    v_cvt_pk_bf16_f32 v11, -v22, -v23
    v_cvt_pk_bf16_f32 v14, v20, v21
    v_cvt_pk_bf16_f32 v15, v22, v23
    v_accvgpr_write_b32 a72, v10
    v_accvgpr_write_b32 a73, v11
    v_accvgpr_write_b32 a74, v12
    v_accvgpr_write_b32 a75, v13
    v_accvgpr_write_b32 a76, v14
    v_accvgpr_write_b32 a77, v15
    v_fmamk_f32 v10, v8, 0x41800000, v9
    v_fmamk_f32 v11, v8, 0x41880000, v9
    v_fmamk_f32 v12, v8, 0x41900000, v9
    v_fmamk_f32 v13, v8, 0x41980000, v9
    v_cos_f32 v16, v10
    v_cos_f32 v17, v11
    v_cos_f32 v18, v12
    v_cos_f32 v19, v13
    v_sin_f32 v20, v10
    v_sin_f32 v21, v11
    v_sin_f32 v22, v12
    v_sin_f32 v23, v13
    v_cvt_pk_bf16_f32 v12, v16, v17
    v_cvt_pk_bf16_f32 v13, v18, v19
    v_cvt_pk_bf16_f32 v10, -v20, -v21
    v_cvt_pk_bf16_f32 v11, -v22, -v23
    v_cvt_pk_bf16_f32 v14, v20, v21
    v_cvt_pk_bf16_f32 v15, v22, v23
    v_accvgpr_write_b32 a78, v10
    v_accvgpr_write_b32 a79, v11
    v_accvgpr_write_b32 a80, v12
    v_accvgpr_write_b32 a81, v13
    v_accvgpr_write_b32 a82, v14
    v_accvgpr_write_b32 a83, v15
    v_fmamk_f32 v10, v8, 0x42000000, v9
    v_fmamk_f32 v11, v8, 0x42040000, v9
    v_fmamk_f32 v12, v8, 0x42080000, v9
    v_fmamk_f32 v13, v8, 0x420c0000, v9
    v_cos_f32 v16, v10
    v_cos_f32 v17, v11
    v_cos_f32 v18, v12
    v_cos_f32 v19, v13
    v_sin_f32 v20, v10
    v_sin_f32 v21, v11
    v_sin_f32 v22, v12
    v_sin_f32 v23, v13
    v_cvt_pk_bf16_f32 v12, v16, v17
    v_cvt_pk_bf16_f32 v13, v18, v19
    v_cvt_pk_bf16_f32 v10, -v20, -v21
    v_cvt_pk_bf16_f32 v11, -v22, -v23
    v_cvt_pk_bf16_f32 v14, v20, v21
    v_cvt_pk_bf16_f32 v15, v22, v23
    v_accvgpr_write_b32 a84, v10
    v_accvgpr_write_b32 a85, v11
    v_accvgpr_write_b32 a86, v12
    v_accvgpr_write_b32 a87, v13
    v_accvgpr_write_b32 a88, v14
    v_accvgpr_write_b32 a89, v15
    v_fmamk_f32 v10, v8, 0x42400000, v9
    v_fmamk_f32 v11, v8, 0x42440000, v9
    v_fmamk_f32 v12, v8, 0x42480000, v9
    v_fmamk_f32 v13, v8, 0x424c0000, v9
    v_cos_f32 v16, v10
    v_cos_f32 v17, v11
    v_cos_f32 v18, v12
    v_cos_f32 v19, v13
    v_sin_f32 v20, v10
    v_sin_f32 v21, v11
    v_sin_f32 v22, v12
    v_sin_f32 v23, v13
    v_cvt_pk_bf16_f32 v12, v16, v17
    v_cvt_pk_bf16_f32 v13, v18, v19
    v_cvt_pk_bf16_f32 v10, -v20, -v21
    v_cvt_pk_bf16_f32 v11, -v22, -v23
    v_cvt_pk_bf16_f32 v14, v20, v21
    v_cvt_pk_bf16_f32 v15, v22, v23
    v_accvgpr_write_b32 a90, v10
    v_accvgpr_write_b32 a91, v11
    v_accvgpr_write_b32 a92, v12
    v_accvgpr_write_b32 a93, v13
    v_accvgpr_write_b32 a94, v14
    v_accvgpr_write_b32 a95, v15
    v_add_f32 v8, 0x0, v6
    v_mul_f32 v8, 0x3d000000, v8
    v_mul_f32 v9, 4.0, v7
    v_mul_f32 v9, v9, v8
    v_fmamk_f32 v10, v8, 0x0, v9
    v_fmamk_f32 v11, v8, 0x3f800000, v9
    v_fmamk_f32 v12, v8, 0x40000000, v9
    v_fmamk_f32 v13, v8, 0x40400000, v9
    v_cos_f32 v16, v10
    v_cos_f32 v17, v11
    v_cos_f32 v18, v12
    v_cos_f32 v19, v13
    v_sin_f32 v20, v10
    v_sin_f32 v21, v11
    v_sin_f32 v22, v12
    v_sin_f32 v23, v13
    v_cvt_pk_bf16_f32 v12, v16, v17
    v_cvt_pk_bf16_f32 v13, v18, v19
    v_cvt_pk_bf16_f32 v10, -v20, -v21
    v_cvt_pk_bf16_f32 v11, -v22, -v23
    v_cvt_pk_bf16_f32 v14, v20, v21
    v_cvt_pk_bf16_f32 v15, v22, v23
    v_accvgpr_write_b32 a96, v10
    v_accvgpr_write_b32 a97, v11
    v_accvgpr_write_b32 a98, v12
    v_accvgpr_write_b32 a99, v13
    v_accvgpr_write_b32 a100, v14
    v_accvgpr_write_b32 a101, v15
    v_fmamk_f32 v10, v8, 0x41800000, v9
    v_fmamk_f32 v11, v8, 0x41880000, v9
    v_fmamk_f32 v12, v8, 0x41900000, v9
    v_fmamk_f32 v13, v8, 0x41980000, v9
    v_cos_f32 v16, v10
    v_cos_f32 v17, v11
    v_cos_f32 v18, v12
    v_cos_f32 v19, v13
    v_sin_f32 v20, v10
    v_sin_f32 v21, v11
    v_sin_f32 v22, v12
    v_sin_f32 v23, v13
    v_cvt_pk_bf16_f32 v12, v16, v17
    v_cvt_pk_bf16_f32 v13, v18, v19
    v_cvt_pk_bf16_f32 v10, -v20, -v21
    v_cvt_pk_bf16_f32 v11, -v22, -v23
    v_cvt_pk_bf16_f32 v14, v20, v21
    v_cvt_pk_bf16_f32 v15, v22, v23
    v_accvgpr_write_b32 a102, v10
    v_accvgpr_write_b32 a103, v11
    v_accvgpr_write_b32 a104, v12
    v_accvgpr_write_b32 a105, v13
    v_accvgpr_write_b32 a106, v14
    v_accvgpr_write_b32 a107, v15
    v_add_f32 v8, 0x41800000, v6
    v_mul_f32 v8, 0x3d000000, v8
    v_mul_f32 v9, 4.0, v7
    v_mul_f32 v9, v9, v8
    v_fmamk_f32 v10, v8, 0x0, v9
    v_fmamk_f32 v11, v8, 0x3f800000, v9
    v_fmamk_f32 v12, v8, 0x40000000, v9
    v_fmamk_f32 v13, v8, 0x40400000, v9
    v_cos_f32 v16, v10
    v_cos_f32 v17, v11
    v_cos_f32 v18, v12
    v_cos_f32 v19, v13
    v_sin_f32 v20, v10
    v_sin_f32 v21, v11
    v_sin_f32 v22, v12
    v_sin_f32 v23, v13
    v_cvt_pk_bf16_f32 v12, v16, v17
    v_cvt_pk_bf16_f32 v13, v18, v19
    v_cvt_pk_bf16_f32 v10, -v20, -v21
    v_cvt_pk_bf16_f32 v11, -v22, -v23
    v_cvt_pk_bf16_f32 v14, v20, v21
    v_cvt_pk_bf16_f32 v15, v22, v23
    v_accvgpr_write_b32 a108, v10
    v_accvgpr_write_b32 a109, v11
    v_accvgpr_write_b32 a110, v12
    v_accvgpr_write_b32 a111, v13
    v_accvgpr_write_b32 a112, v14
    v_accvgpr_write_b32 a113, v15
    v_fmamk_f32 v10, v8, 0x41800000, v9
    v_fmamk_f32 v11, v8, 0x41880000, v9
    v_fmamk_f32 v12, v8, 0x41900000, v9
    v_fmamk_f32 v13, v8, 0x41980000, v9
    v_cos_f32 v16, v10
    v_cos_f32 v17, v11
    v_cos_f32 v18, v12
    v_cos_f32 v19, v13
    v_sin_f32 v20, v10
    v_sin_f32 v21, v11
    v_sin_f32 v22, v12
    v_sin_f32 v23, v13
    v_cvt_pk_bf16_f32 v12, v16, v17
    v_cvt_pk_bf16_f32 v13, v18, v19
    v_cvt_pk_bf16_f32 v10, -v20, -v21
    v_cvt_pk_bf16_f32 v11, -v22, -v23
    v_cvt_pk_bf16_f32 v14, v20, v21
    v_cvt_pk_bf16_f32 v15, v22, v23
    v_accvgpr_write_b32 a114, v10
    v_accvgpr_write_b32 a115, v11
    v_accvgpr_write_b32 a116, v12
    v_accvgpr_write_b32 a117, v13
    v_accvgpr_write_b32 a118, v14
    v_accvgpr_write_b32 a119, v15
    s_cmp_lg_u32 s3, 0
    s_cbranch_scc1 WC_16
    v_mov_b32 v3, 15744
    s_mov_b32 s24, 524288
WP_17:
    global_load_dword v2, v3, s[18:19] sc1
    s_sub_u32 s24, s24, 1
    s_cbranch_scc1 BAIL_1
    s_waitcnt vmcnt(0)
    v_readfirstlane_b32 s25, v2
    s_cmp_ge_u32 s25, 96
    s_cbranch_scc1 WC_16
    s_sleep 4
    s_branch WP_17
WC_16:
    s_barrier
P2_go:
    s_lshl_b32 s28, s26, 2
    s_add_u32 s28, s28, s3
    s_lshl_b32 s29, s28, 4
    s_add_u32 s29, s29, 18513920
    v_lshlrev_b32 v8, 12, v0
    v_add_u32 v8, s29, v8
    s_lshl_b32 s29, s28, 13
    s_add_u32 s29, s29, 20615168
    v_add_u32 v9, s29, v1
    global_load_dwordx4 v[32:35], v8, s[12:13] sc1
    v_add_u32 v8, 0x40000, v8
    global_load_dwordx4 v[36:39], v8, s[12:13] sc1
    v_add_u32 v8, 0x40000, v8
    global_load_dwordx4 v[40:43], v8, s[12:13] sc1
    v_add_u32 v8, 0x40000, v8
    global_load_dwordx4 v[44:47], v8, s[12:13] sc1
    v_add_u32 v8, 0x40000, v8
    global_load_dwordx4 v[48:51], v8, s[12:13] sc1
    v_add_u32 v8, 0x40000, v8
    global_load_dwordx4 v[52:55], v8, s[12:13] sc1
    v_add_u32 v8, 0x40000, v8
    global_load_dwordx4 v[56:59], v8, s[12:13] sc1
    v_add_u32 v8, 0x40000, v8
    global_load_dwordx4 v[60:63], v8, s[12:13] sc1
    global_load_dwordx4 v[64:67], v9, s[12:13] offset:-4096 sc1
    global_load_dwordx4 v[68:71], v9, s[12:13] offset:-3072 sc1
    global_load_dwordx4 v[72:75], v9, s[12:13] offset:-2048 sc1
    global_load_dwordx4 v[76:79], v9, s[12:13] offset:-1024 sc1
    global_load_dwordx4 v[80:83], v9, s[12:13] offset:0 sc1
    global_load_dwordx4 v[84:87], v9, s[12:13] offset:1024 sc1
    global_load_dwordx4 v[88:91], v9, s[12:13] offset:2048 sc1
    global_load_dwordx4 v[92:95], v9, s[12:13] offset:3072 sc1
    s_waitcnt vmcnt(8)
    v_mfma_f32_16x16x32_bf16 v[96:99], v[32:35], a[98:101], 0
    v_mfma_f32_16x16x32_bf16 v[96:99], v[36:39], a[104:107], v[96:99]
    v_mfma_f32_16x16x32_bf16 v[100:103], v[32:35], a[96:99], 0
    v_mfma_f32_16x16x32_bf16 v[100:103], v[36:39], a[102:105], v[100:103]
    v_mfma_f32_16x16x32_bf16 v[104:107], v[32:35], a[110:113], 0
    v_mfma_f32_16x16x32_bf16 v[104:107], v[36:39], a[116:119], v[104:107]
    v_mfma_f32_16x16x32_bf16 v[108:111], v[32:35], a[108:111], 0
    v_mfma_f32_16x16x32_bf16 v[108:111], v[36:39], a[114:117], v[108:111]
    v_mfma_f32_16x16x32_bf16 v[112:115], v[40:43], a[98:101], 0
    v_mfma_f32_16x16x32_bf16 v[112:115], v[44:47], a[104:107], v[112:115]
    v_mfma_f32_16x16x32_bf16 v[116:119], v[40:43], a[96:99], 0
    v_mfma_f32_16x16x32_bf16 v[116:119], v[44:47], a[102:105], v[116:119]
    v_mfma_f32_16x16x32_bf16 v[120:123], v[40:43], a[110:113], 0
    v_mfma_f32_16x16x32_bf16 v[120:123], v[44:47], a[116:119], v[120:123]
    v_mfma_f32_16x16x32_bf16 v[124:127], v[40:43], a[108:111], 0
    v_mfma_f32_16x16x32_bf16 v[124:127], v[44:47], a[114:117], v[124:127]
    v_mfma_f32_16x16x32_bf16 v[128:131], v[48:51], a[98:101], 0
    v_mfma_f32_16x16x32_bf16 v[128:131], v[52:55], a[104:107], v[128:131]
    v_mfma_f32_16x16x32_bf16 v[132:135], v[48:51], a[96:99], 0
    v_mfma_f32_16x16x32_bf16 v[132:135], v[52:55], a[102:105], v[132:135]
    v_mfma_f32_16x16x32_bf16 v[136:139], v[48:51], a[110:113], 0
    v_mfma_f32_16x16x32_bf16 v[136:139], v[52:55], a[116:119], v[136:139]
    v_mfma_f32_16x16x32_bf16 v[140:143], v[48:51], a[108:111], 0
    v_mfma_f32_16x16x32_bf16 v[140:143], v[52:55], a[114:117], v[140:143]
    v_mfma_f32_16x16x32_bf16 v[144:147], v[56:59], a[98:101], 0
    v_mfma_f32_16x16x32_bf16 v[144:147], v[60:63], a[104:107], v[144:147]
    v_mfma_f32_16x16x32_bf16 v[148:151], v[56:59], a[96:99], 0
    v_mfma_f32_16x16x32_bf16 v[148:151], v[60:63], a[102:105], v[148:151]
    v_mfma_f32_16x16x32_bf16 v[152:155], v[56:59], a[110:113], 0
    v_mfma_f32_16x16x32_bf16 v[152:155], v[60:63], a[116:119], v[152:155]
    v_mfma_f32_16x16x32_bf16 v[156:159], v[56:59], a[108:111], 0
    v_mfma_f32_16x16x32_bf16 v[156:159], v[60:63], a[114:117], v[156:159]
    v_add_f32 v8, 0x0, v6
    v_mul_f32 v8, 0x3a000000, v8
    v_mul_f32 v9, 4.0, v7
    v_mul_f32 v9, v9, v8
    v_fmamk_f32 v10, v8, 0x0, v9
    v_fmamk_f32 v11, v8, 0x3f800000, v9
    v_fmamk_f32 v12, v8, 0x40000000, v9
    v_fmamk_f32 v13, v8, 0x40400000, v9
    v_cos_f32 v16, v10
    v_cos_f32 v17, v11
    v_cos_f32 v18, v12
    v_cos_f32 v19, v13
    v_sin_f32 v20, v10
    v_sin_f32 v21, v11
    v_sin_f32 v22, v12
    v_sin_f32 v23, v13
    v_mul_f32 v24, v96, v16
    v_mul_f32 v28, v100, v16
    v_mul_f32 v25, v97, v17
    v_mul_f32 v29, v101, v17
    v_mul_f32 v26, v98, v18
    v_mul_f32 v30, v102, v18
    v_mul_f32 v27, v99, v19
    v_mul_f32 v31, v103, v19
    v_fma_f32 v24, v100, v20, v24
    v_fma_f32 v28, -v96, v20, v28
    v_fma_f32 v25, v101, v21, v25
    v_fma_f32 v29, -v97, v21, v29
    v_fma_f32 v26, v102, v22, v26
    v_fma_f32 v30, -v98, v22, v30
    v_fma_f32 v27, v103, v23, v27
    v_fma_f32 v31, -v99, v23, v31
    v_cvt_pk_bf16_f32 v160, v24, v25
    v_cvt_pk_bf16_f32 v161, v26, v27
    v_cvt_pk_bf16_f32 v162, v28, v29
    v_cvt_pk_bf16_f32 v163, v30, v31
    v_fmamk_f32 v10, v8, 0x41800000, v9
    v_fmamk_f32 v11, v8, 0x41880000, v9
    v_fmamk_f32 v12, v8, 0x41900000, v9
    v_fmamk_f32 v13, v8, 0x41980000, v9
    v_cos_f32 v16, v10
    v_cos_f32 v17, v11
    v_cos_f32 v18, v12
    v_cos_f32 v19, v13
    v_sin_f32 v20, v10
    v_sin_f32 v21, v11
    v_sin_f32 v22, v12
    v_sin_f32 v23, v13
    v_mul_f32 v24, v112, v16
    v_mul_f32 v28, v116, v16
    v_mul_f32 v25, v113, v17
    v_mul_f32 v29, v117, v17
    v_mul_f32 v26, v114, v18
    v_mul_f32 v30, v118, v18
    v_mul_f32 v27, v115, v19
    v_mul_f32 v31, v119, v19
    v_fma_f32 v24, v116, v20, v24
    v_fma_f32 v28, -v112, v20, v28
    v_fma_f32 v25, v117, v21, v25
    v_fma_f32 v29, -v113, v21, v29
    v_fma_f32 v26, v118, v22, v26
    v_fma_f32 v30, -v114, v22, v30
    v_fma_f32 v27, v119, v23, v27
    v_fma_f32 v31, -v115, v23, v31
    v_cvt_pk_bf16_f32 v168, v24, v25
    v_cvt_pk_bf16_f32 v169, v26, v27
    v_cvt_pk_bf16_f32 v170, v28, v29
    v_cvt_pk_bf16_f32 v171, v30, v31
    v_fmamk_f32 v10, v8, 0x42000000, v9
    v_fmamk_f32 v11, v8, 0x42040000, v9
    v_fmamk_f32 v12, v8, 0x42080000, v9
    v_fmamk_f32 v13, v8, 0x420c0000, v9
    v_cos_f32 v16, v10
    v_cos_f32 v17, v11
    v_cos_f32 v18, v12
    v_cos_f32 v19, v13
    v_sin_f32 v20, v10
    v_sin_f32 v21, v11
    v_sin_f32 v22, v12
    v_sin_f32 v23, v13
    v_mul_f32 v24, v128, v16
    v_mul_f32 v28, v132, v16
    v_mul_f32 v25, v129, v17
    v_mul_f32 v29, v133, v17
    v_mul_f32 v26, v130, v18
    v_mul_f32 v30, v134, v18
    v_mul_f32 v27, v131, v19
    v_mul_f32 v31, v135, v19
    v_fma_f32 v24, v132, v20, v24
    v_fma_f32 v28, -v128, v20, v28
    v_fma_f32 v25, v133, v21, v25
    v_fma_f32 v29, -v129, v21, v29
    v_fma_f32 v26, v134, v22, v26
    v_fma_f32 v30, -v130, v22, v30
    v_fma_f32 v27, v135, v23, v27
    v_fma_f32 v31, -v131, v23, v31
    v_cvt_pk_bf16_f32 v176, v24, v25
    v_cvt_pk_bf16_f32 v177, v26, v27
    v_cvt_pk_bf16_f32 v178, v28, v29
    v_cvt_pk_bf16_f32 v179, v30, v31
    v_fmamk_f32 v10, v8, 0x42400000, v9
    v_fmamk_f32 v11, v8, 0x42440000, v9
    v_fmamk_f32 v12, v8, 0x42480000, v9
    v_fmamk_f32 v13, v8, 0x424c0000, v9
    v_cos_f32 v16, v10
    v_cos_f32 v17, v11
    v_cos_f32 v18, v12
    v_cos_f32 v19, v13
    v_sin_f32 v20, v10
    v_sin_f32 v21, v11
    v_sin_f32 v22, v12
    v_sin_f32 v23, v13
    v_mul_f32 v24, v144, v16
    v_mul_f32 v28, v148, v16
    v_mul_f32 v25, v145, v17
    v_mul_f32 v29, v149, v17
    v_mul_f32 v26, v146, v18
    v_mul_f32 v30, v150, v18
    v_mul_f32 v27, v147, v19
    v_mul_f32 v31, v151, v19
    v_fma_f32 v24, v148, v20, v24
    v_fma_f32 v28, -v144, v20, v28
    v_fma_f32 v25, v149, v21, v25
    v_fma_f32 v29, -v145, v21, v29
    v_fma_f32 v26, v150, v22, v26
    v_fma_f32 v30, -v146, v22, v30
    v_fma_f32 v27, v151, v23, v27
    v_fma_f32 v31, -v147, v23, v31
    v_cvt_pk_bf16_f32 v184, v24, v25
    v_cvt_pk_bf16_f32 v185, v26, v27
    v_cvt_pk_bf16_f32 v186, v28, v29
    v_cvt_pk_bf16_f32 v187, v30, v31
    v_add_f32 v8, 0x41800000, v6
    v_mul_f32 v8, 0x3a000000, v8
    v_mul_f32 v9, 4.0, v7
    v_mul_f32 v9, v9, v8
    v_fmamk_f32 v10, v8, 0x0, v9
    v_fmamk_f32 v11, v8, 0x3f800000, v9
    v_fmamk_f32 v12, v8, 0x40000000, v9
    v_fmamk_f32 v13, v8, 0x40400000, v9
    v_cos_f32 v16, v10
    v_cos_f32 v17, v11
    v_cos_f32 v18, v12
    v_cos_f32 v19, v13
    v_sin_f32 v20, v10
    v_sin_f32 v21, v11
    v_sin_f32 v22, v12
    v_sin_f32 v23, v13
    v_mul_f32 v24, v104, v16
    v_mul_f32 v28, v108, v16
    v_mul_f32 v25, v105, v17
    v_mul_f32 v29, v109, v17
    v_mul_f32 v26, v106, v18
    v_mul_f32 v30, v110, v18
    v_mul_f32 v27, v107, v19
    v_mul_f32 v31, v111, v19
    v_fma_f32 v24, v108, v20, v24
    v_fma_f32 v28, -v104, v20, v28
    v_fma_f32 v25, v109, v21, v25
    v_fma_f32 v29, -v105, v21, v29
    v_fma_f32 v26, v110, v22, v26
    v_fma_f32 v30, -v106, v22, v30
    v_fma_f32 v27, v111, v23, v27
    v_fma_f32 v31, -v107, v23, v31
    v_cvt_pk_bf16_f32 v164, v24, v25
    v_cvt_pk_bf16_f32 v165, v26, v27
    v_cvt_pk_bf16_f32 v166, v28, v29
    v_cvt_pk_bf16_f32 v167, v30, v31
    v_fmamk_f32 v10, v8, 0x41800000, v9
    v_fmamk_f32 v11, v8, 0x41880000, v9
    v_fmamk_f32 v12, v8, 0x41900000, v9
    v_fmamk_f32 v13, v8, 0x41980000, v9
    v_cos_f32 v16, v10
    v_cos_f32 v17, v11
    v_cos_f32 v18, v12
    v_cos_f32 v19, v13
    v_sin_f32 v20, v10
    v_sin_f32 v21, v11
    v_sin_f32 v22, v12
    v_sin_f32 v23, v13
    v_mul_f32 v24, v120, v16
    v_mul_f32 v28, v124, v16
    v_mul_f32 v25, v121, v17
    v_mul_f32 v29, v125, v17
    v_mul_f32 v26, v122, v18
    v_mul_f32 v30, v126, v18
    v_mul_f32 v27, v123, v19
    v_mul_f32 v31, v127, v19
    v_fma_f32 v24, v124, v20, v24
    v_fma_f32 v28, -v120, v20, v28
    v_fma_f32 v25, v125, v21, v25
    v_fma_f32 v29, -v121, v21, v29
    v_fma_f32 v26, v126, v22, v26
    v_fma_f32 v30, -v122, v22, v30
    v_fma_f32 v27, v127, v23, v27
    v_fma_f32 v31, -v123, v23, v31
    v_cvt_pk_bf16_f32 v172, v24, v25
    v_cvt_pk_bf16_f32 v173, v26, v27
    v_cvt_pk_bf16_f32 v174, v28, v29
    v_cvt_pk_bf16_f32 v175, v30, v31
    v_fmamk_f32 v10, v8, 0x42000000, v9
    v_fmamk_f32 v11, v8, 0x42040000, v9
    v_fmamk_f32 v12, v8, 0x42080000, v9
    v_fmamk_f32 v13, v8, 0x420c0000, v9
    v_cos_f32 v16, v10
    v_cos_f32 v17, v11
    v_cos_f32 v18, v12
    v_cos_f32 v19, v13
    v_sin_f32 v20, v10
    v_sin_f32 v21, v11
    v_sin_f32 v22, v12
    v_sin_f32 v23, v13
    v_mul_f32 v24, v136, v16
    v_mul_f32 v28, v140, v16
    v_mul_f32 v25, v137, v17
    v_mul_f32 v29, v141, v17
    v_mul_f32 v26, v138, v18
    v_mul_f32 v30, v142, v18
    v_mul_f32 v27, v139, v19
    v_mul_f32 v31, v143, v19
    v_fma_f32 v24, v140, v20, v24
    v_fma_f32 v28, -v136, v20, v28
    v_fma_f32 v25, v141, v21, v25
    v_fma_f32 v29, -v137, v21, v29
    v_fma_f32 v26, v142, v22, v26
    v_fma_f32 v30, -v138, v22, v30
    v_fma_f32 v27, v143, v23, v27
    v_fma_f32 v31, -v139, v23, v31
    v_cvt_pk_bf16_f32 v180, v24, v25
    v_cvt_pk_bf16_f32 v181, v26, v27
    v_cvt_pk_bf16_f32 v182, v28, v29
    v_cvt_pk_bf16_f32 v183, v30, v31
    v_fmamk_f32 v10, v8, 0x42400000, v9
    v_fmamk_f32 v11, v8, 0x42440000, v9
    v_fmamk_f32 v12, v8, 0x42480000, v9
    v_fmamk_f32 v13, v8, 0x424c0000, v9
    v_cos_f32 v16, v10
    v_cos_f32 v17, v11
    v_cos_f32 v18, v12
    v_cos_f32 v19, v13
    v_sin_f32 v20, v10
    v_sin_f32 v21, v11
    v_sin_f32 v22, v12
    v_sin_f32 v23, v13
    v_mul_f32 v24, v152, v16
    v_mul_f32 v28, v156, v16
    v_mul_f32 v25, v153, v17
    v_mul_f32 v29, v157, v17
    v_mul_f32 v26, v154, v18
    v_mul_f32 v30, v158, v18
    v_mul_f32 v27, v155, v19
    v_mul_f32 v31, v159, v19
    v_fma_f32 v24, v156, v20, v24
    v_fma_f32 v28, -v152, v20, v28
    v_fma_f32 v25, v157, v21, v25
    v_fma_f32 v29, -v153, v21, v29
    v_fma_f32 v26, v158, v22, v26
    v_fma_f32 v30, -v154, v22, v30
    v_fma_f32 v27, v159, v23, v27
    v_fma_f32 v31, -v155, v23, v31
    v_cvt_pk_bf16_f32 v188, v24, v25
    v_cvt_pk_bf16_f32 v189, v26, v27
    v_cvt_pk_bf16_f32 v190, v28, v29
    v_cvt_pk_bf16_f32 v191, v30, v31
    v_mfma_f32_16x16x32_bf16 v[96:99], a[2:5], v[160:163], 0
    v_mfma_f32_16x16x32_bf16 v[96:99], a[8:11], v[168:171], v[96:99]
    v_mfma_f32_16x16x32_bf16 v[96:99], a[14:17], v[176:179], v[96:99]
    v_mfma_f32_16x16x32_bf16 v[96:99], a[20:23], v[184:187], v[96:99]
    v_mfma_f32_16x16x32_bf16 v[100:103], a[0:3], v[160:163], 0
    v_mfma_f32_16x16x32_bf16 v[100:103], a[6:9], v[168:171], v[100:103]
    v_mfma_f32_16x16x32_bf16 v[100:103], a[12:15], v[176:179], v[100:103]
    v_mfma_f32_16x16x32_bf16 v[100:103], a[18:21], v[184:187], v[100:103]
    v_mfma_f32_16x16x32_bf16 v[104:107], a[2:5], v[164:167], 0
    v_mfma_f32_16x16x32_bf16 v[104:107], a[8:11], v[172:175], v[104:107]
    v_mfma_f32_16x16x32_bf16 v[104:107], a[14:17], v[180:183], v[104:107]
    v_mfma_f32_16x16x32_bf16 v[104:107], a[20:23], v[188:191], v[104:107]
    v_mfma_f32_16x16x32_bf16 v[108:111], a[0:3], v[164:167], 0
    v_mfma_f32_16x16x32_bf16 v[108:111], a[6:9], v[172:175], v[108:111]
    v_mfma_f32_16x16x32_bf16 v[108:111], a[12:15], v[180:183], v[108:111]
    v_mfma_f32_16x16x32_bf16 v[108:111], a[18:21], v[188:191], v[108:111]
    v_mfma_f32_16x16x32_bf16 v[112:115], a[26:29], v[160:163], 0
    v_mfma_f32_16x16x32_bf16 v[112:115], a[32:35], v[168:171], v[112:115]
    v_mfma_f32_16x16x32_bf16 v[112:115], a[38:41], v[176:179], v[112:115]
    v_mfma_f32_16x16x32_bf16 v[112:115], a[44:47], v[184:187], v[112:115]
    v_mfma_f32_16x16x32_bf16 v[116:119], a[24:27], v[160:163], 0
    v_mfma_f32_16x16x32_bf16 v[116:119], a[30:33], v[168:171], v[116:119]
    v_mfma_f32_16x16x32_bf16 v[116:119], a[36:39], v[176:179], v[116:119]
    v_mfma_f32_16x16x32_bf16 v[116:119], a[42:45], v[184:187], v[116:119]
    v_mfma_f32_16x16x32_bf16 v[120:123], a[26:29], v[164:167], 0
    v_mfma_f32_16x16x32_bf16 v[120:123], a[32:35], v[172:175], v[120:123]
    v_mfma_f32_16x16x32_bf16 v[120:123], a[38:41], v[180:183], v[120:123]
    v_mfma_f32_16x16x32_bf16 v[120:123], a[44:47], v[188:191], v[120:123]
    v_mfma_f32_16x16x32_bf16 v[124:127], a[24:27], v[164:167], 0
    v_mfma_f32_16x16x32_bf16 v[124:127], a[30:33], v[172:175], v[124:127]
    v_mfma_f32_16x16x32_bf16 v[124:127], a[36:39], v[180:183], v[124:127]
    v_mfma_f32_16x16x32_bf16 v[124:127], a[42:45], v[188:191], v[124:127]
    v_mfma_f32_16x16x32_bf16 v[128:131], a[50:53], v[160:163], 0
    v_mfma_f32_16x16x32_bf16 v[128:131], a[56:59], v[168:171], v[128:131]
    v_mfma_f32_16x16x32_bf16 v[128:131], a[62:65], v[176:179], v[128:131]
    v_mfma_f32_16x16x32_bf16 v[128:131], a[68:71], v[184:187], v[128:131]
    v_mfma_f32_16x16x32_bf16 v[132:135], a[48:51], v[160:163], 0
    v_mfma_f32_16x16x32_bf16 v[132:135], a[54:57], v[168:171], v[132:135]
    v_mfma_f32_16x16x32_bf16 v[132:135], a[60:63], v[176:179], v[132:135]
    v_mfma_f32_16x16x32_bf16 v[132:135], a[66:69], v[184:187], v[132:135]
    v_mfma_f32_16x16x32_bf16 v[136:139], a[50:53], v[164:167], 0
    v_mfma_f32_16x16x32_bf16 v[136:139], a[56:59], v[172:175], v[136:139]
    v_mfma_f32_16x16x32_bf16 v[136:139], a[62:65], v[180:183], v[136:139]
    v_mfma_f32_16x16x32_bf16 v[136:139], a[68:71], v[188:191], v[136:139]
    v_mfma_f32_16x16x32_bf16 v[140:143], a[48:51], v[164:167], 0
    v_mfma_f32_16x16x32_bf16 v[140:143], a[54:57], v[172:175], v[140:143]
    v_mfma_f32_16x16x32_bf16 v[140:143], a[60:63], v[180:183], v[140:143]
    v_mfma_f32_16x16x32_bf16 v[140:143], a[66:69], v[188:191], v[140:143]
    v_mfma_f32_16x16x32_bf16 v[144:147], a[74:77], v[160:163], 0
    v_mfma_f32_16x16x32_bf16 v[144:147], a[80:83], v[168:171], v[144:147]
    v_mfma_f32_16x16x32_bf16 v[144:147], a[86:89], v[176:179], v[144:147]
    v_mfma_f32_16x16x32_bf16 v[144:147], a[92:95], v[184:187], v[144:147]
    v_mfma_f32_16x16x32_bf16 v[148:151], a[72:75], v[160:163], 0
    v_mfma_f32_16x16x32_bf16 v[148:151], a[78:81], v[168:171], v[148:151]
    v_mfma_f32_16x16x32_bf16 v[148:151], a[84:87], v[176:179], v[148:151]
    v_mfma_f32_16x16x32_bf16 v[148:151], a[90:93], v[184:187], v[148:151]
    v_mfma_f32_16x16x32_bf16 v[152:155], a[74:77], v[164:167], 0
    v_mfma_f32_16x16x32_bf16 v[152:155], a[80:83], v[172:175], v[152:155]
    v_mfma_f32_16x16x32_bf16 v[152:155], a[86:89], v[180:183], v[152:155]
    v_mfma_f32_16x16x32_bf16 v[152:155], a[92:95], v[188:191], v[152:155]
    v_mfma_f32_16x16x32_bf16 v[156:159], a[72:75], v[164:167], 0
    v_mfma_f32_16x16x32_bf16 v[156:159], a[78:81], v[172:175], v[156:159]
    v_mfma_f32_16x16x32_bf16 v[156:159], a[84:87], v[180:183], v[156:159]
    v_mfma_f32_16x16x32_bf16 v[156:159], a[90:93], v[188:191], v[156:159]
    s_waitcnt vmcnt(0)
    s_mov_b32 s29, 0xffff0000
    v_lshlrev_b32 v16, 16, v64
    v_and_b32 v20, s29, v64
    v_lshlrev_b32 v17, 16, v65
    v_and_b32 v21, s29, v65
    v_lshlrev_b32 v18, 16, v66
    v_and_b32 v22, s29, v66
    v_lshlrev_b32 v19, 16, v67
    v_and_b32 v23, s29, v67
    v_mul_f32 v24, v96, v16
    v_mul_f32 v28, v100, v16
    v_mul_f32 v25, v97, v17
    v_mul_f32 v29, v101, v17
    v_mul_f32 v26, v98, v18
    v_mul_f32 v30, v102, v18
    v_mul_f32 v27, v99, v19
    v_mul_f32 v31, v103, v19
    v_fma_f32 v24, -v100, v20, v24
    v_fma_f32 v28, v96, v20, v28
    v_fma_f32 v25, -v101, v21, v25
    v_fma_f32 v29, v97, v21, v29
    v_fma_f32 v26, -v102, v22, v26
    v_fma_f32 v30, v98, v22, v30
    v_fma_f32 v27, -v103, v23, v27
    v_fma_f32 v31, v99, v23, v31
    v_cvt_pk_bf16_f32 v32, v28, v29
    v_cvt_pk_bf16_f32 v33, v30, v31
    v_cvt_pk_bf16_f32 v34, v24, v25
    v_cvt_pk_bf16_f32 v35, v26, v27
    v_lshlrev_b32 v16, 16, v68
    v_and_b32 v20, s29, v68
    v_lshlrev_b32 v17, 16, v69
    v_and_b32 v21, s29, v69
    v_lshlrev_b32 v18, 16, v70
    v_and_b32 v22, s29, v70
    v_lshlrev_b32 v19, 16, v71
    v_and_b32 v23, s29, v71
    v_mul_f32 v24, v104, v16
    v_mul_f32 v28, v108, v16
    v_mul_f32 v25, v105, v17
    v_mul_f32 v29, v109, v17
    v_mul_f32 v26, v106, v18
    v_mul_f32 v30, v110, v18
    v_mul_f32 v27, v107, v19
    v_mul_f32 v31, v111, v19
    v_fma_f32 v24, -v108, v20, v24
    v_fma_f32 v28, v104, v20, v28
    v_fma_f32 v25, -v109, v21, v25
    v_fma_f32 v29, v105, v21, v29
    v_fma_f32 v26, -v110, v22, v26
    v_fma_f32 v30, v106, v22, v30
    v_fma_f32 v27, -v111, v23, v27
    v_fma_f32 v31, v107, v23, v31
    v_cvt_pk_bf16_f32 v36, v28, v29
    v_cvt_pk_bf16_f32 v37, v30, v31
    v_cvt_pk_bf16_f32 v38, v24, v25
    v_cvt_pk_bf16_f32 v39, v26, v27
    v_lshlrev_b32 v16, 16, v72
    v_and_b32 v20, s29, v72
    v_lshlrev_b32 v17, 16, v73
    v_and_b32 v21, s29, v73
    v_lshlrev_b32 v18, 16, v74
    v_and_b32 v22, s29, v74
    v_lshlrev_b32 v19, 16, v75
    v_and_b32 v23, s29, v75
    v_mul_f32 v24, v112, v16
    v_mul_f32 v28, v116, v16
    v_mul_f32 v25, v113, v17
    v_mul_f32 v29, v117, v17
    v_mul_f32 v26, v114, v18
    v_mul_f32 v30, v118, v18
    v_mul_f32 v27, v115, v19
    v_mul_f32 v31, v119, v19
    v_fma_f32 v24, -v116, v20, v24
    v_fma_f32 v28, v112, v20, v28
    v_fma_f32 v25, -v117, v21, v25
    v_fma_f32 v29, v113, v21, v29
    v_fma_f32 v26, -v118, v22, v26
    v_fma_f32 v30, v114, v22, v30
    v_fma_f32 v27, -v119, v23, v27
    v_fma_f32 v31, v115, v23, v31
    v_cvt_pk_bf16_f32 v40, v28, v29
    v_cvt_pk_bf16_f32 v41, v30, v31
    v_cvt_pk_bf16_f32 v42, v24, v25
    v_cvt_pk_bf16_f32 v43, v26, v27
    v_lshlrev_b32 v16, 16, v76
    v_and_b32 v20, s29, v76
    v_lshlrev_b32 v17, 16, v77
    v_and_b32 v21, s29, v77
    v_lshlrev_b32 v18, 16, v78
    v_and_b32 v22, s29, v78
    v_lshlrev_b32 v19, 16, v79
    v_and_b32 v23, s29, v79
    v_mul_f32 v24, v120, v16
    v_mul_f32 v28, v124, v16
    v_mul_f32 v25, v121, v17
    v_mul_f32 v29, v125, v17
    v_mul_f32 v26, v122, v18
    v_mul_f32 v30, v126, v18
    v_mul_f32 v27, v123, v19
    v_mul_f32 v31, v127, v19
    v_fma_f32 v24, -v124, v20, v24
    v_fma_f32 v28, v120, v20, v28
    v_fma_f32 v25, -v125, v21, v25
    v_fma_f32 v29, v121, v21, v29
    v_fma_f32 v26, -v126, v22, v26
    v_fma_f32 v30, v122, v22, v30
    v_fma_f32 v27, -v127, v23, v27
    v_fma_f32 v31, v123, v23, v31
    v_cvt_pk_bf16_f32 v44, v28, v29
    v_cvt_pk_bf16_f32 v45, v30, v31
    v_cvt_pk_bf16_f32 v46, v24, v25
    v_cvt_pk_bf16_f32 v47, v26, v27
    v_lshlrev_b32 v16, 16, v80
    v_and_b32 v20, s29, v80
    v_lshlrev_b32 v17, 16, v81
    v_and_b32 v21, s29, v81
    v_lshlrev_b32 v18, 16, v82
    v_and_b32 v22, s29, v82
    v_lshlrev_b32 v19, 16, v83
    v_and_b32 v23, s29, v83
    v_mul_f32 v24, v128, v16
    v_mul_f32 v28, v132, v16
    v_mul_f32 v25, v129, v17
    v_mul_f32 v29, v133, v17
    v_mul_f32 v26, v130, v18
    v_mul_f32 v30, v134, v18
    v_mul_f32 v27, v131, v19
    v_mul_f32 v31, v135, v19
    v_fma_f32 v24, -v132, v20, v24
    v_fma_f32 v28, v128, v20, v28
    v_fma_f32 v25, -v133, v21, v25
    v_fma_f32 v29, v129, v21, v29
    v_fma_f32 v26, -v134, v22, v26
    v_fma_f32 v30, v130, v22, v30
    v_fma_f32 v27, -v135, v23, v27
    v_fma_f32 v31, v131, v23, v31
    v_cvt_pk_bf16_f32 v48, v28, v29
    v_cvt_pk_bf16_f32 v49, v30, v31
    v_cvt_pk_bf16_f32 v50, v24, v25
    v_cvt_pk_bf16_f32 v51, v26, v27
    v_lshlrev_b32 v16, 16, v84
    v_and_b32 v20, s29, v84
    v_lshlrev_b32 v17, 16, v85
    v_and_b32 v21, s29, v85
    v_lshlrev_b32 v18, 16, v86
    v_and_b32 v22, s29, v86
    v_lshlrev_b32 v19, 16, v87
    v_and_b32 v23, s29, v87
    v_mul_f32 v24, v136, v16
    v_mul_f32 v28, v140, v16
    v_mul_f32 v25, v137, v17
    v_mul_f32 v29, v141, v17
    v_mul_f32 v26, v138, v18
    v_mul_f32 v30, v142, v18
    v_mul_f32 v27, v139, v19
    v_mul_f32 v31, v143, v19
    v_fma_f32 v24, -v140, v20, v24
    v_fma_f32 v28, v136, v20, v28
    v_fma_f32 v25, -v141, v21, v25
    v_fma_f32 v29, v137, v21, v29
    v_fma_f32 v26, -v142, v22, v26
    v_fma_f32 v30, v138, v22, v30
    v_fma_f32 v27, -v143, v23, v27
    v_fma_f32 v31, v139, v23, v31
    v_cvt_pk_bf16_f32 v52, v28, v29
    v_cvt_pk_bf16_f32 v53, v30, v31
    v_cvt_pk_bf16_f32 v54, v24, v25
    v_cvt_pk_bf16_f32 v55, v26, v27
    v_lshlrev_b32 v16, 16, v88
    v_and_b32 v20, s29, v88
    v_lshlrev_b32 v17, 16, v89
    v_and_b32 v21, s29, v89
    v_lshlrev_b32 v18, 16, v90
    v_and_b32 v22, s29, v90
    v_lshlrev_b32 v19, 16, v91
    v_and_b32 v23, s29, v91
    v_mul_f32 v24, v144, v16
    v_mul_f32 v28, v148, v16
    v_mul_f32 v25, v145, v17
    v_mul_f32 v29, v149, v17
    v_mul_f32 v26, v146, v18
    v_mul_f32 v30, v150, v18
    v_mul_f32 v27, v147, v19
    v_mul_f32 v31, v151, v19
    v_fma_f32 v24, -v148, v20, v24
    v_fma_f32 v28, v144, v20, v28
    v_fma_f32 v25, -v149, v21, v25
    v_fma_f32 v29, v145, v21, v29
    v_fma_f32 v26, -v150, v22, v26
    v_fma_f32 v30, v146, v22, v30
    v_fma_f32 v27, -v151, v23, v27
    v_fma_f32 v31, v147, v23, v31
    v_cvt_pk_bf16_f32 v56, v28, v29
    v_cvt_pk_bf16_f32 v57, v30, v31
    v_cvt_pk_bf16_f32 v58, v24, v25
    v_cvt_pk_bf16_f32 v59, v26, v27
    v_lshlrev_b32 v16, 16, v92
    v_and_b32 v20, s29, v92
    v_lshlrev_b32 v17, 16, v93
    v_and_b32 v21, s29, v93
    v_lshlrev_b32 v18, 16, v94
    v_and_b32 v22, s29, v94
    v_lshlrev_b32 v19, 16, v95
    v_and_b32 v23, s29, v95
    v_mul_f32 v24, v152, v16
    v_mul_f32 v28, v156, v16
    v_mul_f32 v25, v153, v17
    v_mul_f32 v29, v157, v17
    v_mul_f32 v26, v154, v18
    v_mul_f32 v30, v158, v18
    v_mul_f32 v27, v155, v19
    v_mul_f32 v31, v159, v19
    v_fma_f32 v24, -v156, v20, v24
    v_fma_f32 v28, v152, v20, v28
    v_fma_f32 v25, -v157, v21, v25
    v_fma_f32 v29, v153, v21, v29
    v_fma_f32 v26, -v158, v22, v26
    v_fma_f32 v30, v154, v22, v30
    v_fma_f32 v27, -v159, v23, v27
    v_fma_f32 v31, v155, v23, v31
    v_cvt_pk_bf16_f32 v60, v28, v29
    v_cvt_pk_bf16_f32 v61, v30, v31
    v_cvt_pk_bf16_f32 v62, v24, v25
    v_cvt_pk_bf16_f32 v63, v26, v27
    v_mfma_f32_16x16x32_bf16 v[96:99], v[32:35], a[0:3], 0
    v_mfma_f32_16x16x32_bf16 v[96:99], v[40:43], a[6:9], v[96:99]
    v_mfma_f32_16x16x32_bf16 v[96:99], v[48:51], a[12:15], v[96:99]
    v_mfma_f32_16x16x32_bf16 v[96:99], v[56:59], a[18:21], v[96:99]
    v_mfma_f32_16x16x32_bf16 v[100:103], v[32:35], a[2:5], 0
    v_mfma_f32_16x16x32_bf16 v[100:103], v[40:43], a[8:11], v[100:103]
    v_mfma_f32_16x16x32_bf16 v[100:103], v[48:51], a[14:17], v[100:103]
    v_mfma_f32_16x16x32_bf16 v[100:103], v[56:59], a[20:23], v[100:103]
    v_mfma_f32_16x16x32_bf16 v[104:107], v[32:35], a[24:27], 0
    v_mfma_f32_16x16x32_bf16 v[104:107], v[40:43], a[30:33], v[104:107]
    v_mfma_f32_16x16x32_bf16 v[104:107], v[48:51], a[36:39], v[104:107]
    v_mfma_f32_16x16x32_bf16 v[104:107], v[56:59], a[42:45], v[104:107]
    v_mfma_f32_16x16x32_bf16 v[108:111], v[32:35], a[26:29], 0
    v_mfma_f32_16x16x32_bf16 v[108:111], v[40:43], a[32:35], v[108:111]
    v_mfma_f32_16x16x32_bf16 v[108:111], v[48:51], a[38:41], v[108:111]
    v_mfma_f32_16x16x32_bf16 v[108:111], v[56:59], a[44:47], v[108:111]
    v_mfma_f32_16x16x32_bf16 v[112:115], v[32:35], a[48:51], 0
    v_mfma_f32_16x16x32_bf16 v[112:115], v[40:43], a[54:57], v[112:115]
    v_mfma_f32_16x16x32_bf16 v[112:115], v[48:51], a[60:63], v[112:115]
    v_mfma_f32_16x16x32_bf16 v[112:115], v[56:59], a[66:69], v[112:115]
    v_mfma_f32_16x16x32_bf16 v[116:119], v[32:35], a[50:53], 0
    v_mfma_f32_16x16x32_bf16 v[116:119], v[40:43], a[56:59], v[116:119]
    v_mfma_f32_16x16x32_bf16 v[116:119], v[48:51], a[62:65], v[116:119]
    v_mfma_f32_16x16x32_bf16 v[116:119], v[56:59], a[68:71], v[116:119]
    v_mfma_f32_16x16x32_bf16 v[120:123], v[32:35], a[72:75], 0
    v_mfma_f32_16x16x32_bf16 v[120:123], v[40:43], a[78:81], v[120:123]
    v_mfma_f32_16x16x32_bf16 v[120:123], v[48:51], a[84:87], v[120:123]
    v_mfma_f32_16x16x32_bf16 v[120:123], v[56:59], a[90:93], v[120:123]
    v_mfma_f32_16x16x32_bf16 v[124:127], v[32:35], a[74:77], 0
    v_mfma_f32_16x16x32_bf16 v[124:127], v[40:43], a[80:83], v[124:127]
    v_mfma_f32_16x16x32_bf16 v[124:127], v[48:51], a[86:89], v[124:127]
    v_mfma_f32_16x16x32_bf16 v[124:127], v[56:59], a[92:95], v[124:127]
    v_mfma_f32_16x16x32_bf16 v[128:131], v[36:39], a[0:3], 0
    v_mfma_f32_16x16x32_bf16 v[128:131], v[44:47], a[6:9], v[128:131]
    v_mfma_f32_16x16x32_bf16 v[128:131], v[52:55], a[12:15], v[128:131]
    v_mfma_f32_16x16x32_bf16 v[128:131], v[60:63], a[18:21], v[128:131]
    v_mfma_f32_16x16x32_bf16 v[132:135], v[36:39], a[2:5], 0
    v_mfma_f32_16x16x32_bf16 v[132:135], v[44:47], a[8:11], v[132:135]
    v_mfma_f32_16x16x32_bf16 v[132:135], v[52:55], a[14:17], v[132:135]
    v_mfma_f32_16x16x32_bf16 v[132:135], v[60:63], a[20:23], v[132:135]
    v_mfma_f32_16x16x32_bf16 v[136:139], v[36:39], a[24:27], 0
    v_mfma_f32_16x16x32_bf16 v[136:139], v[44:47], a[30:33], v[136:139]
    v_mfma_f32_16x16x32_bf16 v[136:139], v[52:55], a[36:39], v[136:139]
    v_mfma_f32_16x16x32_bf16 v[136:139], v[60:63], a[42:45], v[136:139]
    v_mfma_f32_16x16x32_bf16 v[140:143], v[36:39], a[26:29], 0
    v_mfma_f32_16x16x32_bf16 v[140:143], v[44:47], a[32:35], v[140:143]
    v_mfma_f32_16x16x32_bf16 v[140:143], v[52:55], a[38:41], v[140:143]
    v_mfma_f32_16x16x32_bf16 v[140:143], v[60:63], a[44:47], v[140:143]
    v_mfma_f32_16x16x32_bf16 v[144:147], v[36:39], a[48:51], 0
    v_mfma_f32_16x16x32_bf16 v[144:147], v[44:47], a[54:57], v[144:147]
    v_mfma_f32_16x16x32_bf16 v[144:147], v[52:55], a[60:63], v[144:147]
    v_mfma_f32_16x16x32_bf16 v[144:147], v[60:63], a[66:69], v[144:147]
    v_mfma_f32_16x16x32_bf16 v[148:151], v[36:39], a[50:53], 0
    v_mfma_f32_16x16x32_bf16 v[148:151], v[44:47], a[56:59], v[148:151]
    v_mfma_f32_16x16x32_bf16 v[148:151], v[52:55], a[62:65], v[148:151]
    v_mfma_f32_16x16x32_bf16 v[148:151], v[60:63], a[68:71], v[148:151]
    v_mfma_f32_16x16x32_bf16 v[152:155], v[36:39], a[72:75], 0
    v_mfma_f32_16x16x32_bf16 v[152:155], v[44:47], a[78:81], v[152:155]
    v_mfma_f32_16x16x32_bf16 v[152:155], v[52:55], a[84:87], v[152:155]
    v_mfma_f32_16x16x32_bf16 v[152:155], v[60:63], a[90:93], v[152:155]
    v_mfma_f32_16x16x32_bf16 v[156:159], v[36:39], a[74:77], 0
    v_mfma_f32_16x16x32_bf16 v[156:159], v[44:47], a[80:83], v[156:159]
    v_mfma_f32_16x16x32_bf16 v[156:159], v[52:55], a[86:89], v[156:159]
    v_mfma_f32_16x16x32_bf16 v[156:159], v[60:63], a[92:95], v[156:159]
    v_add_f32 v8, 0x0, v6
    v_mul_f32 v8, 0x3a000000, v8
    v_mul_f32 v9, 4.0, v7
    v_mul_f32 v9, v9, v8
    v_fmamk_f32 v10, v8, 0x0, v9
    v_fmamk_f32 v11, v8, 0x3f800000, v9
    v_fmamk_f32 v12, v8, 0x40000000, v9
    v_fmamk_f32 v13, v8, 0x40400000, v9
    v_cos_f32 v16, v10
    v_cos_f32 v17, v11
    v_cos_f32 v18, v12
    v_cos_f32 v19, v13
    v_sin_f32 v20, v10
    v_sin_f32 v21, v11
    v_sin_f32 v22, v12
    v_sin_f32 v23, v13
    v_mul_f32 v24, v96, v16
    v_mul_f32 v28, v100, v16
    v_mul_f32 v25, v97, v17
    v_mul_f32 v29, v101, v17
    v_mul_f32 v26, v98, v18
    v_mul_f32 v30, v102, v18
    v_mul_f32 v27, v99, v19
    v_mul_f32 v31, v103, v19
    v_fma_f32 v24, -v100, v20, v24
    v_fma_f32 v28, v96, v20, v28
    v_fma_f32 v25, -v101, v21, v25
    v_fma_f32 v29, v97, v21, v29
    v_fma_f32 v26, -v102, v22, v26
    v_fma_f32 v30, v98, v22, v30
    v_fma_f32 v27, -v103, v23, v27
    v_fma_f32 v31, v99, v23, v31
    v_cvt_pk_bf16_f32 v160, v28, v29
    v_cvt_pk_bf16_f32 v161, v30, v31
    v_cvt_pk_bf16_f32 v162, v24, v25
    v_cvt_pk_bf16_f32 v163, v26, v27
    v_fmamk_f32 v10, v8, 0x41800000, v9
    v_fmamk_f32 v11, v8, 0x41880000, v9
    v_fmamk_f32 v12, v8, 0x41900000, v9
    v_fmamk_f32 v13, v8, 0x41980000, v9
    v_cos_f32 v16, v10
    v_cos_f32 v17, v11
    v_cos_f32 v18, v12
    v_cos_f32 v19, v13
    v_sin_f32 v20, v10
    v_sin_f32 v21, v11
    v_sin_f32 v22, v12
    v_sin_f32 v23, v13
    v_mul_f32 v24, v128, v16
    v_mul_f32 v28, v132, v16
    v_mul_f32 v25, v129, v17
    v_mul_f32 v29, v133, v17
    v_mul_f32 v26, v130, v18
    v_mul_f32 v30, v134, v18
    v_mul_f32 v27, v131, v19
    v_mul_f32 v31, v135, v19
    v_fma_f32 v24, -v132, v20, v24
    v_fma_f32 v28, v128, v20, v28
    v_fma_f32 v25, -v133, v21, v25
    v_fma_f32 v29, v129, v21, v29
    v_fma_f32 v26, -v134, v22, v26
    v_fma_f32 v30, v130, v22, v30
    v_fma_f32 v27, -v135, v23, v27
    v_fma_f32 v31, v131, v23, v31
    v_cvt_pk_bf16_f32 v176, v28, v29
    v_cvt_pk_bf16_f32 v177, v30, v31
    v_cvt_pk_bf16_f32 v178, v24, v25
    v_cvt_pk_bf16_f32 v179, v26, v27
    v_add_f32 v8, 0x41800000, v6
    v_mul_f32 v8, 0x3a000000, v8
    v_mul_f32 v9, 4.0, v7
    v_mul_f32 v9, v9, v8
    v_fmamk_f32 v10, v8, 0x0, v9
    v_fmamk_f32 v11, v8, 0x3f800000, v9
    v_fmamk_f32 v12, v8, 0x40000000, v9
    v_fmamk_f32 v13, v8, 0x40400000, v9
    v_cos_f32 v16, v10
    v_cos_f32 v17, v11
    v_cos_f32 v18, v12
    v_cos_f32 v19, v13
    v_sin_f32 v20, v10
    v_sin_f32 v21, v11
    v_sin_f32 v22, v12
    v_sin_f32 v23, v13
    v_mul_f32 v24, v104, v16
    v_mul_f32 v28, v108, v16
    v_mul_f32 v25, v105, v17
    v_mul_f32 v29, v109, v17
    v_mul_f32 v26, v106, v18
    v_mul_f32 v30, v110, v18
    v_mul_f32 v27, v107, v19
    v_mul_f32 v31, v111, v19
    v_fma_f32 v24, -v108, v20, v24
    v_fma_f32 v28, v104, v20, v28
    v_fma_f32 v25, -v109, v21, v25
    v_fma_f32 v29, v105, v21, v29
    v_fma_f32 v26, -v110, v22, v26
    v_fma_f32 v30, v106, v22, v30
    v_fma_f32 v27, -v111, v23, v27
    v_fma_f32 v31, v107, v23, v31
    v_cvt_pk_bf16_f32 v164, v28, v29
    v_cvt_pk_bf16_f32 v165, v30, v31
    v_cvt_pk_bf16_f32 v166, v24, v25
    v_cvt_pk_bf16_f32 v167, v26, v27
    v_fmamk_f32 v10, v8, 0x41800000, v9
    v_fmamk_f32 v11, v8, 0x41880000, v9
    v_fmamk_f32 v12, v8, 0x41900000, v9
    v_fmamk_f32 v13, v8, 0x41980000, v9
    v_cos_f32 v16, v10
    v_cos_f32 v17, v11
    v_cos_f32 v18, v12
    v_cos_f32 v19, v13
    v_sin_f32 v20, v10
    v_sin_f32 v21, v11
    v_sin_f32 v22, v12
    v_sin_f32 v23, v13
    v_mul_f32 v24, v136, v16
    v_mul_f32 v28, v140, v16
    v_mul_f32 v25, v137, v17
    v_mul_f32 v29, v141, v17
    v_mul_f32 v26, v138, v18
    v_mul_f32 v30, v142, v18
    v_mul_f32 v27, v139, v19
    v_mul_f32 v31, v143, v19
    v_fma_f32 v24, -v140, v20, v24
    v_fma_f32 v28, v136, v20, v28
    v_fma_f32 v25, -v141, v21, v25
    v_fma_f32 v29, v137, v21, v29
    v_fma_f32 v26, -v142, v22, v26
    v_fma_f32 v30, v138, v22, v30
    v_fma_f32 v27, -v143, v23, v27
    v_fma_f32 v31, v139, v23, v31
    v_cvt_pk_bf16_f32 v180, v28, v29
    v_cvt_pk_bf16_f32 v181, v30, v31
    v_cvt_pk_bf16_f32 v182, v24, v25
    v_cvt_pk_bf16_f32 v183, v26, v27
    v_add_f32 v8, 0x42000000, v6
    v_mul_f32 v8, 0x3a000000, v8
    v_mul_f32 v9, 4.0, v7
    v_mul_f32 v9, v9, v8
    v_fmamk_f32 v10, v8, 0x0, v9
    v_fmamk_f32 v11, v8, 0x3f800000, v9
    v_fmamk_f32 v12, v8, 0x40000000, v9
    v_fmamk_f32 v13, v8, 0x40400000, v9
    v_cos_f32 v16, v10
    v_cos_f32 v17, v11
    v_cos_f32 v18, v12
    v_cos_f32 v19, v13
    v_sin_f32 v20, v10
    v_sin_f32 v21, v11
    v_sin_f32 v22, v12
    v_sin_f32 v23, v13
    v_mul_f32 v24, v112, v16
    v_mul_f32 v28, v116, v16
    v_mul_f32 v25, v113, v17
    v_mul_f32 v29, v117, v17
    v_mul_f32 v26, v114, v18
    v_mul_f32 v30, v118, v18
    v_mul_f32 v27, v115, v19
    v_mul_f32 v31, v119, v19
    v_fma_f32 v24, -v116, v20, v24
    v_fma_f32 v28, v112, v20, v28
    v_fma_f32 v25, -v117, v21, v25
    v_fma_f32 v29, v113, v21, v29
    v_fma_f32 v26, -v118, v22, v26
    v_fma_f32 v30, v114, v22, v30
    v_fma_f32 v27, -v119, v23, v27
    v_fma_f32 v31, v115, v23, v31
    v_cvt_pk_bf16_f32 v168, v28, v29
    v_cvt_pk_bf16_f32 v169, v30, v31
    v_cvt_pk_bf16_f32 v170, v24, v25
    v_cvt_pk_bf16_f32 v171, v26, v27
    v_fmamk_f32 v10, v8, 0x41800000, v9
    v_fmamk_f32 v11, v8, 0x41880000, v9
    v_fmamk_f32 v12, v8, 0x41900000, v9
    v_fmamk_f32 v13, v8, 0x41980000, v9
    v_cos_f32 v16, v10
    v_cos_f32 v17, v11
    v_cos_f32 v18, v12
    v_cos_f32 v19, v13
    v_sin_f32 v20, v10
    v_sin_f32 v21, v11
    v_sin_f32 v22, v12
    v_sin_f32 v23, v13
    v_mul_f32 v24, v144, v16
    v_mul_f32 v28, v148, v16
    v_mul_f32 v25, v145, v17
    v_mul_f32 v29, v149, v17
    v_mul_f32 v26, v146, v18
    v_mul_f32 v30, v150, v18
    v_mul_f32 v27, v147, v19
    v_mul_f32 v31, v151, v19
    v_fma_f32 v24, -v148, v20, v24
    v_fma_f32 v28, v144, v20, v28
    v_fma_f32 v25, -v149, v21, v25
    v_fma_f32 v29, v145, v21, v29
    v_fma_f32 v26, -v150, v22, v26
    v_fma_f32 v30, v146, v22, v30
    v_fma_f32 v27, -v151, v23, v27
    v_fma_f32 v31, v147, v23, v31
    v_cvt_pk_bf16_f32 v184, v28, v29
    v_cvt_pk_bf16_f32 v185, v30, v31
    v_cvt_pk_bf16_f32 v186, v24, v25
    v_cvt_pk_bf16_f32 v187, v26, v27
    v_add_f32 v8, 0x42400000, v6
    v_mul_f32 v8, 0x3a000000, v8
    v_mul_f32 v9, 4.0, v7
    v_mul_f32 v9, v9, v8
    v_fmamk_f32 v10, v8, 0x0, v9
    v_fmamk_f32 v11, v8, 0x3f800000, v9
    v_fmamk_f32 v12, v8, 0x40000000, v9
    v_fmamk_f32 v13, v8, 0x40400000, v9
    v_cos_f32 v16, v10
    v_cos_f32 v17, v11
    v_cos_f32 v18, v12
    v_cos_f32 v19, v13
    v_sin_f32 v20, v10
    v_sin_f32 v21, v11
    v_sin_f32 v22, v12
    v_sin_f32 v23, v13
    v_mul_f32 v24, v120, v16
    v_mul_f32 v28, v124, v16
    v_mul_f32 v25, v121, v17
    v_mul_f32 v29, v125, v17
    v_mul_f32 v26, v122, v18
    v_mul_f32 v30, v126, v18
    v_mul_f32 v27, v123, v19
    v_mul_f32 v31, v127, v19
    v_fma_f32 v24, -v124, v20, v24
    v_fma_f32 v28, v120, v20, v28
    v_fma_f32 v25, -v125, v21, v25
    v_fma_f32 v29, v121, v21, v29
    v_fma_f32 v26, -v126, v22, v26
    v_fma_f32 v30, v122, v22, v30
    v_fma_f32 v27, -v127, v23, v27
    v_fma_f32 v31, v123, v23, v31
    v_cvt_pk_bf16_f32 v172, v28, v29
    v_cvt_pk_bf16_f32 v173, v30, v31
    v_cvt_pk_bf16_f32 v174, v24, v25
    v_cvt_pk_bf16_f32 v175, v26, v27
    v_fmamk_f32 v10, v8, 0x41800000, v9
    v_fmamk_f32 v11, v8, 0x41880000, v9
    v_fmamk_f32 v12, v8, 0x41900000, v9
    v_fmamk_f32 v13, v8, 0x41980000, v9
    v_cos_f32 v16, v10
    v_cos_f32 v17, v11
    v_cos_f32 v18, v12
    v_cos_f32 v19, v13
    v_sin_f32 v20, v10
    v_sin_f32 v21, v11
    v_sin_f32 v22, v12
    v_sin_f32 v23, v13
    v_mul_f32 v24, v152, v16
    v_mul_f32 v28, v156, v16
    v_mul_f32 v25, v153, v17
    v_mul_f32 v29, v157, v17
    v_mul_f32 v26, v154, v18
    v_mul_f32 v30, v158, v18
    v_mul_f32 v27, v155, v19
    v_mul_f32 v31, v159, v19
    v_fma_f32 v24, -v156, v20, v24
    v_fma_f32 v28, v152, v20, v28
    v_fma_f32 v25, -v157, v21, v25
    v_fma_f32 v29, v153, v21, v29
    v_fma_f32 v26, -v158, v22, v26
    v_fma_f32 v30, v154, v22, v30
    v_fma_f32 v27, -v159, v23, v27
    v_fma_f32 v31, v155, v23, v31
    v_cvt_pk_bf16_f32 v188, v28, v29
    v_cvt_pk_bf16_f32 v189, v30, v31
    v_cvt_pk_bf16_f32 v190, v24, v25
    v_cvt_pk_bf16_f32 v191, v26, v27
    v_mfma_f32_16x16x32_bf16 v[96:99], v[160:163], a[96:99], 0
    v_mfma_f32_16x16x32_bf16 v[96:99], v[176:179], a[102:105], v[96:99]
    v_mfma_f32_16x16x32_bf16 v[100:103], v[160:163], a[98:101], 0
    v_mfma_f32_16x16x32_bf16 v[100:103], v[176:179], a[104:107], v[100:103]
    v_mfma_f32_16x16x32_bf16 v[104:107], v[160:163], a[108:111], 0
    v_mfma_f32_16x16x32_bf16 v[104:107], v[176:179], a[114:117], v[104:107]
    v_mfma_f32_16x16x32_bf16 v[108:111], v[160:163], a[110:113], 0
    v_mfma_f32_16x16x32_bf16 v[108:111], v[176:179], a[116:119], v[108:111]
    v_mfma_f32_16x16x32_bf16 v[112:115], v[164:167], a[96:99], 0
    v_mfma_f32_16x16x32_bf16 v[112:115], v[180:183], a[102:105], v[112:115]
    v_mfma_f32_16x16x32_bf16 v[116:119], v[164:167], a[98:101], 0
    v_mfma_f32_16x16x32_bf16 v[116:119], v[180:183], a[104:107], v[116:119]
    v_mfma_f32_16x16x32_bf16 v[120:123], v[164:167], a[108:111], 0
    v_mfma_f32_16x16x32_bf16 v[120:123], v[180:183], a[114:117], v[120:123]
    v_mfma_f32_16x16x32_bf16 v[124:127], v[164:167], a[110:113], 0
    v_mfma_f32_16x16x32_bf16 v[124:127], v[180:183], a[116:119], v[124:127]
    v_mfma_f32_16x16x32_bf16 v[128:131], v[168:171], a[96:99], 0
    v_mfma_f32_16x16x32_bf16 v[128:131], v[184:187], a[102:105], v[128:131]
    v_mfma_f32_16x16x32_bf16 v[132:135], v[168:171], a[98:101], 0
    v_mfma_f32_16x16x32_bf16 v[132:135], v[184:187], a[104:107], v[132:135]
    v_mfma_f32_16x16x32_bf16 v[136:139], v[168:171], a[108:111], 0
    v_mfma_f32_16x16x32_bf16 v[136:139], v[184:187], a[114:117], v[136:139]
    v_mfma_f32_16x16x32_bf16 v[140:143], v[168:171], a[110:113], 0
    v_mfma_f32_16x16x32_bf16 v[140:143], v[184:187], a[116:119], v[140:143]
    v_mfma_f32_16x16x32_bf16 v[144:147], v[172:175], a[96:99], 0
    v_mfma_f32_16x16x32_bf16 v[144:147], v[188:191], a[102:105], v[144:147]
    v_mfma_f32_16x16x32_bf16 v[148:151], v[172:175], a[98:101], 0
    v_mfma_f32_16x16x32_bf16 v[148:151], v[188:191], a[104:107], v[148:151]
    v_mfma_f32_16x16x32_bf16 v[152:155], v[172:175], a[108:111], 0
    v_mfma_f32_16x16x32_bf16 v[152:155], v[188:191], a[114:117], v[152:155]
    v_mfma_f32_16x16x32_bf16 v[156:159], v[172:175], a[110:113], 0
    v_mfma_f32_16x16x32_bf16 v[156:159], v[188:191], a[116:119], v[156:159]
    v_mul_u32_u24 v8, 272, v4
    v_lshl_add_u32 v8, v5, 4, v8
    s_mul_i32 s29, s3, 8704
    v_add_u32 v8, s29, v8
    v_cvt_pk_bf16_f32 v32, v96, v100
    v_cvt_pk_bf16_f32 v33, v97, v101
    v_cvt_pk_bf16_f32 v34, v98, v102
    v_cvt_pk_bf16_f32 v35, v99, v103
    ds_write_b128 v8, v[32:35] offset:0
    v_cvt_pk_bf16_f32 v36, v104, v108
    v_cvt_pk_bf16_f32 v37, v105, v109
    v_cvt_pk_bf16_f32 v38, v106, v110
    v_cvt_pk_bf16_f32 v39, v107, v111
    ds_write_b128 v8, v[36:39] offset:4352
    v_cvt_pk_bf16_f32 v40, v112, v116
    v_cvt_pk_bf16_f32 v41, v113, v117
    v_cvt_pk_bf16_f32 v42, v114, v118
    v_cvt_pk_bf16_f32 v43, v115, v119
    ds_write_b128 v8, v[40:43] offset:64
    v_cvt_pk_bf16_f32 v44, v120, v124
    v_cvt_pk_bf16_f32 v45, v121, v125
    v_cvt_pk_bf16_f32 v46, v122, v126
    v_cvt_pk_bf16_f32 v47, v123, v127
    ds_write_b128 v8, v[44:47] offset:4416
    v_cvt_pk_bf16_f32 v48, v128, v132
    v_cvt_pk_bf16_f32 v49, v129, v133
    v_cvt_pk_bf16_f32 v50, v130, v134
    v_cvt_pk_bf16_f32 v51, v131, v135
    ds_write_b128 v8, v[48:51] offset:128
    v_cvt_pk_bf16_f32 v52, v136, v140
    v_cvt_pk_bf16_f32 v53, v137, v141
    v_cvt_pk_bf16_f32 v54, v138, v142
    v_cvt_pk_bf16_f32 v55, v139, v143
    ds_write_b128 v8, v[52:55] offset:4480
    v_cvt_pk_bf16_f32 v56, v144, v148
    v_cvt_pk_bf16_f32 v57, v145, v149
    v_cvt_pk_bf16_f32 v58, v146, v150
    v_cvt_pk_bf16_f32 v59, v147, v151
    ds_write_b128 v8, v[56:59] offset:192
    v_cvt_pk_bf16_f32 v60, v152, v156
    v_cvt_pk_bf16_f32 v61, v153, v157
    v_cvt_pk_bf16_f32 v62, v154, v158
    v_cvt_pk_bf16_f32 v63, v155, v159
    ds_write_b128 v8, v[60:63] offset:4544
    s_mul_i32 s29, s3, 272
    v_lshlrev_b32 v8, 2, v0
    v_add_u32 v8, s29, v8
    s_lshl_b32 s29, s26, 15
    s_lshl_b32 s30, s3, 10
    s_add_u32 s29, s29, s30
    s_add_u32 s29, s29, 22478848
    v_add_u32 v9, s29, v1
    s_waitcnt lgkmcnt(0)
    s_barrier
    ds_read_b32 v64, v8 offset:0
    ds_read_b32 v65, v8 offset:8704
    ds_read_b32 v66, v8 offset:17408
    ds_read_b32 v67, v8 offset:26112
    ds_read_b32 v68, v8 offset:1088
    ds_read_b32 v69, v8 offset:9792
    ds_read_b32 v70, v8 offset:18496
    ds_read_b32 v71, v8 offset:27200
    ds_read_b32 v72, v8 offset:2176
    ds_read_b32 v73, v8 offset:10880
    ds_read_b32 v74, v8 offset:19584
    ds_read_b32 v75, v8 offset:28288
    ds_read_b32 v76, v8 offset:3264
    ds_read_b32 v77, v8 offset:11968
    ds_read_b32 v78, v8 offset:20672
    ds_read_b32 v79, v8 offset:29376
    ds_read_b32 v80, v8 offset:4352
    ds_read_b32 v81, v8 offset:13056
    ds_read_b32 v82, v8 offset:21760
    ds_read_b32 v83, v8 offset:30464
    ds_read_b32 v84, v8 offset:5440
    ds_read_b32 v85, v8 offset:14144
    ds_read_b32 v86, v8 offset:22848
    ds_read_b32 v87, v8 offset:31552
    ds_read_b32 v88, v8 offset:6528
    ds_read_b32 v89, v8 offset:15232
    ds_read_b32 v90, v8 offset:23936
    ds_read_b32 v91, v8 offset:32640
    ds_read_b32 v92, v8 offset:7616
    ds_read_b32 v93, v8 offset:16320
    ds_read_b32 v94, v8 offset:25024
    ds_read_b32 v95, v8 offset:33728
    s_waitcnt lgkmcnt(15)
    global_store_dwordx4 v9, v[64:67], s[12:13] sc1
    v_add_u32 v9, 4096, v9
    s_waitcnt lgkmcnt(15)
    global_store_dwordx4 v9, v[68:71], s[12:13] sc1
    v_add_u32 v9, 4096, v9
    s_waitcnt lgkmcnt(15)
    global_store_dwordx4 v9, v[72:75], s[12:13] sc1
    v_add_u32 v9, 4096, v9
    s_waitcnt lgkmcnt(15)
    global_store_dwordx4 v9, v[76:79], s[12:13] sc1
    v_add_u32 v9, 4096, v9
    s_waitcnt lgkmcnt(12)
    global_store_dwordx4 v9, v[80:83], s[12:13] sc1
    v_add_u32 v9, 4096, v9
    s_waitcnt lgkmcnt(8)
    global_store_dwordx4 v9, v[84:87], s[12:13] sc1
    v_add_u32 v9, 4096, v9
    s_waitcnt lgkmcnt(4)
    global_store_dwordx4 v9, v[88:91], s[12:13] sc1
    v_add_u32 v9, 4096, v9
    s_waitcnt lgkmcnt(0)
    global_store_dwordx4 v9, v[92:95], s[12:13] sc1
    s_waitcnt vmcnt(0)
    s_barrier
    s_cmp_lg_u32 s3, 0
    s_cbranch_scc1 SG_18
    s_mov_b64 exec, 1
    v_mov_b32 v3, 15872
    v_mov_b32 v2, 1
    global_atomic_add v3, v2, s[18:19] sc1
    s_mov_b64 exec, -1
SG_18:
    s_branch P2_loop
P3_loop:
    s_cmp_lg_u32 s3, 0
    s_cbranch_scc1 BC_19
    s_mov_b64 exec, 1
    v_mov_b32 v3, 15616
    v_mov_b32 v2, 1
    global_atomic_add v2, v3, v2, s[18:19] sc0 sc1
    s_waitcnt vmcnt(0)
    v_mov_b32 v3, 163596
    ds_write_b32 v3, v2
    s_mov_b64 exec, -1
    s_waitcnt lgkmcnt(0)
BC_19:
    s_barrier
    v_mov_b32 v3, 163596
    ds_read_b32 v2, v3
    s_waitcnt lgkmcnt(0)
    v_readfirstlane_b32 s26, v2
    s_cmp_ge_u32 s26, 64
    s_cbranch_scc1 FFT_done
    s_and_b32 s27, s26, 1
    s_lshl_b32 s27, s27, 2
    s_add_u32 s27, s27, s3
    s_lshr_b32 s28, s26, 1
    s_cmp_eq_u32 s27, 7
    s_cbranch_scc1 P3_wait
    v_lshrrev_b32 v8, 2, v4
    v_and_b32 v9, 3, v4
    v_lshl_add_u32 v16, v8, 3, v9
    s_lshl_b32 s29, s27, 6
    v_add_u32 v16, s29, v16
    v_cmp_eq_u32 vcc, 0, v5
    s_nop 1
    v_cndmask_b32 v17, 1.0, 0.5, vcc
    v_add_u32 v10, 0, v16
    v_cvt_f32_u32 v8, v10
    v_mul_f32 v8, 0x3b124925, v8
    v_mul_f32 v9, 4.0, v7
    v_mul_f32 v9, v9, v8
    v_lshlrev_b32 v10, 15, v10
    v_and_b32 v10, 0x8000, v10
    v_or_b32 v10, 0x3f00, v10
    v_cndmask_b32 v10, 0, v10, vcc
    v_accvgpr_write_b32 a56, v10
    v_accvgpr_write_b32 a57, 0
    v_accvgpr_write_b32 a58, 0
    v_accvgpr_write_b32 a59, 0
    v_fmamk_f32 v10, v8, 0x0, v9
    v_fmamk_f32 v11, v8, 0x3f800000, v9
    v_cos_f32 v12, v10
    v_sin_f32 v13, v10
    v_cos_f32 v14, v11
    v_sin_f32 v15, v11
    v_mul_f32 v12, v12, v17
    v_cvt_pk_bf16_f32 v12, v12, -v13
    v_cvt_pk_bf16_f32 v14, v14, -v15
    v_accvgpr_write_b32 a0, v12
    v_accvgpr_write_b32 a1, v14
    v_fmamk_f32 v10, v8, 0x40000000, v9
    v_fmamk_f32 v11, v8, 0x40400000, v9
    v_cos_f32 v12, v10
    v_sin_f32 v13, v10
    v_cos_f32 v14, v11
    v_sin_f32 v15, v11
    v_cvt_pk_bf16_f32 v12, v12, -v13
    v_cvt_pk_bf16_f32 v14, v14, -v15
    v_accvgpr_write_b32 a2, v12
    v_accvgpr_write_b32 a3, v14
    v_fmamk_f32 v10, v8, 0x41800000, v9
    v_fmamk_f32 v11, v8, 0x41880000, v9
    v_cos_f32 v12, v10
    v_sin_f32 v13, v10
    v_cos_f32 v14, v11
    v_sin_f32 v15, v11
    v_cvt_pk_bf16_f32 v12, v12, -v13
    v_cvt_pk_bf16_f32 v14, v14, -v15
    v_accvgpr_write_b32 a4, v12
    v_accvgpr_write_b32 a5, v14
    v_fmamk_f32 v10, v8, 0x41900000, v9
    v_fmamk_f32 v11, v8, 0x41980000, v9
    v_cos_f32 v12, v10
    v_sin_f32 v13, v10
    v_cos_f32 v14, v11
    v_sin_f32 v15, v11
    v_cvt_pk_bf16_f32 v12, v12, -v13
    v_cvt_pk_bf16_f32 v14, v14, -v15
    v_accvgpr_write_b32 a6, v12
    v_accvgpr_write_b32 a7, v14
    v_fmamk_f32 v10, v8, 0x42000000, v9
    v_fmamk_f32 v11, v8, 0x42040000, v9
    v_cos_f32 v12, v10
    v_sin_f32 v13, v10
    v_cos_f32 v14, v11
    v_sin_f32 v15, v11
    v_cvt_pk_bf16_f32 v12, v12, -v13
    v_cvt_pk_bf16_f32 v14, v14, -v15
    v_accvgpr_write_b32 a8, v12
    v_accvgpr_write_b32 a9, v14
    v_fmamk_f32 v10, v8, 0x42080000, v9
    v_fmamk_f32 v11, v8, 0x420c0000, v9
    v_cos_f32 v12, v10
    v_sin_f32 v13, v10
    v_cos_f32 v14, v11
    v_sin_f32 v15, v11
    v_cvt_pk_bf16_f32 v12, v12, -v13
    v_cvt_pk_bf16_f32 v14, v14, -v15
    v_accvgpr_write_b32 a10, v12
    v_accvgpr_write_b32 a11, v14
    v_fmamk_f32 v10, v8, 0x42400000, v9
    v_fmamk_f32 v11, v8, 0x42440000, v9
    v_cos_f32 v12, v10
    v_sin_f32 v13, v10
    v_cos_f32 v14, v11
    v_sin_f32 v15, v11
    v_cvt_pk_bf16_f32 v12, v12, -v13
    v_cvt_pk_bf16_f32 v14, v14, -v15
    v_accvgpr_write_b32 a12, v12
    v_accvgpr_write_b32 a13, v14
    v_fmamk_f32 v10, v8, 0x42480000, v9
    v_fmamk_f32 v11, v8, 0x424c0000, v9
    v_cos_f32 v12, v10
    v_sin_f32 v13, v10
    v_cos_f32 v14, v11
    v_sin_f32 v15, v11
    v_cvt_pk_bf16_f32 v12, v12, -v13
    v_cvt_pk_bf16_f32 v14, v14, -v15
    v_accvgpr_write_b32 a14, v12
    v_accvgpr_write_b32 a15, v14
    v_fmamk_f32 v10, v8, 0x42800000, v9
    v_fmamk_f32 v11, v8, 0x42820000, v9
    v_cos_f32 v12, v10
    v_sin_f32 v13, v10
    v_cos_f32 v14, v11
    v_sin_f32 v15, v11
    v_cvt_pk_bf16_f32 v12, v12, -v13
    v_cvt_pk_bf16_f32 v14, v14, -v15
    v_accvgpr_write_b32 a16, v12
    v_accvgpr_write_b32 a17, v14
    v_fmamk_f32 v10, v8, 0x42840000, v9
    v_fmamk_f32 v11, v8, 0x42860000, v9
    v_cos_f32 v12, v10
    v_sin_f32 v13, v10
    v_cos_f32 v14, v11
    v_sin_f32 v15, v11
    v_cvt_pk_bf16_f32 v12, v12, -v13
    v_cvt_pk_bf16_f32 v14, v14, -v15
    v_accvgpr_write_b32 a18, v12
    v_accvgpr_write_b32 a19, v14
    v_fmamk_f32 v10, v8, 0x42a00000, v9
    v_fmamk_f32 v11, v8, 0x42a20000, v9
    v_cos_f32 v12, v10
    v_sin_f32 v13, v10
    v_cos_f32 v14, v11
    v_sin_f32 v15, v11
    v_cvt_pk_bf16_f32 v12, v12, -v13
    v_cvt_pk_bf16_f32 v14, v14, -v15
    v_accvgpr_write_b32 a20, v12
    v_accvgpr_write_b32 a21, v14
    v_fmamk_f32 v10, v8, 0x42a40000, v9
    v_fmamk_f32 v11, v8, 0x42a60000, v9
    v_cos_f32 v12, v10
    v_sin_f32 v13, v10
    v_cos_f32 v14, v11
    v_sin_f32 v15, v11
    v_cvt_pk_bf16_f32 v12, v12, -v13
    v_cvt_pk_bf16_f32 v14, v14, -v15
    v_accvgpr_write_b32 a22, v12
    v_accvgpr_write_b32 a23, v14
    v_fmamk_f32 v10, v8, 0x42c00000, v9
    v_fmamk_f32 v11, v8, 0x42c20000, v9
    v_cos_f32 v12, v10
    v_sin_f32 v13, v10
    v_cos_f32 v14, v11
    v_sin_f32 v15, v11
    v_cvt_pk_bf16_f32 v12, v12, -v13
    v_cvt_pk_bf16_f32 v14, v14, -v15
    v_accvgpr_write_b32 a24, v12
    v_accvgpr_write_b32 a25, v14
    v_fmamk_f32 v10, v8, 0x42c40000, v9
    v_fmamk_f32 v11, v8, 0x42c60000, v9
    v_cos_f32 v12, v10
    v_sin_f32 v13, v10
    v_cos_f32 v14, v11
    v_sin_f32 v15, v11
    v_cvt_pk_bf16_f32 v12, v12, -v13
    v_cvt_pk_bf16_f32 v14, v14, -v15
    v_accvgpr_write_b32 a26, v12
    v_accvgpr_write_b32 a27, v14
    v_fmamk_f32 v10, v8, 0x42e00000, v9
    v_fmamk_f32 v11, v8, 0x42e20000, v9
    v_cos_f32 v12, v10
    v_sin_f32 v13, v10
    v_cos_f32 v14, v11
    v_sin_f32 v15, v11
    v_cvt_pk_bf16_f32 v12, v12, -v13
    v_cvt_pk_bf16_f32 v14, v14, -v15
    v_accvgpr_write_b32 a28, v12
    v_accvgpr_write_b32 a29, v14
    v_fmamk_f32 v10, v8, 0x42e40000, v9
    v_fmamk_f32 v11, v8, 0x42e60000, v9
    v_cos_f32 v12, v10
    v_sin_f32 v13, v10
    v_cos_f32 v14, v11
    v_sin_f32 v15, v11
    v_cvt_pk_bf16_f32 v12, v12, -v13
    v_cvt_pk_bf16_f32 v14, v14, -v15
    v_accvgpr_write_b32 a30, v12
    v_accvgpr_write_b32 a31, v14
    v_fmamk_f32 v10, v8, 0x43000000, v9
    v_fmamk_f32 v11, v8, 0x43010000, v9
    v_cos_f32 v12, v10
    v_sin_f32 v13, v10
    v_cos_f32 v14, v11
    v_sin_f32 v15, v11
    v_cvt_pk_bf16_f32 v12, v12, -v13
    v_cvt_pk_bf16_f32 v14, v14, -v15
    v_accvgpr_write_b32 a32, v12
    v_accvgpr_write_b32 a33, v14
    v_fmamk_f32 v10, v8, 0x43020000, v9
    v_fmamk_f32 v11, v8, 0x43030000, v9
    v_cos_f32 v12, v10
    v_sin_f32 v13, v10
    v_cos_f32 v14, v11
    v_sin_f32 v15, v11
    v_cvt_pk_bf16_f32 v12, v12, -v13
    v_cvt_pk_bf16_f32 v14, v14, -v15
    v_accvgpr_write_b32 a34, v12
    v_accvgpr_write_b32 a35, v14
    v_fmamk_f32 v10, v8, 0x43100000, v9
    v_fmamk_f32 v11, v8, 0x43110000, v9
    v_cos_f32 v12, v10
    v_sin_f32 v13, v10
    v_cos_f32 v14, v11
    v_sin_f32 v15, v11
    v_cvt_pk_bf16_f32 v12, v12, -v13
    v_cvt_pk_bf16_f32 v14, v14, -v15
    v_accvgpr_write_b32 a36, v12
    v_accvgpr_write_b32 a37, v14
    v_fmamk_f32 v10, v8, 0x43120000, v9
    v_fmamk_f32 v11, v8, 0x43130000, v9
    v_cos_f32 v12, v10
    v_sin_f32 v13, v10
    v_cos_f32 v14, v11
    v_sin_f32 v15, v11
    v_cvt_pk_bf16_f32 v12, v12, -v13
    v_cvt_pk_bf16_f32 v14, v14, -v15
    v_accvgpr_write_b32 a38, v12
    v_accvgpr_write_b32 a39, v14
    v_fmamk_f32 v10, v8, 0x43200000, v9
    v_fmamk_f32 v11, v8, 0x43210000, v9
    v_cos_f32 v12, v10
    v_sin_f32 v13, v10
    v_cos_f32 v14, v11
    v_sin_f32 v15, v11
    v_cvt_pk_bf16_f32 v12, v12, -v13
    v_cvt_pk_bf16_f32 v14, v14, -v15
    v_accvgpr_write_b32 a40, v12
    v_accvgpr_write_b32 a41, v14
    v_fmamk_f32 v10, v8, 0x43220000, v9
    v_fmamk_f32 v11, v8, 0x43230000, v9
    v_cos_f32 v12, v10
    v_sin_f32 v13, v10
    v_cos_f32 v14, v11
    v_sin_f32 v15, v11
    v_cvt_pk_bf16_f32 v12, v12, -v13
    v_cvt_pk_bf16_f32 v14, v14, -v15
    v_accvgpr_write_b32 a42, v12
    v_accvgpr_write_b32 a43, v14
    v_fmamk_f32 v10, v8, 0x43300000, v9
    v_fmamk_f32 v11, v8, 0x43310000, v9
    v_cos_f32 v12, v10
    v_sin_f32 v13, v10
    v_cos_f32 v14, v11
    v_sin_f32 v15, v11
    v_cvt_pk_bf16_f32 v12, v12, -v13
    v_cvt_pk_bf16_f32 v14, v14, -v15
    v_accvgpr_write_b32 a44, v12
    v_accvgpr_write_b32 a45, v14
    v_fmamk_f32 v10, v8, 0x43320000, v9
    v_fmamk_f32 v11, v8, 0x43330000, v9
    v_cos_f32 v12, v10
    v_sin_f32 v13, v10
    v_cos_f32 v14, v11
    v_sin_f32 v15, v11
    v_cvt_pk_bf16_f32 v12, v12, -v13
    v_cvt_pk_bf16_f32 v14, v14, -v15
    v_accvgpr_write_b32 a46, v12
    v_accvgpr_write_b32 a47, v14
    v_fmamk_f32 v10, v8, 0x43400000, v9
    v_fmamk_f32 v11, v8, 0x43410000, v9
    v_cos_f32 v12, v10
    v_sin_f32 v13, v10
    v_cos_f32 v14, v11
    v_sin_f32 v15, v11
    v_cvt_pk_bf16_f32 v12, v12, -v13
    v_cvt_pk_bf16_f32 v14, v14, -v15
    v_accvgpr_write_b32 a48, v12
    v_accvgpr_write_b32 a49, v14
    v_fmamk_f32 v10, v8, 0x43420000, v9
    v_fmamk_f32 v11, v8, 0x43430000, v9
    v_cos_f32 v12, v10
    v_sin_f32 v13, v10
    v_cos_f32 v14, v11
    v_sin_f32 v15, v11
    v_cvt_pk_bf16_f32 v12, v12, -v13
    v_cvt_pk_bf16_f32 v14, v14, -v15
    v_accvgpr_write_b32 a50, v12
    v_accvgpr_write_b32 a51, v14
    v_fmamk_f32 v10, v8, 0x43500000, v9
    v_fmamk_f32 v11, v8, 0x43510000, v9
    v_cos_f32 v12, v10
    v_sin_f32 v13, v10
    v_cos_f32 v14, v11
    v_sin_f32 v15, v11
    v_cvt_pk_bf16_f32 v12, v12, -v13
    v_cvt_pk_bf16_f32 v14, v14, -v15
    v_accvgpr_write_b32 a52, v12
    v_accvgpr_write_b32 a53, v14
    v_fmamk_f32 v10, v8, 0x43520000, v9
    v_fmamk_f32 v11, v8, 0x43530000, v9
    v_cos_f32 v12, v10
    v_sin_f32 v13, v10
    v_cos_f32 v14, v11
    v_sin_f32 v15, v11
    v_cvt_pk_bf16_f32 v12, v12, -v13
    v_cvt_pk_bf16_f32 v14, v14, -v15
    v_accvgpr_write_b32 a54, v12
    v_accvgpr_write_b32 a55, v14
    v_add_u32 v10, 4, v16
    v_cvt_f32_u32 v8, v10
    v_mul_f32 v8, 0x3b124925, v8
    v_mul_f32 v9, 4.0, v7
    v_mul_f32 v9, v9, v8
    v_lshlrev_b32 v10, 15, v10
    v_and_b32 v10, 0x8000, v10
    v_or_b32 v10, 0x3f00, v10
    v_cndmask_b32 v10, 0, v10, vcc
    v_accvgpr_write_b32 a116, v10
    v_accvgpr_write_b32 a117, 0
    v_accvgpr_write_b32 a118, 0
    v_accvgpr_write_b32 a119, 0
    v_fmamk_f32 v10, v8, 0x0, v9
    v_fmamk_f32 v11, v8, 0x3f800000, v9
    v_cos_f32 v12, v10
    v_sin_f32 v13, v10
    v_cos_f32 v14, v11
    v_sin_f32 v15, v11
    v_mul_f32 v12, v12, v17
    v_cvt_pk_bf16_f32 v12, v12, -v13
    v_cvt_pk_bf16_f32 v14, v14, -v15
    v_accvgpr_write_b32 a60, v12
    v_accvgpr_write_b32 a61, v14
    v_fmamk_f32 v10, v8, 0x40000000, v9
    v_fmamk_f32 v11, v8, 0x40400000, v9
    v_cos_f32 v12, v10
    v_sin_f32 v13, v10
    v_cos_f32 v14, v11
    v_sin_f32 v15, v11
    v_cvt_pk_bf16_f32 v12, v12, -v13
    v_cvt_pk_bf16_f32 v14, v14, -v15
    v_accvgpr_write_b32 a62, v12
    v_accvgpr_write_b32 a63, v14
    v_fmamk_f32 v10, v8, 0x41800000, v9
    v_fmamk_f32 v11, v8, 0x41880000, v9
    v_cos_f32 v12, v10
    v_sin_f32 v13, v10
    v_cos_f32 v14, v11
    v_sin_f32 v15, v11
    v_cvt_pk_bf16_f32 v12, v12, -v13
    v_cvt_pk_bf16_f32 v14, v14, -v15
    v_accvgpr_write_b32 a64, v12
    v_accvgpr_write_b32 a65, v14
    v_fmamk_f32 v10, v8, 0x41900000, v9
    v_fmamk_f32 v11, v8, 0x41980000, v9
    v_cos_f32 v12, v10
    v_sin_f32 v13, v10
    v_cos_f32 v14, v11
    v_sin_f32 v15, v11
    v_cvt_pk_bf16_f32 v12, v12, -v13
    v_cvt_pk_bf16_f32 v14, v14, -v15
    v_accvgpr_write_b32 a66, v12
    v_accvgpr_write_b32 a67, v14
    v_fmamk_f32 v10, v8, 0x42000000, v9
    v_fmamk_f32 v11, v8, 0x42040000, v9
    v_cos_f32 v12, v10
    v_sin_f32 v13, v10
    v_cos_f32 v14, v11
    v_sin_f32 v15, v11
    v_cvt_pk_bf16_f32 v12, v12, -v13
    v_cvt_pk_bf16_f32 v14, v14, -v15
    v_accvgpr_write_b32 a68, v12
    v_accvgpr_write_b32 a69, v14
    v_fmamk_f32 v10, v8, 0x42080000, v9
    v_fmamk_f32 v11, v8, 0x420c0000, v9
    v_cos_f32 v12, v10
    v_sin_f32 v13, v10
    v_cos_f32 v14, v11
    v_sin_f32 v15, v11
    v_cvt_pk_bf16_f32 v12, v12, -v13
    v_cvt_pk_bf16_f32 v14, v14, -v15
    v_accvgpr_write_b32 a70, v12
    v_accvgpr_write_b32 a71, v14
    v_fmamk_f32 v10, v8, 0x42400000, v9
    v_fmamk_f32 v11, v8, 0x42440000, v9
    v_cos_f32 v12, v10
    v_sin_f32 v13, v10
    v_cos_f32 v14, v11
    v_sin_f32 v15, v11
    v_cvt_pk_bf16_f32 v12, v12, -v13
    v_cvt_pk_bf16_f32 v14, v14, -v15
    v_accvgpr_write_b32 a72, v12
    v_accvgpr_write_b32 a73, v14
    v_fmamk_f32 v10, v8, 0x42480000, v9
    v_fmamk_f32 v11, v8, 0x424c0000, v9
    v_cos_f32 v12, v10
    v_sin_f32 v13, v10
    v_cos_f32 v14, v11
    v_sin_f32 v15, v11
    v_cvt_pk_bf16_f32 v12, v12, -v13
    v_cvt_pk_bf16_f32 v14, v14, -v15
    v_accvgpr_write_b32 a74, v12
    v_accvgpr_write_b32 a75, v14
    v_fmamk_f32 v10, v8, 0x42800000, v9
    v_fmamk_f32 v11, v8, 0x42820000, v9
    v_cos_f32 v12, v10
    v_sin_f32 v13, v10
    v_cos_f32 v14, v11
    v_sin_f32 v15, v11
    v_cvt_pk_bf16_f32 v12, v12, -v13
    v_cvt_pk_bf16_f32 v14, v14, -v15
    v_accvgpr_write_b32 a76, v12
    v_accvgpr_write_b32 a77, v14
    v_fmamk_f32 v10, v8, 0x42840000, v9
    v_fmamk_f32 v11, v8, 0x42860000, v9
    v_cos_f32 v12, v10
    v_sin_f32 v13, v10
    v_cos_f32 v14, v11
    v_sin_f32 v15, v11
    v_cvt_pk_bf16_f32 v12, v12, -v13
    v_cvt_pk_bf16_f32 v14, v14, -v15
    v_accvgpr_write_b32 a78, v12
    v_accvgpr_write_b32 a79, v14
    v_fmamk_f32 v10, v8, 0x42a00000, v9
    v_fmamk_f32 v11, v8, 0x42a20000, v9
    v_cos_f32 v12, v10
    v_sin_f32 v13, v10
    v_cos_f32 v14, v11
    v_sin_f32 v15, v11
    v_cvt_pk_bf16_f32 v12, v12, -v13
    v_cvt_pk_bf16_f32 v14, v14, -v15
    v_accvgpr_write_b32 a80, v12
    v_accvgpr_write_b32 a81, v14
    v_fmamk_f32 v10, v8, 0x42a40000, v9
    v_fmamk_f32 v11, v8, 0x42a60000, v9
    v_cos_f32 v12, v10
    v_sin_f32 v13, v10
    v_cos_f32 v14, v11
    v_sin_f32 v15, v11
    v_cvt_pk_bf16_f32 v12, v12, -v13
    v_cvt_pk_bf16_f32 v14, v14, -v15
    v_accvgpr_write_b32 a82, v12
    v_accvgpr_write_b32 a83, v14
    v_fmamk_f32 v10, v8, 0x42c00000, v9
    v_fmamk_f32 v11, v8, 0x42c20000, v9
    v_cos_f32 v12, v10
    v_sin_f32 v13, v10
    v_cos_f32 v14, v11
    v_sin_f32 v15, v11
    v_cvt_pk_bf16_f32 v12, v12, -v13
    v_cvt_pk_bf16_f32 v14, v14, -v15
    v_accvgpr_write_b32 a84, v12
    v_accvgpr_write_b32 a85, v14
    v_fmamk_f32 v10, v8, 0x42c40000, v9
    v_fmamk_f32 v11, v8, 0x42c60000, v9
    v_cos_f32 v12, v10
    v_sin_f32 v13, v10
    v_cos_f32 v14, v11
    v_sin_f32 v15, v11
    v_cvt_pk_bf16_f32 v12, v12, -v13
    v_cvt_pk_bf16_f32 v14, v14, -v15
    v_accvgpr_write_b32 a86, v12
    v_accvgpr_write_b32 a87, v14
    v_fmamk_f32 v10, v8, 0x42e00000, v9
    v_fmamk_f32 v11, v8, 0x42e20000, v9
    v_cos_f32 v12, v10
    v_sin_f32 v13, v10
    v_cos_f32 v14, v11
    v_sin_f32 v15, v11
    v_cvt_pk_bf16_f32 v12, v12, -v13
    v_cvt_pk_bf16_f32 v14, v14, -v15
    v_accvgpr_write_b32 a88, v12
    v_accvgpr_write_b32 a89, v14
    v_fmamk_f32 v10, v8, 0x42e40000, v9
    v_fmamk_f32 v11, v8, 0x42e60000, v9
    v_cos_f32 v12, v10
    v_sin_f32 v13, v10
    v_cos_f32 v14, v11
    v_sin_f32 v15, v11
    v_cvt_pk_bf16_f32 v12, v12, -v13
    v_cvt_pk_bf16_f32 v14, v14, -v15
    v_accvgpr_write_b32 a90, v12
    v_accvgpr_write_b32 a91, v14
    v_fmamk_f32 v10, v8, 0x43000000, v9
    v_fmamk_f32 v11, v8, 0x43010000, v9
    v_cos_f32 v12, v10
    v_sin_f32 v13, v10
    v_cos_f32 v14, v11
    v_sin_f32 v15, v11
    v_cvt_pk_bf16_f32 v12, v12, -v13
    v_cvt_pk_bf16_f32 v14, v14, -v15
    v_accvgpr_write_b32 a92, v12
    v_accvgpr_write_b32 a93, v14
    v_fmamk_f32 v10, v8, 0x43020000, v9
    v_fmamk_f32 v11, v8, 0x43030000, v9
    v_cos_f32 v12, v10
    v_sin_f32 v13, v10
    v_cos_f32 v14, v11
    v_sin_f32 v15, v11
    v_cvt_pk_bf16_f32 v12, v12, -v13
    v_cvt_pk_bf16_f32 v14, v14, -v15
    v_accvgpr_write_b32 a94, v12
    v_accvgpr_write_b32 a95, v14
    v_fmamk_f32 v10, v8, 0x43100000, v9
    v_fmamk_f32 v11, v8, 0x43110000, v9
    v_cos_f32 v12, v10
    v_sin_f32 v13, v10
    v_cos_f32 v14, v11
    v_sin_f32 v15, v11
    v_cvt_pk_bf16_f32 v12, v12, -v13
    v_cvt_pk_bf16_f32 v14, v14, -v15
    v_accvgpr_write_b32 a96, v12
    v_accvgpr_write_b32 a97, v14
    v_fmamk_f32 v10, v8, 0x43120000, v9
    v_fmamk_f32 v11, v8, 0x43130000, v9
    v_cos_f32 v12, v10
    v_sin_f32 v13, v10
    v_cos_f32 v14, v11
    v_sin_f32 v15, v11
    v_cvt_pk_bf16_f32 v12, v12, -v13
    v_cvt_pk_bf16_f32 v14, v14, -v15
    v_accvgpr_write_b32 a98, v12
    v_accvgpr_write_b32 a99, v14
    v_fmamk_f32 v10, v8, 0x43200000, v9
    v_fmamk_f32 v11, v8, 0x43210000, v9
    v_cos_f32 v12, v10
    v_sin_f32 v13, v10
    v_cos_f32 v14, v11
    v_sin_f32 v15, v11
    v_cvt_pk_bf16_f32 v12, v12, -v13
    v_cvt_pk_bf16_f32 v14, v14, -v15
    v_accvgpr_write_b32 a100, v12
    v_accvgpr_write_b32 a101, v14
    v_fmamk_f32 v10, v8, 0x43220000, v9
    v_fmamk_f32 v11, v8, 0x43230000, v9
    v_cos_f32 v12, v10
    v_sin_f32 v13, v10
    v_cos_f32 v14, v11
    v_sin_f32 v15, v11
    v_cvt_pk_bf16_f32 v12, v12, -v13
    v_cvt_pk_bf16_f32 v14, v14, -v15
    v_accvgpr_write_b32 a102, v12
    v_accvgpr_write_b32 a103, v14
    v_fmamk_f32 v10, v8, 0x43300000, v9
    v_fmamk_f32 v11, v8, 0x43310000, v9
    v_cos_f32 v12, v10
    v_sin_f32 v13, v10
    v_cos_f32 v14, v11
    v_sin_f32 v15, v11
    v_cvt_pk_bf16_f32 v12, v12, -v13
    v_cvt_pk_bf16_f32 v14, v14, -v15
    v_accvgpr_write_b32 a104, v12
    v_accvgpr_write_b32 a105, v14
    v_fmamk_f32 v10, v8, 0x43320000, v9
    v_fmamk_f32 v11, v8, 0x43330000, v9
    v_cos_f32 v12, v10
    v_sin_f32 v13, v10
    v_cos_f32 v14, v11
    v_sin_f32 v15, v11
    v_cvt_pk_bf16_f32 v12, v12, -v13
    v_cvt_pk_bf16_f32 v14, v14, -v15
    v_accvgpr_write_b32 a106, v12
    v_accvgpr_write_b32 a107, v14
    v_fmamk_f32 v10, v8, 0x43400000, v9
    v_fmamk_f32 v11, v8, 0x43410000, v9
    v_cos_f32 v12, v10
    v_sin_f32 v13, v10
    v_cos_f32 v14, v11
    v_sin_f32 v15, v11
    v_cvt_pk_bf16_f32 v12, v12, -v13
    v_cvt_pk_bf16_f32 v14, v14, -v15
    v_accvgpr_write_b32 a108, v12
    v_accvgpr_write_b32 a109, v14
    v_fmamk_f32 v10, v8, 0x43420000, v9
    v_fmamk_f32 v11, v8, 0x43430000, v9
    v_cos_f32 v12, v10
    v_sin_f32 v13, v10
    v_cos_f32 v14, v11
    v_sin_f32 v15, v11
    v_cvt_pk_bf16_f32 v12, v12, -v13
    v_cvt_pk_bf16_f32 v14, v14, -v15
    v_accvgpr_write_b32 a110, v12
    v_accvgpr_write_b32 a111, v14
    v_fmamk_f32 v10, v8, 0x43500000, v9
    v_fmamk_f32 v11, v8, 0x43510000, v9
    v_cos_f32 v12, v10
    v_sin_f32 v13, v10
    v_cos_f32 v14, v11
    v_sin_f32 v15, v11
    v_cvt_pk_bf16_f32 v12, v12, -v13
    v_cvt_pk_bf16_f32 v14, v14, -v15
    v_accvgpr_write_b32 a112, v12
    v_accvgpr_write_b32 a113, v14
    v_fmamk_f32 v10, v8, 0x43520000, v9
    v_fmamk_f32 v11, v8, 0x43530000, v9
    v_cos_f32 v12, v10
    v_sin_f32 v13, v10
    v_cos_f32 v14, v11
    v_sin_f32 v15, v11
    v_cvt_pk_bf16_f32 v12, v12, -v13
    v_cvt_pk_bf16_f32 v14, v14, -v15
    v_accvgpr_write_b32 a114, v12
    v_accvgpr_write_b32 a115, v14
    v_add_u32 v10, 32, v16
    v_cvt_f32_u32 v8, v10
    v_mul_f32 v8, 0x3b124925, v8
    v_mul_f32 v9, 4.0, v7
    v_mul_f32 v9, v9, v8
    v_lshlrev_b32 v10, 15, v10
    v_and_b32 v10, 0x8000, v10
    v_or_b32 v10, 0x3f00, v10
    v_cndmask_b32 v10, 0, v10, vcc
    v_accvgpr_write_b32 a176, v10
    v_accvgpr_write_b32 a177, 0
    v_accvgpr_write_b32 a178, 0
    v_accvgpr_write_b32 a179, 0
    v_fmamk_f32 v10, v8, 0x0, v9
    v_fmamk_f32 v11, v8, 0x3f800000, v9
    v_cos_f32 v12, v10
    v_sin_f32 v13, v10
    v_cos_f32 v14, v11
    v_sin_f32 v15, v11
    v_mul_f32 v12, v12, v17
    v_cvt_pk_bf16_f32 v12, v12, -v13
    v_cvt_pk_bf16_f32 v14, v14, -v15
    v_accvgpr_write_b32 a120, v12
    v_accvgpr_write_b32 a121, v14
    v_fmamk_f32 v10, v8, 0x40000000, v9
    v_fmamk_f32 v11, v8, 0x40400000, v9
    v_cos_f32 v12, v10
    v_sin_f32 v13, v10
    v_cos_f32 v14, v11
    v_sin_f32 v15, v11
    v_cvt_pk_bf16_f32 v12, v12, -v13
    v_cvt_pk_bf16_f32 v14, v14, -v15
    v_accvgpr_write_b32 a122, v12
    v_accvgpr_write_b32 a123, v14
    v_fmamk_f32 v10, v8, 0x41800000, v9
    v_fmamk_f32 v11, v8, 0x41880000, v9
    v_cos_f32 v12, v10
    v_sin_f32 v13, v10
    v_cos_f32 v14, v11
    v_sin_f32 v15, v11
    v_cvt_pk_bf16_f32 v12, v12, -v13
    v_cvt_pk_bf16_f32 v14, v14, -v15
    v_accvgpr_write_b32 a124, v12
    v_accvgpr_write_b32 a125, v14
    v_fmamk_f32 v10, v8, 0x41900000, v9
    v_fmamk_f32 v11, v8, 0x41980000, v9
    v_cos_f32 v12, v10
    v_sin_f32 v13, v10
    v_cos_f32 v14, v11
    v_sin_f32 v15, v11
    v_cvt_pk_bf16_f32 v12, v12, -v13
    v_cvt_pk_bf16_f32 v14, v14, -v15
    v_accvgpr_write_b32 a126, v12
    v_accvgpr_write_b32 a127, v14
    v_fmamk_f32 v10, v8, 0x42000000, v9
    v_fmamk_f32 v11, v8, 0x42040000, v9
    v_cos_f32 v12, v10
    v_sin_f32 v13, v10
    v_cos_f32 v14, v11
    v_sin_f32 v15, v11
    v_cvt_pk_bf16_f32 v12, v12, -v13
    v_cvt_pk_bf16_f32 v14, v14, -v15
    v_accvgpr_write_b32 a128, v12
    v_accvgpr_write_b32 a129, v14
    v_fmamk_f32 v10, v8, 0x42080000, v9
    v_fmamk_f32 v11, v8, 0x420c0000, v9
    v_cos_f32 v12, v10
    v_sin_f32 v13, v10
    v_cos_f32 v14, v11
    v_sin_f32 v15, v11
    v_cvt_pk_bf16_f32 v12, v12, -v13
    v_cvt_pk_bf16_f32 v14, v14, -v15
    v_accvgpr_write_b32 a130, v12
    v_accvgpr_write_b32 a131, v14
    v_fmamk_f32 v10, v8, 0x42400000, v9
    v_fmamk_f32 v11, v8, 0x42440000, v9
    v_cos_f32 v12, v10
    v_sin_f32 v13, v10
    v_cos_f32 v14, v11
    v_sin_f32 v15, v11
    v_cvt_pk_bf16_f32 v12, v12, -v13
    v_cvt_pk_bf16_f32 v14, v14, -v15
    v_accvgpr_write_b32 a132, v12
    v_accvgpr_write_b32 a133, v14
    v_fmamk_f32 v10, v8, 0x42480000, v9
    v_fmamk_f32 v11, v8, 0x424c0000, v9
    v_cos_f32 v12, v10
    v_sin_f32 v13, v10
    v_cos_f32 v14, v11
    v_sin_f32 v15, v11
    v_cvt_pk_bf16_f32 v12, v12, -v13
    v_cvt_pk_bf16_f32 v14, v14, -v15
    v_accvgpr_write_b32 a134, v12
    v_accvgpr_write_b32 a135, v14
    v_fmamk_f32 v10, v8, 0x42800000, v9
    v_fmamk_f32 v11, v8, 0x42820000, v9
    v_cos_f32 v12, v10
    v_sin_f32 v13, v10
    v_cos_f32 v14, v11
    v_sin_f32 v15, v11
    v_cvt_pk_bf16_f32 v12, v12, -v13
    v_cvt_pk_bf16_f32 v14, v14, -v15
    v_accvgpr_write_b32 a136, v12
    v_accvgpr_write_b32 a137, v14
    v_fmamk_f32 v10, v8, 0x42840000, v9
    v_fmamk_f32 v11, v8, 0x42860000, v9
    v_cos_f32 v12, v10
    v_sin_f32 v13, v10
    v_cos_f32 v14, v11
    v_sin_f32 v15, v11
    v_cvt_pk_bf16_f32 v12, v12, -v13
    v_cvt_pk_bf16_f32 v14, v14, -v15
    v_accvgpr_write_b32 a138, v12
    v_accvgpr_write_b32 a139, v14
    v_fmamk_f32 v10, v8, 0x42a00000, v9
    v_fmamk_f32 v11, v8, 0x42a20000, v9
    v_cos_f32 v12, v10
    v_sin_f32 v13, v10
    v_cos_f32 v14, v11
    v_sin_f32 v15, v11
    v_cvt_pk_bf16_f32 v12, v12, -v13
    v_cvt_pk_bf16_f32 v14, v14, -v15
    v_accvgpr_write_b32 a140, v12
    v_accvgpr_write_b32 a141, v14
    v_fmamk_f32 v10, v8, 0x42a40000, v9
    v_fmamk_f32 v11, v8, 0x42a60000, v9
    v_cos_f32 v12, v10
    v_sin_f32 v13, v10
    v_cos_f32 v14, v11
    v_sin_f32 v15, v11
    v_cvt_pk_bf16_f32 v12, v12, -v13
    v_cvt_pk_bf16_f32 v14, v14, -v15
    v_accvgpr_write_b32 a142, v12
    v_accvgpr_write_b32 a143, v14
    v_fmamk_f32 v10, v8, 0x42c00000, v9
    v_fmamk_f32 v11, v8, 0x42c20000, v9
    v_cos_f32 v12, v10
    v_sin_f32 v13, v10
    v_cos_f32 v14, v11
    v_sin_f32 v15, v11
    v_cvt_pk_bf16_f32 v12, v12, -v13
    v_cvt_pk_bf16_f32 v14, v14, -v15
    v_accvgpr_write_b32 a144, v12
    v_accvgpr_write_b32 a145, v14
    v_fmamk_f32 v10, v8, 0x42c40000, v9
    v_fmamk_f32 v11, v8, 0x42c60000, v9
    v_cos_f32 v12, v10
    v_sin_f32 v13, v10
    v_cos_f32 v14, v11
    v_sin_f32 v15, v11
    v_cvt_pk_bf16_f32 v12, v12, -v13
    v_cvt_pk_bf16_f32 v14, v14, -v15
    v_accvgpr_write_b32 a146, v12
    v_accvgpr_write_b32 a147, v14
    v_fmamk_f32 v10, v8, 0x42e00000, v9
    v_fmamk_f32 v11, v8, 0x42e20000, v9
    v_cos_f32 v12, v10
    v_sin_f32 v13, v10
    v_cos_f32 v14, v11
    v_sin_f32 v15, v11
    v_cvt_pk_bf16_f32 v12, v12, -v13
    v_cvt_pk_bf16_f32 v14, v14, -v15
    v_accvgpr_write_b32 a148, v12
    v_accvgpr_write_b32 a149, v14
    v_fmamk_f32 v10, v8, 0x42e40000, v9
    v_fmamk_f32 v11, v8, 0x42e60000, v9
    v_cos_f32 v12, v10
    v_sin_f32 v13, v10
    v_cos_f32 v14, v11
    v_sin_f32 v15, v11
    v_cvt_pk_bf16_f32 v12, v12, -v13
    v_cvt_pk_bf16_f32 v14, v14, -v15
    v_accvgpr_write_b32 a150, v12
    v_accvgpr_write_b32 a151, v14
    v_fmamk_f32 v10, v8, 0x43000000, v9
    v_fmamk_f32 v11, v8, 0x43010000, v9
    v_cos_f32 v12, v10
    v_sin_f32 v13, v10
    v_cos_f32 v14, v11
    v_sin_f32 v15, v11
    v_cvt_pk_bf16_f32 v12, v12, -v13
    v_cvt_pk_bf16_f32 v14, v14, -v15
    v_accvgpr_write_b32 a152, v12
    v_accvgpr_write_b32 a153, v14
    v_fmamk_f32 v10, v8, 0x43020000, v9
    v_fmamk_f32 v11, v8, 0x43030000, v9
    v_cos_f32 v12, v10
    v_sin_f32 v13, v10
    v_cos_f32 v14, v11
    v_sin_f32 v15, v11
    v_cvt_pk_bf16_f32 v12, v12, -v13
    v_cvt_pk_bf16_f32 v14, v14, -v15
    v_accvgpr_write_b32 a154, v12
    v_accvgpr_write_b32 a155, v14
    v_fmamk_f32 v10, v8, 0x43100000, v9
    v_fmamk_f32 v11, v8, 0x43110000, v9
    v_cos_f32 v12, v10
    v_sin_f32 v13, v10
    v_cos_f32 v14, v11
    v_sin_f32 v15, v11
    v_cvt_pk_bf16_f32 v12, v12, -v13
    v_cvt_pk_bf16_f32 v14, v14, -v15
    v_accvgpr_write_b32 a156, v12
    v_accvgpr_write_b32 a157, v14
    v_fmamk_f32 v10, v8, 0x43120000, v9
    v_fmamk_f32 v11, v8, 0x43130000, v9
    v_cos_f32 v12, v10
    v_sin_f32 v13, v10
    v_cos_f32 v14, v11
    v_sin_f32 v15, v11
    v_cvt_pk_bf16_f32 v12, v12, -v13
    v_cvt_pk_bf16_f32 v14, v14, -v15
    v_accvgpr_write_b32 a158, v12
    v_accvgpr_write_b32 a159, v14
    v_fmamk_f32 v10, v8, 0x43200000, v9
    v_fmamk_f32 v11, v8, 0x43210000, v9
    v_cos_f32 v12, v10
    v_sin_f32 v13, v10
    v_cos_f32 v14, v11
    v_sin_f32 v15, v11
    v_cvt_pk_bf16_f32 v12, v12, -v13
    v_cvt_pk_bf16_f32 v14, v14, -v15
    v_accvgpr_write_b32 a160, v12
    v_accvgpr_write_b32 a161, v14
    v_fmamk_f32 v10, v8, 0x43220000, v9
    v_fmamk_f32 v11, v8, 0x43230000, v9
    v_cos_f32 v12, v10
    v_sin_f32 v13, v10
    v_cos_f32 v14, v11
    v_sin_f32 v15, v11
    v_cvt_pk_bf16_f32 v12, v12, -v13
    v_cvt_pk_bf16_f32 v14, v14, -v15
    v_accvgpr_write_b32 a162, v12
    v_accvgpr_write_b32 a163, v14
    v_fmamk_f32 v10, v8, 0x43300000, v9
    v_fmamk_f32 v11, v8, 0x43310000, v9
    v_cos_f32 v12, v10
    v_sin_f32 v13, v10
    v_cos_f32 v14, v11
    v_sin_f32 v15, v11
    v_cvt_pk_bf16_f32 v12, v12, -v13
    v_cvt_pk_bf16_f32 v14, v14, -v15
    v_accvgpr_write_b32 a164, v12
    v_accvgpr_write_b32 a165, v14
    v_fmamk_f32 v10, v8, 0x43320000, v9
    v_fmamk_f32 v11, v8, 0x43330000, v9
    v_cos_f32 v12, v10
    v_sin_f32 v13, v10
    v_cos_f32 v14, v11
    v_sin_f32 v15, v11
    v_cvt_pk_bf16_f32 v12, v12, -v13
    v_cvt_pk_bf16_f32 v14, v14, -v15
    v_accvgpr_write_b32 a166, v12
    v_accvgpr_write_b32 a167, v14
    v_fmamk_f32 v10, v8, 0x43400000, v9
    v_fmamk_f32 v11, v8, 0x43410000, v9
    v_cos_f32 v12, v10
    v_sin_f32 v13, v10
    v_cos_f32 v14, v11
    v_sin_f32 v15, v11
    v_cvt_pk_bf16_f32 v12, v12, -v13
    v_cvt_pk_bf16_f32 v14, v14, -v15
    v_accvgpr_write_b32 a168, v12
    v_accvgpr_write_b32 a169, v14
    v_fmamk_f32 v10, v8, 0x43420000, v9
    v_fmamk_f32 v11, v8, 0x43430000, v9
    v_cos_f32 v12, v10
    v_sin_f32 v13, v10
    v_cos_f32 v14, v11
    v_sin_f32 v15, v11
    v_cvt_pk_bf16_f32 v12, v12, -v13
    v_cvt_pk_bf16_f32 v14, v14, -v15
    v_accvgpr_write_b32 a170, v12
    v_accvgpr_write_b32 a171, v14
    v_fmamk_f32 v10, v8, 0x43500000, v9
    v_fmamk_f32 v11, v8, 0x43510000, v9
    v_cos_f32 v12, v10
    v_sin_f32 v13, v10
    v_cos_f32 v14, v11
    v_sin_f32 v15, v11
    v_cvt_pk_bf16_f32 v12, v12, -v13
    v_cvt_pk_bf16_f32 v14, v14, -v15
    v_accvgpr_write_b32 a172, v12
    v_accvgpr_write_b32 a173, v14
    v_fmamk_f32 v10, v8, 0x43520000, v9
    v_fmamk_f32 v11, v8, 0x43530000, v9
    v_cos_f32 v12, v10
    v_sin_f32 v13, v10
    v_cos_f32 v14, v11
    v_sin_f32 v15, v11
    v_cvt_pk_bf16_f32 v12, v12, -v13
    v_cvt_pk_bf16_f32 v14, v14, -v15
    v_accvgpr_write_b32 a174, v12
    v_accvgpr_write_b32 a175, v14
    v_add_u32 v10, 36, v16
    v_cvt_f32_u32 v8, v10
    v_mul_f32 v8, 0x3b124925, v8
    v_mul_f32 v9, 4.0, v7
    v_mul_f32 v9, v9, v8
    v_lshlrev_b32 v10, 15, v10
    v_and_b32 v10, 0x8000, v10
    v_or_b32 v10, 0x3f00, v10
    v_cndmask_b32 v10, 0, v10, vcc
    v_accvgpr_write_b32 a236, v10
    v_accvgpr_write_b32 a237, 0
    v_accvgpr_write_b32 a238, 0
    v_accvgpr_write_b32 a239, 0
    v_fmamk_f32 v10, v8, 0x0, v9
    v_fmamk_f32 v11, v8, 0x3f800000, v9
    v_cos_f32 v12, v10
    v_sin_f32 v13, v10
    v_cos_f32 v14, v11
    v_sin_f32 v15, v11
    v_mul_f32 v12, v12, v17
    v_cvt_pk_bf16_f32 v12, v12, -v13
    v_cvt_pk_bf16_f32 v14, v14, -v15
    v_accvgpr_write_b32 a180, v12
    v_accvgpr_write_b32 a181, v14
    v_fmamk_f32 v10, v8, 0x40000000, v9
    v_fmamk_f32 v11, v8, 0x40400000, v9
    v_cos_f32 v12, v10
    v_sin_f32 v13, v10
    v_cos_f32 v14, v11
    v_sin_f32 v15, v11
    v_cvt_pk_bf16_f32 v12, v12, -v13
    v_cvt_pk_bf16_f32 v14, v14, -v15
    v_accvgpr_write_b32 a182, v12
    v_accvgpr_write_b32 a183, v14
    v_fmamk_f32 v10, v8, 0x41800000, v9
    v_fmamk_f32 v11, v8, 0x41880000, v9
    v_cos_f32 v12, v10
    v_sin_f32 v13, v10
    v_cos_f32 v14, v11
    v_sin_f32 v15, v11
    v_cvt_pk_bf16_f32 v12, v12, -v13
    v_cvt_pk_bf16_f32 v14, v14, -v15
    v_accvgpr_write_b32 a184, v12
    v_accvgpr_write_b32 a185, v14
    v_fmamk_f32 v10, v8, 0x41900000, v9
    v_fmamk_f32 v11, v8, 0x41980000, v9
    v_cos_f32 v12, v10
    v_sin_f32 v13, v10
    v_cos_f32 v14, v11
    v_sin_f32 v15, v11
    v_cvt_pk_bf16_f32 v12, v12, -v13
    v_cvt_pk_bf16_f32 v14, v14, -v15
    v_accvgpr_write_b32 a186, v12
    v_accvgpr_write_b32 a187, v14
    v_fmamk_f32 v10, v8, 0x42000000, v9
    v_fmamk_f32 v11, v8, 0x42040000, v9
    v_cos_f32 v12, v10
    v_sin_f32 v13, v10
    v_cos_f32 v14, v11
    v_sin_f32 v15, v11
    v_cvt_pk_bf16_f32 v12, v12, -v13
    v_cvt_pk_bf16_f32 v14, v14, -v15
    v_accvgpr_write_b32 a188, v12
    v_accvgpr_write_b32 a189, v14
    v_fmamk_f32 v10, v8, 0x42080000, v9
    v_fmamk_f32 v11, v8, 0x420c0000, v9
    v_cos_f32 v12, v10
    v_sin_f32 v13, v10
    v_cos_f32 v14, v11
    v_sin_f32 v15, v11
    v_cvt_pk_bf16_f32 v12, v12, -v13
    v_cvt_pk_bf16_f32 v14, v14, -v15
    v_accvgpr_write_b32 a190, v12
    v_accvgpr_write_b32 a191, v14
    v_fmamk_f32 v10, v8, 0x42400000, v9
    v_fmamk_f32 v11, v8, 0x42440000, v9
    v_cos_f32 v12, v10
    v_sin_f32 v13, v10
    v_cos_f32 v14, v11
    v_sin_f32 v15, v11
    v_cvt_pk_bf16_f32 v12, v12, -v13
    v_cvt_pk_bf16_f32 v14, v14, -v15
    v_accvgpr_write_b32 a192, v12
    v_accvgpr_write_b32 a193, v14
    v_fmamk_f32 v10, v8, 0x42480000, v9
    v_fmamk_f32 v11, v8, 0x424c0000, v9
    v_cos_f32 v12, v10
    v_sin_f32 v13, v10
    v_cos_f32 v14, v11
    v_sin_f32 v15, v11
    v_cvt_pk_bf16_f32 v12, v12, -v13
    v_cvt_pk_bf16_f32 v14, v14, -v15
    v_accvgpr_write_b32 a194, v12
    v_accvgpr_write_b32 a195, v14
    v_fmamk_f32 v10, v8, 0x42800000, v9
    v_fmamk_f32 v11, v8, 0x42820000, v9
    v_cos_f32 v12, v10
    v_sin_f32 v13, v10
    v_cos_f32 v14, v11
    v_sin_f32 v15, v11
    v_cvt_pk_bf16_f32 v12, v12, -v13
    v_cvt_pk_bf16_f32 v14, v14, -v15
    v_accvgpr_write_b32 a196, v12
    v_accvgpr_write_b32 a197, v14
    v_fmamk_f32 v10, v8, 0x42840000, v9
    v_fmamk_f32 v11, v8, 0x42860000, v9
    v_cos_f32 v12, v10
    v_sin_f32 v13, v10
    v_cos_f32 v14, v11
    v_sin_f32 v15, v11
    v_cvt_pk_bf16_f32 v12, v12, -v13
    v_cvt_pk_bf16_f32 v14, v14, -v15
    v_accvgpr_write_b32 a198, v12
    v_accvgpr_write_b32 a199, v14
    v_fmamk_f32 v10, v8, 0x42a00000, v9
    v_fmamk_f32 v11, v8, 0x42a20000, v9
    v_cos_f32 v12, v10
    v_sin_f32 v13, v10
    v_cos_f32 v14, v11
    v_sin_f32 v15, v11
    v_cvt_pk_bf16_f32 v12, v12, -v13
    v_cvt_pk_bf16_f32 v14, v14, -v15
    v_accvgpr_write_b32 a200, v12
    v_accvgpr_write_b32 a201, v14
    v_fmamk_f32 v10, v8, 0x42a40000, v9
    v_fmamk_f32 v11, v8, 0x42a60000, v9
    v_cos_f32 v12, v10
    v_sin_f32 v13, v10
    v_cos_f32 v14, v11
    v_sin_f32 v15, v11
    v_cvt_pk_bf16_f32 v12, v12, -v13
    v_cvt_pk_bf16_f32 v14, v14, -v15
    v_accvgpr_write_b32 a202, v12
    v_accvgpr_write_b32 a203, v14
    v_fmamk_f32 v10, v8, 0x42c00000, v9
    v_fmamk_f32 v11, v8, 0x42c20000, v9
    v_cos_f32 v12, v10
    v_sin_f32 v13, v10
    v_cos_f32 v14, v11
    v_sin_f32 v15, v11
    v_cvt_pk_bf16_f32 v12, v12, -v13
    v_cvt_pk_bf16_f32 v14, v14, -v15
    v_accvgpr_write_b32 a204, v12
    v_accvgpr_write_b32 a205, v14
    v_fmamk_f32 v10, v8, 0x42c40000, v9
    v_fmamk_f32 v11, v8, 0x42c60000, v9
    v_cos_f32 v12, v10
    v_sin_f32 v13, v10
    v_cos_f32 v14, v11
    v_sin_f32 v15, v11
    v_cvt_pk_bf16_f32 v12, v12, -v13
    v_cvt_pk_bf16_f32 v14, v14, -v15
    v_accvgpr_write_b32 a206, v12
    v_accvgpr_write_b32 a207, v14
    v_fmamk_f32 v10, v8, 0x42e00000, v9
    v_fmamk_f32 v11, v8, 0x42e20000, v9
    v_cos_f32 v12, v10
    v_sin_f32 v13, v10
    v_cos_f32 v14, v11
    v_sin_f32 v15, v11
    v_cvt_pk_bf16_f32 v12, v12, -v13
    v_cvt_pk_bf16_f32 v14, v14, -v15
    v_accvgpr_write_b32 a208, v12
    v_accvgpr_write_b32 a209, v14
    v_fmamk_f32 v10, v8, 0x42e40000, v9
    v_fmamk_f32 v11, v8, 0x42e60000, v9
    v_cos_f32 v12, v10
    v_sin_f32 v13, v10
    v_cos_f32 v14, v11
    v_sin_f32 v15, v11
    v_cvt_pk_bf16_f32 v12, v12, -v13
    v_cvt_pk_bf16_f32 v14, v14, -v15
    v_accvgpr_write_b32 a210, v12
    v_accvgpr_write_b32 a211, v14
    v_fmamk_f32 v10, v8, 0x43000000, v9
    v_fmamk_f32 v11, v8, 0x43010000, v9
    v_cos_f32 v12, v10
    v_sin_f32 v13, v10
    v_cos_f32 v14, v11
    v_sin_f32 v15, v11
    v_cvt_pk_bf16_f32 v12, v12, -v13
    v_cvt_pk_bf16_f32 v14, v14, -v15
    v_accvgpr_write_b32 a212, v12
    v_accvgpr_write_b32 a213, v14
    v_fmamk_f32 v10, v8, 0x43020000, v9
    v_fmamk_f32 v11, v8, 0x43030000, v9
    v_cos_f32 v12, v10
    v_sin_f32 v13, v10
    v_cos_f32 v14, v11
    v_sin_f32 v15, v11
    v_cvt_pk_bf16_f32 v12, v12, -v13
    v_cvt_pk_bf16_f32 v14, v14, -v15
    v_accvgpr_write_b32 a214, v12
    v_accvgpr_write_b32 a215, v14
    v_fmamk_f32 v10, v8, 0x43100000, v9
    v_fmamk_f32 v11, v8, 0x43110000, v9
    v_cos_f32 v12, v10
    v_sin_f32 v13, v10
    v_cos_f32 v14, v11
    v_sin_f32 v15, v11
    v_cvt_pk_bf16_f32 v12, v12, -v13
    v_cvt_pk_bf16_f32 v14, v14, -v15
    v_accvgpr_write_b32 a216, v12
    v_accvgpr_write_b32 a217, v14
    v_fmamk_f32 v10, v8, 0x43120000, v9
    v_fmamk_f32 v11, v8, 0x43130000, v9
    v_cos_f32 v12, v10
    v_sin_f32 v13, v10
    v_cos_f32 v14, v11
    v_sin_f32 v15, v11
    v_cvt_pk_bf16_f32 v12, v12, -v13
    v_cvt_pk_bf16_f32 v14, v14, -v15
    v_accvgpr_write_b32 a218, v12
    v_accvgpr_write_b32 a219, v14
    v_fmamk_f32 v10, v8, 0x43200000, v9
    v_fmamk_f32 v11, v8, 0x43210000, v9
    v_cos_f32 v12, v10
    v_sin_f32 v13, v10
    v_cos_f32 v14, v11
    v_sin_f32 v15, v11
    v_cvt_pk_bf16_f32 v12, v12, -v13
    v_cvt_pk_bf16_f32 v14, v14, -v15
    v_accvgpr_write_b32 a220, v12
    v_accvgpr_write_b32 a221, v14
    v_fmamk_f32 v10, v8, 0x43220000, v9
    v_fmamk_f32 v11, v8, 0x43230000, v9
    v_cos_f32 v12, v10
    v_sin_f32 v13, v10
    v_cos_f32 v14, v11
    v_sin_f32 v15, v11
    v_cvt_pk_bf16_f32 v12, v12, -v13
    v_cvt_pk_bf16_f32 v14, v14, -v15
    v_accvgpr_write_b32 a222, v12
    v_accvgpr_write_b32 a223, v14
    v_fmamk_f32 v10, v8, 0x43300000, v9
    v_fmamk_f32 v11, v8, 0x43310000, v9
    v_cos_f32 v12, v10
    v_sin_f32 v13, v10
    v_cos_f32 v14, v11
    v_sin_f32 v15, v11
    v_cvt_pk_bf16_f32 v12, v12, -v13
    v_cvt_pk_bf16_f32 v14, v14, -v15
    v_accvgpr_write_b32 a224, v12
    v_accvgpr_write_b32 a225, v14
    v_fmamk_f32 v10, v8, 0x43320000, v9
    v_fmamk_f32 v11, v8, 0x43330000, v9
    v_cos_f32 v12, v10
    v_sin_f32 v13, v10
    v_cos_f32 v14, v11
    v_sin_f32 v15, v11
    v_cvt_pk_bf16_f32 v12, v12, -v13
    v_cvt_pk_bf16_f32 v14, v14, -v15
    v_accvgpr_write_b32 a226, v12
    v_accvgpr_write_b32 a227, v14
    v_fmamk_f32 v10, v8, 0x43400000, v9
    v_fmamk_f32 v11, v8, 0x43410000, v9
    v_cos_f32 v12, v10
    v_sin_f32 v13, v10
    v_cos_f32 v14, v11
    v_sin_f32 v15, v11
    v_cvt_pk_bf16_f32 v12, v12, -v13
    v_cvt_pk_bf16_f32 v14, v14, -v15
    v_accvgpr_write_b32 a228, v12
    v_accvgpr_write_b32 a229, v14
    v_fmamk_f32 v10, v8, 0x43420000, v9
    v_fmamk_f32 v11, v8, 0x43430000, v9
    v_cos_f32 v12, v10
    v_sin_f32 v13, v10
    v_cos_f32 v14, v11
    v_sin_f32 v15, v11
    v_cvt_pk_bf16_f32 v12, v12, -v13
    v_cvt_pk_bf16_f32 v14, v14, -v15
    v_accvgpr_write_b32 a230, v12
    v_accvgpr_write_b32 a231, v14
    v_fmamk_f32 v10, v8, 0x43500000, v9
    v_fmamk_f32 v11, v8, 0x43510000, v9
    v_cos_f32 v12, v10
    v_sin_f32 v13, v10
    v_cos_f32 v14, v11
    v_sin_f32 v15, v11
    v_cvt_pk_bf16_f32 v12, v12, -v13
    v_cvt_pk_bf16_f32 v14, v14, -v15
    v_accvgpr_write_b32 a232, v12
    v_accvgpr_write_b32 a233, v14
    v_fmamk_f32 v10, v8, 0x43520000, v9
    v_fmamk_f32 v11, v8, 0x43530000, v9
    v_cos_f32 v12, v10
    v_sin_f32 v13, v10
    v_cos_f32 v14, v11
    v_sin_f32 v15, v11
    v_cvt_pk_bf16_f32 v12, v12, -v13
    v_cvt_pk_bf16_f32 v14, v14, -v15
    v_accvgpr_write_b32 a234, v12
    v_accvgpr_write_b32 a235, v14
P3_wait:
    s_cmp_lg_u32 s3, 0
    s_cbranch_scc1 WC_20
    v_mov_b32 v3, 15872
    s_mov_b32 s24, 524288
WP_21:
    global_load_dword v2, v3, s[18:19] sc1
    s_sub_u32 s24, s24, 1
    s_cbranch_scc1 BAIL_2
    s_waitcnt vmcnt(0)
    v_readfirstlane_b32 s25, v2
    s_cmp_ge_u32 s25, 57
    s_cbranch_scc1 WC_20
    s_sleep 4
    s_branch WP_21
WC_20:
    s_barrier
    s_cmp_eq_u32 s27, 7
    s_cbranch_scc1 P3_loop
    s_lshl_b32 s29, s28, 10
    v_lshlrev_b32 v9, 4, v4
    v_add_u32 v9, s29, v9
    v_lshl_add_u32 v8, v5, 15, v9
    s_add_u32 s30, s12, 22478848
    s_addc_u32 s31, s13, 0
    global_load_dwordx4 v[16:19], v8, s[30:31] offset:0 sc1
    global_load_dwordx4 v[76:79], v8, s[30:31] offset:256 sc1
    s_add_u32 s30, s30, 131072
    s_addc_u32 s31, s31, 0
    global_load_dwordx4 v[20:23], v8, s[30:31] offset:0 sc1
    global_load_dwordx4 v[80:83], v8, s[30:31] offset:256 sc1
    s_add_u32 s30, s30, 131072
    s_addc_u32 s31, s31, 0
    global_load_dwordx4 v[24:27], v8, s[30:31] offset:0 sc1
    global_load_dwordx4 v[84:87], v8, s[30:31] offset:256 sc1
    s_add_u32 s30, s30, 131072
    s_addc_u32 s31, s31, 0
    global_load_dwordx4 v[28:31], v8, s[30:31] offset:0 sc1
    global_load_dwordx4 v[88:91], v8, s[30:31] offset:256 sc1
    s_add_u32 s30, s30, 131072
    s_addc_u32 s31, s31, 0
    global_load_dwordx4 v[32:35], v8, s[30:31] offset:0 sc1
    global_load_dwordx4 v[92:95], v8, s[30:31] offset:256 sc1
    s_add_u32 s30, s30, 131072
    s_addc_u32 s31, s31, 0
    global_load_dwordx4 v[36:39], v8, s[30:31] offset:0 sc1
    global_load_dwordx4 v[96:99], v8, s[30:31] offset:256 sc1
    s_add_u32 s30, s30, 131072
    s_addc_u32 s31, s31, 0
    global_load_dwordx4 v[40:43], v8, s[30:31] offset:0 sc1
    global_load_dwordx4 v[100:103], v8, s[30:31] offset:256 sc1
    s_add_u32 s30, s30, 131072
    s_addc_u32 s31, s31, 0
    global_load_dwordx4 v[44:47], v8, s[30:31] offset:0 sc1
    global_load_dwordx4 v[104:107], v8, s[30:31] offset:256 sc1
    s_add_u32 s30, s30, 131072
    s_addc_u32 s31, s31, 0
    global_load_dwordx4 v[48:51], v8, s[30:31] offset:0 sc1
    global_load_dwordx4 v[108:111], v8, s[30:31] offset:256 sc1
    s_add_u32 s30, s30, 131072
    s_addc_u32 s31, s31, 0
    global_load_dwordx4 v[52:55], v8, s[30:31] offset:0 sc1
    global_load_dwordx4 v[112:115], v8, s[30:31] offset:256 sc1
    s_add_u32 s30, s30, 131072
    s_addc_u32 s31, s31, 0
    global_load_dwordx4 v[56:59], v8, s[30:31] offset:0 sc1
    global_load_dwordx4 v[116:119], v8, s[30:31] offset:256 sc1
    s_add_u32 s30, s30, 131072
    s_addc_u32 s31, s31, 0
    global_load_dwordx4 v[60:63], v8, s[30:31] offset:0 sc1
    global_load_dwordx4 v[120:123], v8, s[30:31] offset:256 sc1
    s_add_u32 s30, s30, 131072
    s_addc_u32 s31, s31, 0
    global_load_dwordx4 v[64:67], v8, s[30:31] offset:0 sc1
    global_load_dwordx4 v[124:127], v8, s[30:31] offset:256 sc1
    s_add_u32 s30, s30, 131072
    s_addc_u32 s31, s31, 0
    global_load_dwordx4 v[68:71], v8, s[30:31] offset:0 sc1
    global_load_dwordx4 v[128:131], v8, s[30:31] offset:256 sc1
    s_add_u32 s30, s30, 131072
    s_addc_u32 s31, s31, 0
    global_load_dwordx4 v[72:75], v9, s[30:31] offset:0 sc1
    global_load_dwordx4 v[132:135], v9, s[30:31] offset:256 sc1
    s_add_u32 s30, s12, 22478848
    s_addc_u32 s31, s13, 0
    global_load_dwordx4 v[136:139], v8, s[30:31] offset:512 sc1
    global_load_dwordx4 v[196:199], v8, s[30:31] offset:768 sc1
    s_add_u32 s30, s30, 131072
    s_addc_u32 s31, s31, 0
    global_load_dwordx4 v[140:143], v8, s[30:31] offset:512 sc1
    global_load_dwordx4 v[200:203], v8, s[30:31] offset:768 sc1
    s_add_u32 s30, s30, 131072
    s_addc_u32 s31, s31, 0
    global_load_dwordx4 v[144:147], v8, s[30:31] offset:512 sc1
    global_load_dwordx4 v[204:207], v8, s[30:31] offset:768 sc1
    s_add_u32 s30, s30, 131072
    s_addc_u32 s31, s31, 0
    global_load_dwordx4 v[148:151], v8, s[30:31] offset:512 sc1
    global_load_dwordx4 v[208:211], v8, s[30:31] offset:768 sc1
    s_add_u32 s30, s30, 131072
    s_addc_u32 s31, s31, 0
    global_load_dwordx4 v[152:155], v8, s[30:31] offset:512 sc1
    global_load_dwordx4 v[212:215], v8, s[30:31] offset:768 sc1
    s_add_u32 s30, s30, 131072
    s_addc_u32 s31, s31, 0
    global_load_dwordx4 v[156:159], v8, s[30:31] offset:512 sc1
    global_load_dwordx4 v[216:219], v8, s[30:31] offset:768 sc1
    s_add_u32 s30, s30, 131072
    s_addc_u32 s31, s31, 0
    global_load_dwordx4 v[160:163], v8, s[30:31] offset:512 sc1
    global_load_dwordx4 v[220:223], v8, s[30:31] offset:768 sc1
    s_add_u32 s30, s30, 131072
    s_addc_u32 s31, s31, 0
    global_load_dwordx4 v[164:167], v8, s[30:31] offset:512 sc1
    global_load_dwordx4 v[224:227], v8, s[30:31] offset:768 sc1
    s_add_u32 s30, s30, 131072
    s_addc_u32 s31, s31, 0
    global_load_dwordx4 v[168:171], v8, s[30:31] offset:512 sc1
    global_load_dwordx4 v[228:231], v8, s[30:31] offset:768 sc1
    s_add_u32 s30, s30, 131072
    s_addc_u32 s31, s31, 0
    global_load_dwordx4 v[172:175], v8, s[30:31] offset:512 sc1
    global_load_dwordx4 v[232:235], v8, s[30:31] offset:768 sc1
    s_add_u32 s30, s30, 131072
    s_addc_u32 s31, s31, 0
    global_load_dwordx4 v[176:179], v8, s[30:31] offset:512 sc1
    global_load_dwordx4 v[236:239], v8, s[30:31] offset:768 sc1
    s_add_u32 s30, s30, 131072
    s_addc_u32 s31, s31, 0
    global_load_dwordx4 v[180:183], v8, s[30:31] offset:512 sc1
    global_load_dwordx4 v[240:243], v8, s[30:31] offset:768 sc1
    s_add_u32 s30, s30, 131072
    s_addc_u32 s31, s31, 0
    global_load_dwordx4 v[184:187], v8, s[30:31] offset:512 sc1
    global_load_dwordx4 v[244:247], v8, s[30:31] offset:768 sc1
    s_add_u32 s30, s30, 131072
    s_addc_u32 s31, s31, 0
    global_load_dwordx4 v[188:191], v8, s[30:31] offset:512 sc1
    global_load_dwordx4 v[248:251], v8, s[30:31] offset:768 sc1
    s_add_u32 s30, s30, 131072
    s_addc_u32 s31, s31, 0
    global_load_dwordx4 v[192:195], v9, s[30:31] offset:512 sc1
    global_load_dwordx4 v[252:255], v9, s[30:31] offset:768 sc1
    s_mul_i32 s29, s28, 114688
    s_lshl_b32 s30, s27, 7
    s_add_u32 s29, s29, s30
    v_mul_u32_u24 v8, 1792, v4
    v_lshl_add_u32 v8, v5, 4, v8
    v_add_u32 v8, s29, v8
    s_mov_b32 s30, 0x36124925
    s_waitcnt vmcnt(30)
    v_mfma_f32_16x16x32_bf16 a[240:243], a[0:3], v[16:19], 0
    v_mfma_f32_16x16x32_bf16 a[244:247], a[60:63], v[16:19], 0
    v_mfma_f32_16x16x32_bf16 a[248:251], a[120:123], v[16:19], 0
    v_mfma_f32_16x16x32_bf16 a[252:255], a[180:183], v[16:19], 0
    v_mfma_f32_16x16x32_bf16 a[240:243], a[4:7], v[20:23], a[240:243]
    v_mfma_f32_16x16x32_bf16 a[244:247], a[64:67], v[20:23], a[244:247]
    v_mfma_f32_16x16x32_bf16 a[248:251], a[124:127], v[20:23], a[248:251]
    v_mfma_f32_16x16x32_bf16 a[252:255], a[184:187], v[20:23], a[252:255]
    v_mfma_f32_16x16x32_bf16 a[240:243], a[8:11], v[24:27], a[240:243]
    v_mfma_f32_16x16x32_bf16 a[244:247], a[68:71], v[24:27], a[244:247]
    v_mfma_f32_16x16x32_bf16 a[248:251], a[128:131], v[24:27], a[248:251]
    v_mfma_f32_16x16x32_bf16 a[252:255], a[188:191], v[24:27], a[252:255]
    v_mfma_f32_16x16x32_bf16 a[240:243], a[12:15], v[28:31], a[240:243]
    v_mfma_f32_16x16x32_bf16 a[244:247], a[72:75], v[28:31], a[244:247]
    v_mfma_f32_16x16x32_bf16 a[248:251], a[132:135], v[28:31], a[248:251]
    v_mfma_f32_16x16x32_bf16 a[252:255], a[192:195], v[28:31], a[252:255]
    v_mfma_f32_16x16x32_bf16 a[240:243], a[16:19], v[32:35], a[240:243]
    v_mfma_f32_16x16x32_bf16 a[244:247], a[76:79], v[32:35], a[244:247]
    v_mfma_f32_16x16x32_bf16 a[248:251], a[136:139], v[32:35], a[248:251]
    v_mfma_f32_16x16x32_bf16 a[252:255], a[196:199], v[32:35], a[252:255]
    v_mfma_f32_16x16x32_bf16 a[240:243], a[20:23], v[36:39], a[240:243]
    v_mfma_f32_16x16x32_bf16 a[244:247], a[80:83], v[36:39], a[244:247]
    v_mfma_f32_16x16x32_bf16 a[248:251], a[140:143], v[36:39], a[248:251]
    v_mfma_f32_16x16x32_bf16 a[252:255], a[200:203], v[36:39], a[252:255]
    v_mfma_f32_16x16x32_bf16 a[240:243], a[24:27], v[40:43], a[240:243]
    v_mfma_f32_16x16x32_bf16 a[244:247], a[84:87], v[40:43], a[244:247]
    v_mfma_f32_16x16x32_bf16 a[248:251], a[144:147], v[40:43], a[248:251]
    v_mfma_f32_16x16x32_bf16 a[252:255], a[204:207], v[40:43], a[252:255]
    v_mfma_f32_16x16x32_bf16 a[240:243], a[28:31], v[44:47], a[240:243]
    v_mfma_f32_16x16x32_bf16 a[244:247], a[88:91], v[44:47], a[244:247]
    v_mfma_f32_16x16x32_bf16 a[248:251], a[148:151], v[44:47], a[248:251]
    v_mfma_f32_16x16x32_bf16 a[252:255], a[208:211], v[44:47], a[252:255]
    v_mfma_f32_16x16x32_bf16 a[240:243], a[32:35], v[48:51], a[240:243]
    v_mfma_f32_16x16x32_bf16 a[244:247], a[92:95], v[48:51], a[244:247]
    v_mfma_f32_16x16x32_bf16 a[248:251], a[152:155], v[48:51], a[248:251]
    v_mfma_f32_16x16x32_bf16 a[252:255], a[212:215], v[48:51], a[252:255]
    v_mfma_f32_16x16x32_bf16 a[240:243], a[36:39], v[52:55], a[240:243]
    v_mfma_f32_16x16x32_bf16 a[244:247], a[96:99], v[52:55], a[244:247]
    v_mfma_f32_16x16x32_bf16 a[248:251], a[156:159], v[52:55], a[248:251]
    v_mfma_f32_16x16x32_bf16 a[252:255], a[216:219], v[52:55], a[252:255]
    v_mfma_f32_16x16x32_bf16 a[240:243], a[40:43], v[56:59], a[240:243]
    v_mfma_f32_16x16x32_bf16 a[244:247], a[100:103], v[56:59], a[244:247]
    v_mfma_f32_16x16x32_bf16 a[248:251], a[160:163], v[56:59], a[248:251]
    v_mfma_f32_16x16x32_bf16 a[252:255], a[220:223], v[56:59], a[252:255]
    v_mfma_f32_16x16x32_bf16 a[240:243], a[44:47], v[60:63], a[240:243]
    v_mfma_f32_16x16x32_bf16 a[244:247], a[104:107], v[60:63], a[244:247]
    v_mfma_f32_16x16x32_bf16 a[248:251], a[164:167], v[60:63], a[248:251]
    v_mfma_f32_16x16x32_bf16 a[252:255], a[224:227], v[60:63], a[252:255]
    v_mfma_f32_16x16x32_bf16 a[240:243], a[48:51], v[64:67], a[240:243]
    v_mfma_f32_16x16x32_bf16 a[244:247], a[108:111], v[64:67], a[244:247]
    v_mfma_f32_16x16x32_bf16 a[248:251], a[168:171], v[64:67], a[248:251]
    v_mfma_f32_16x16x32_bf16 a[252:255], a[228:231], v[64:67], a[252:255]
    v_mfma_f32_16x16x32_bf16 a[240:243], a[52:55], v[68:71], a[240:243]
    v_mfma_f32_16x16x32_bf16 a[244:247], a[112:115], v[68:71], a[244:247]
    v_mfma_f32_16x16x32_bf16 a[248:251], a[172:175], v[68:71], a[248:251]
    v_mfma_f32_16x16x32_bf16 a[252:255], a[232:235], v[68:71], a[252:255]
    v_mfma_f32_16x16x32_bf16 a[240:243], a[56:59], v[72:75], a[240:243]
    v_mfma_f32_16x16x32_bf16 a[244:247], a[116:119], v[72:75], a[244:247]
    v_mfma_f32_16x16x32_bf16 a[248:251], a[176:179], v[72:75], a[248:251]
    v_mfma_f32_16x16x32_bf16 a[252:255], a[236:239], v[72:75], a[252:255]
    v_accvgpr_read_b32 v16, a240
    v_accvgpr_read_b32 v17, a241
    v_accvgpr_read_b32 v18, a242
    v_accvgpr_read_b32 v19, a243
    v_accvgpr_read_b32 v20, a244
    v_accvgpr_read_b32 v21, a245
    v_accvgpr_read_b32 v22, a246
    v_accvgpr_read_b32 v23, a247
    v_accvgpr_read_b32 v24, a248
    v_accvgpr_read_b32 v25, a249
    v_accvgpr_read_b32 v26, a250
    v_accvgpr_read_b32 v27, a251
    v_accvgpr_read_b32 v28, a252
    v_accvgpr_read_b32 v29, a253
    v_accvgpr_read_b32 v30, a254
    v_accvgpr_read_b32 v31, a255
    v_mul_f32 v16, s30, v16
    v_mul_f32 v17, s30, v17
    v_mul_f32 v18, s30, v18
    v_mul_f32 v19, s30, v19
    v_mul_f32 v20, s30, v20
    v_mul_f32 v21, s30, v21
    v_mul_f32 v22, s30, v22
    v_mul_f32 v23, s30, v23
    v_mul_f32 v24, s30, v24
    v_mul_f32 v25, s30, v25
    v_mul_f32 v26, s30, v26
    v_mul_f32 v27, s30, v27
    v_mul_f32 v28, s30, v28
    v_mul_f32 v29, s30, v29
    v_mul_f32 v30, s30, v30
    v_mul_f32 v31, s30, v31
    v_cvt_pk_bf16_f32 v32, v16, v17
    v_cvt_pk_bf16_f32 v33, v18, v19
    v_cvt_pk_bf16_f32 v34, v20, v21
    v_cvt_pk_bf16_f32 v35, v22, v23
    v_cvt_pk_bf16_f32 v36, v24, v25
    v_cvt_pk_bf16_f32 v37, v26, v27
    v_cvt_pk_bf16_f32 v38, v28, v29
    v_cvt_pk_bf16_f32 v39, v30, v31
    global_store_dwordx4 v8, v[32:35], s[14:15]
    global_store_dwordx4 v8, v[36:39], s[14:15] offset:64
    v_add_u32 v8, 28672, v8
    v_mfma_f32_16x16x32_bf16 a[240:243], a[0:3], v[76:79], 0
    v_mfma_f32_16x16x32_bf16 a[244:247], a[60:63], v[76:79], 0
    v_mfma_f32_16x16x32_bf16 a[248:251], a[120:123], v[76:79], 0
    v_mfma_f32_16x16x32_bf16 a[252:255], a[180:183], v[76:79], 0
    v_mfma_f32_16x16x32_bf16 a[240:243], a[4:7], v[80:83], a[240:243]
    v_mfma_f32_16x16x32_bf16 a[244:247], a[64:67], v[80:83], a[244:247]
    v_mfma_f32_16x16x32_bf16 a[248:251], a[124:127], v[80:83], a[248:251]
    v_mfma_f32_16x16x32_bf16 a[252:255], a[184:187], v[80:83], a[252:255]
    v_mfma_f32_16x16x32_bf16 a[240:243], a[8:11], v[84:87], a[240:243]
    v_mfma_f32_16x16x32_bf16 a[244:247], a[68:71], v[84:87], a[244:247]
    v_mfma_f32_16x16x32_bf16 a[248:251], a[128:131], v[84:87], a[248:251]
    v_mfma_f32_16x16x32_bf16 a[252:255], a[188:191], v[84:87], a[252:255]
    v_mfma_f32_16x16x32_bf16 a[240:243], a[12:15], v[88:91], a[240:243]
    v_mfma_f32_16x16x32_bf16 a[244:247], a[72:75], v[88:91], a[244:247]
    v_mfma_f32_16x16x32_bf16 a[248:251], a[132:135], v[88:91], a[248:251]
    v_mfma_f32_16x16x32_bf16 a[252:255], a[192:195], v[88:91], a[252:255]
    v_mfma_f32_16x16x32_bf16 a[240:243], a[16:19], v[92:95], a[240:243]
    v_mfma_f32_16x16x32_bf16 a[244:247], a[76:79], v[92:95], a[244:247]
    v_mfma_f32_16x16x32_bf16 a[248:251], a[136:139], v[92:95], a[248:251]
    v_mfma_f32_16x16x32_bf16 a[252:255], a[196:199], v[92:95], a[252:255]
    v_mfma_f32_16x16x32_bf16 a[240:243], a[20:23], v[96:99], a[240:243]
    v_mfma_f32_16x16x32_bf16 a[244:247], a[80:83], v[96:99], a[244:247]
    v_mfma_f32_16x16x32_bf16 a[248:251], a[140:143], v[96:99], a[248:251]
    v_mfma_f32_16x16x32_bf16 a[252:255], a[200:203], v[96:99], a[252:255]
    v_mfma_f32_16x16x32_bf16 a[240:243], a[24:27], v[100:103], a[240:243]
    v_mfma_f32_16x16x32_bf16 a[244:247], a[84:87], v[100:103], a[244:247]
    v_mfma_f32_16x16x32_bf16 a[248:251], a[144:147], v[100:103], a[248:251]
    v_mfma_f32_16x16x32_bf16 a[252:255], a[204:207], v[100:103], a[252:255]
    v_mfma_f32_16x16x32_bf16 a[240:243], a[28:31], v[104:107], a[240:243]
    v_mfma_f32_16x16x32_bf16 a[244:247], a[88:91], v[104:107], a[244:247]
    v_mfma_f32_16x16x32_bf16 a[248:251], a[148:151], v[104:107], a[248:251]
    v_mfma_f32_16x16x32_bf16 a[252:255], a[208:211], v[104:107], a[252:255]
    v_mfma_f32_16x16x32_bf16 a[240:243], a[32:35], v[108:111], a[240:243]
    v_mfma_f32_16x16x32_bf16 a[244:247], a[92:95], v[108:111], a[244:247]
    v_mfma_f32_16x16x32_bf16 a[248:251], a[152:155], v[108:111], a[248:251]
    v_mfma_f32_16x16x32_bf16 a[252:255], a[212:215], v[108:111], a[252:255]
    v_mfma_f32_16x16x32_bf16 a[240:243], a[36:39], v[112:115], a[240:243]
    v_mfma_f32_16x16x32_bf16 a[244:247], a[96:99], v[112:115], a[244:247]
    v_mfma_f32_16x16x32_bf16 a[248:251], a[156:159], v[112:115], a[248:251]
    v_mfma_f32_16x16x32_bf16 a[252:255], a[216:219], v[112:115], a[252:255]
    v_mfma_f32_16x16x32_bf16 a[240:243], a[40:43], v[116:119], a[240:243]
    v_mfma_f32_16x16x32_bf16 a[244:247], a[100:103], v[116:119], a[244:247]
    v_mfma_f32_16x16x32_bf16 a[248:251], a[160:163], v[116:119], a[248:251]
    v_mfma_f32_16x16x32_bf16 a[252:255], a[220:223], v[116:119], a[252:255]
    v_mfma_f32_16x16x32_bf16 a[240:243], a[44:47], v[120:123], a[240:243]
    v_mfma_f32_16x16x32_bf16 a[244:247], a[104:107], v[120:123], a[244:247]
    v_mfma_f32_16x16x32_bf16 a[248:251], a[164:167], v[120:123], a[248:251]
    v_mfma_f32_16x16x32_bf16 a[252:255], a[224:227], v[120:123], a[252:255]
    v_mfma_f32_16x16x32_bf16 a[240:243], a[48:51], v[124:127], a[240:243]
    v_mfma_f32_16x16x32_bf16 a[244:247], a[108:111], v[124:127], a[244:247]
    v_mfma_f32_16x16x32_bf16 a[248:251], a[168:171], v[124:127], a[248:251]
    v_mfma_f32_16x16x32_bf16 a[252:255], a[228:231], v[124:127], a[252:255]
    v_mfma_f32_16x16x32_bf16 a[240:243], a[52:55], v[128:131], a[240:243]
    v_mfma_f32_16x16x32_bf16 a[244:247], a[112:115], v[128:131], a[244:247]
    v_mfma_f32_16x16x32_bf16 a[248:251], a[172:175], v[128:131], a[248:251]
    v_mfma_f32_16x16x32_bf16 a[252:255], a[232:235], v[128:131], a[252:255]
    v_mfma_f32_16x16x32_bf16 a[240:243], a[56:59], v[132:135], a[240:243]
    v_mfma_f32_16x16x32_bf16 a[244:247], a[116:119], v[132:135], a[244:247]
    v_mfma_f32_16x16x32_bf16 a[248:251], a[176:179], v[132:135], a[248:251]
    v_mfma_f32_16x16x32_bf16 a[252:255], a[236:239], v[132:135], a[252:255]
    v_accvgpr_read_b32 v76, a240
    v_accvgpr_read_b32 v77, a241
    v_accvgpr_read_b32 v78, a242
    v_accvgpr_read_b32 v79, a243
    v_accvgpr_read_b32 v80, a244
    v_accvgpr_read_b32 v81, a245
    v_accvgpr_read_b32 v82, a246
    v_accvgpr_read_b32 v83, a247
    v_accvgpr_read_b32 v84, a248
    v_accvgpr_read_b32 v85, a249
    v_accvgpr_read_b32 v86, a250
    v_accvgpr_read_b32 v87, a251
    v_accvgpr_read_b32 v88, a252
    v_accvgpr_read_b32 v89, a253
    v_accvgpr_read_b32 v90, a254
    v_accvgpr_read_b32 v91, a255
    v_mul_f32 v76, s30, v76
    v_mul_f32 v77, s30, v77
    v_mul_f32 v78, s30, v78
    v_mul_f32 v79, s30, v79
    v_mul_f32 v80, s30, v80
    v_mul_f32 v81, s30, v81
    v_mul_f32 v82, s30, v82
    v_mul_f32 v83, s30, v83
    v_mul_f32 v84, s30, v84
    v_mul_f32 v85, s30, v85
    v_mul_f32 v86, s30, v86
    v_mul_f32 v87, s30, v87
    v_mul_f32 v88, s30, v88
    v_mul_f32 v89, s30, v89
    v_mul_f32 v90, s30, v90
    v_mul_f32 v91, s30, v91
    v_cvt_pk_bf16_f32 v92, v76, v77
    v_cvt_pk_bf16_f32 v93, v78, v79
    v_cvt_pk_bf16_f32 v94, v80, v81
    v_cvt_pk_bf16_f32 v95, v82, v83
    v_cvt_pk_bf16_f32 v96, v84, v85
    v_cvt_pk_bf16_f32 v97, v86, v87
    v_cvt_pk_bf16_f32 v98, v88, v89
    v_cvt_pk_bf16_f32 v99, v90, v91
    global_store_dwordx4 v8, v[92:95], s[14:15]
    global_store_dwordx4 v8, v[96:99], s[14:15] offset:64
    v_add_u32 v8, 28672, v8
    s_waitcnt vmcnt(4)
    v_mfma_f32_16x16x32_bf16 a[240:243], a[0:3], v[136:139], 0
    v_mfma_f32_16x16x32_bf16 a[244:247], a[60:63], v[136:139], 0
    v_mfma_f32_16x16x32_bf16 a[248:251], a[120:123], v[136:139], 0
    v_mfma_f32_16x16x32_bf16 a[252:255], a[180:183], v[136:139], 0
    v_mfma_f32_16x16x32_bf16 a[240:243], a[4:7], v[140:143], a[240:243]
    v_mfma_f32_16x16x32_bf16 a[244:247], a[64:67], v[140:143], a[244:247]
    v_mfma_f32_16x16x32_bf16 a[248:251], a[124:127], v[140:143], a[248:251]
    v_mfma_f32_16x16x32_bf16 a[252:255], a[184:187], v[140:143], a[252:255]
    v_mfma_f32_16x16x32_bf16 a[240:243], a[8:11], v[144:147], a[240:243]
    v_mfma_f32_16x16x32_bf16 a[244:247], a[68:71], v[144:147], a[244:247]
    v_mfma_f32_16x16x32_bf16 a[248:251], a[128:131], v[144:147], a[248:251]
    v_mfma_f32_16x16x32_bf16 a[252:255], a[188:191], v[144:147], a[252:255]
    v_mfma_f32_16x16x32_bf16 a[240:243], a[12:15], v[148:151], a[240:243]
    v_mfma_f32_16x16x32_bf16 a[244:247], a[72:75], v[148:151], a[244:247]
    v_mfma_f32_16x16x32_bf16 a[248:251], a[132:135], v[148:151], a[248:251]
    v_mfma_f32_16x16x32_bf16 a[252:255], a[192:195], v[148:151], a[252:255]
    v_mfma_f32_16x16x32_bf16 a[240:243], a[16:19], v[152:155], a[240:243]
    v_mfma_f32_16x16x32_bf16 a[244:247], a[76:79], v[152:155], a[244:247]
    v_mfma_f32_16x16x32_bf16 a[248:251], a[136:139], v[152:155], a[248:251]
    v_mfma_f32_16x16x32_bf16 a[252:255], a[196:199], v[152:155], a[252:255]
    v_mfma_f32_16x16x32_bf16 a[240:243], a[20:23], v[156:159], a[240:243]
    v_mfma_f32_16x16x32_bf16 a[244:247], a[80:83], v[156:159], a[244:247]
    v_mfma_f32_16x16x32_bf16 a[248:251], a[140:143], v[156:159], a[248:251]
    v_mfma_f32_16x16x32_bf16 a[252:255], a[200:203], v[156:159], a[252:255]
    v_mfma_f32_16x16x32_bf16 a[240:243], a[24:27], v[160:163], a[240:243]
    v_mfma_f32_16x16x32_bf16 a[244:247], a[84:87], v[160:163], a[244:247]
    v_mfma_f32_16x16x32_bf16 a[248:251], a[144:147], v[160:163], a[248:251]
    v_mfma_f32_16x16x32_bf16 a[252:255], a[204:207], v[160:163], a[252:255]
    v_mfma_f32_16x16x32_bf16 a[240:243], a[28:31], v[164:167], a[240:243]
    v_mfma_f32_16x16x32_bf16 a[244:247], a[88:91], v[164:167], a[244:247]
    v_mfma_f32_16x16x32_bf16 a[248:251], a[148:151], v[164:167], a[248:251]
    v_mfma_f32_16x16x32_bf16 a[252:255], a[208:211], v[164:167], a[252:255]
    v_mfma_f32_16x16x32_bf16 a[240:243], a[32:35], v[168:171], a[240:243]
    v_mfma_f32_16x16x32_bf16 a[244:247], a[92:95], v[168:171], a[244:247]
    v_mfma_f32_16x16x32_bf16 a[248:251], a[152:155], v[168:171], a[248:251]
    v_mfma_f32_16x16x32_bf16 a[252:255], a[212:215], v[168:171], a[252:255]
    v_mfma_f32_16x16x32_bf16 a[240:243], a[36:39], v[172:175], a[240:243]
    v_mfma_f32_16x16x32_bf16 a[244:247], a[96:99], v[172:175], a[244:247]
    v_mfma_f32_16x16x32_bf16 a[248:251], a[156:159], v[172:175], a[248:251]
    v_mfma_f32_16x16x32_bf16 a[252:255], a[216:219], v[172:175], a[252:255]
    v_mfma_f32_16x16x32_bf16 a[240:243], a[40:43], v[176:179], a[240:243]
    v_mfma_f32_16x16x32_bf16 a[244:247], a[100:103], v[176:179], a[244:247]
    v_mfma_f32_16x16x32_bf16 a[248:251], a[160:163], v[176:179], a[248:251]
    v_mfma_f32_16x16x32_bf16 a[252:255], a[220:223], v[176:179], a[252:255]
    v_mfma_f32_16x16x32_bf16 a[240:243], a[44:47], v[180:183], a[240:243]
    v_mfma_f32_16x16x32_bf16 a[244:247], a[104:107], v[180:183], a[244:247]
    v_mfma_f32_16x16x32_bf16 a[248:251], a[164:167], v[180:183], a[248:251]
    v_mfma_f32_16x16x32_bf16 a[252:255], a[224:227], v[180:183], a[252:255]
    v_mfma_f32_16x16x32_bf16 a[240:243], a[48:51], v[184:187], a[240:243]
    v_mfma_f32_16x16x32_bf16 a[244:247], a[108:111], v[184:187], a[244:247]
    v_mfma_f32_16x16x32_bf16 a[248:251], a[168:171], v[184:187], a[248:251]
    v_mfma_f32_16x16x32_bf16 a[252:255], a[228:231], v[184:187], a[252:255]
    v_mfma_f32_16x16x32_bf16 a[240:243], a[52:55], v[188:191], a[240:243]
    v_mfma_f32_16x16x32_bf16 a[244:247], a[112:115], v[188:191], a[244:247]
    v_mfma_f32_16x16x32_bf16 a[248:251], a[172:175], v[188:191], a[248:251]
    v_mfma_f32_16x16x32_bf16 a[252:255], a[232:235], v[188:191], a[252:255]
    v_mfma_f32_16x16x32_bf16 a[240:243], a[56:59], v[192:195], a[240:243]
    v_mfma_f32_16x16x32_bf16 a[244:247], a[116:119], v[192:195], a[244:247]
    v_mfma_f32_16x16x32_bf16 a[248:251], a[176:179], v[192:195], a[248:251]
    v_mfma_f32_16x16x32_bf16 a[252:255], a[236:239], v[192:195], a[252:255]
    v_accvgpr_read_b32 v136, a240
    v_accvgpr_read_b32 v137, a241
    v_accvgpr_read_b32 v138, a242
    v_accvgpr_read_b32 v139, a243
    v_accvgpr_read_b32 v140, a244
    v_accvgpr_read_b32 v141, a245
    v_accvgpr_read_b32 v142, a246
    v_accvgpr_read_b32 v143, a247
    v_accvgpr_read_b32 v144, a248
    v_accvgpr_read_b32 v145, a249
    v_accvgpr_read_b32 v146, a250
    v_accvgpr_read_b32 v147, a251
    v_accvgpr_read_b32 v148, a252
    v_accvgpr_read_b32 v149, a253
    v_accvgpr_read_b32 v150, a254
    v_accvgpr_read_b32 v151, a255
    v_mul_f32 v136, s30, v136
    v_mul_f32 v137, s30, v137
    v_mul_f32 v138, s30, v138
    v_mul_f32 v139, s30, v139
    v_mul_f32 v140, s30, v140
    v_mul_f32 v141, s30, v141
    v_mul_f32 v142, s30, v142
    v_mul_f32 v143, s30, v143
    v_mul_f32 v144, s30, v144
    v_mul_f32 v145, s30, v145
    v_mul_f32 v146, s30, v146
    v_mul_f32 v147, s30, v147
    v_mul_f32 v148, s30, v148
    v_mul_f32 v149, s30, v149
    v_mul_f32 v150, s30, v150
    v_mul_f32 v151, s30, v151
    v_cvt_pk_bf16_f32 v152, v136, v137
    v_cvt_pk_bf16_f32 v153, v138, v139
    v_cvt_pk_bf16_f32 v154, v140, v141
    v_cvt_pk_bf16_f32 v155, v142, v143
    v_cvt_pk_bf16_f32 v156, v144, v145
    v_cvt_pk_bf16_f32 v157, v146, v147
    v_cvt_pk_bf16_f32 v158, v148, v149
    v_cvt_pk_bf16_f32 v159, v150, v151
    global_store_dwordx4 v8, v[152:155], s[14:15]
    global_store_dwordx4 v8, v[156:159], s[14:15] offset:64
    v_add_u32 v8, 28672, v8
    v_mfma_f32_16x16x32_bf16 a[240:243], a[0:3], v[196:199], 0
    v_mfma_f32_16x16x32_bf16 a[244:247], a[60:63], v[196:199], 0
    v_mfma_f32_16x16x32_bf16 a[248:251], a[120:123], v[196:199], 0
    v_mfma_f32_16x16x32_bf16 a[252:255], a[180:183], v[196:199], 0
    v_mfma_f32_16x16x32_bf16 a[240:243], a[4:7], v[200:203], a[240:243]
    v_mfma_f32_16x16x32_bf16 a[244:247], a[64:67], v[200:203], a[244:247]
    v_mfma_f32_16x16x32_bf16 a[248:251], a[124:127], v[200:203], a[248:251]
    v_mfma_f32_16x16x32_bf16 a[252:255], a[184:187], v[200:203], a[252:255]
    v_mfma_f32_16x16x32_bf16 a[240:243], a[8:11], v[204:207], a[240:243]
    v_mfma_f32_16x16x32_bf16 a[244:247], a[68:71], v[204:207], a[244:247]
    v_mfma_f32_16x16x32_bf16 a[248:251], a[128:131], v[204:207], a[248:251]
    v_mfma_f32_16x16x32_bf16 a[252:255], a[188:191], v[204:207], a[252:255]
    v_mfma_f32_16x16x32_bf16 a[240:243], a[12:15], v[208:211], a[240:243]
    v_mfma_f32_16x16x32_bf16 a[244:247], a[72:75], v[208:211], a[244:247]
    v_mfma_f32_16x16x32_bf16 a[248:251], a[132:135], v[208:211], a[248:251]
    v_mfma_f32_16x16x32_bf16 a[252:255], a[192:195], v[208:211], a[252:255]
    v_mfma_f32_16x16x32_bf16 a[240:243], a[16:19], v[212:215], a[240:243]
    v_mfma_f32_16x16x32_bf16 a[244:247], a[76:79], v[212:215], a[244:247]
    v_mfma_f32_16x16x32_bf16 a[248:251], a[136:139], v[212:215], a[248:251]
    v_mfma_f32_16x16x32_bf16 a[252:255], a[196:199], v[212:215], a[252:255]
    v_mfma_f32_16x16x32_bf16 a[240:243], a[20:23], v[216:219], a[240:243]
    v_mfma_f32_16x16x32_bf16 a[244:247], a[80:83], v[216:219], a[244:247]
    v_mfma_f32_16x16x32_bf16 a[248:251], a[140:143], v[216:219], a[248:251]
    v_mfma_f32_16x16x32_bf16 a[252:255], a[200:203], v[216:219], a[252:255]
    v_mfma_f32_16x16x32_bf16 a[240:243], a[24:27], v[220:223], a[240:243]
    v_mfma_f32_16x16x32_bf16 a[244:247], a[84:87], v[220:223], a[244:247]
    v_mfma_f32_16x16x32_bf16 a[248:251], a[144:147], v[220:223], a[248:251]
    v_mfma_f32_16x16x32_bf16 a[252:255], a[204:207], v[220:223], a[252:255]
    v_mfma_f32_16x16x32_bf16 a[240:243], a[28:31], v[224:227], a[240:243]
    v_mfma_f32_16x16x32_bf16 a[244:247], a[88:91], v[224:227], a[244:247]
    v_mfma_f32_16x16x32_bf16 a[248:251], a[148:151], v[224:227], a[248:251]
    v_mfma_f32_16x16x32_bf16 a[252:255], a[208:211], v[224:227], a[252:255]
    v_mfma_f32_16x16x32_bf16 a[240:243], a[32:35], v[228:231], a[240:243]
    v_mfma_f32_16x16x32_bf16 a[244:247], a[92:95], v[228:231], a[244:247]
    v_mfma_f32_16x16x32_bf16 a[248:251], a[152:155], v[228:231], a[248:251]
    v_mfma_f32_16x16x32_bf16 a[252:255], a[212:215], v[228:231], a[252:255]
    v_mfma_f32_16x16x32_bf16 a[240:243], a[36:39], v[232:235], a[240:243]
    v_mfma_f32_16x16x32_bf16 a[244:247], a[96:99], v[232:235], a[244:247]
    v_mfma_f32_16x16x32_bf16 a[248:251], a[156:159], v[232:235], a[248:251]
    v_mfma_f32_16x16x32_bf16 a[252:255], a[216:219], v[232:235], a[252:255]
    v_mfma_f32_16x16x32_bf16 a[240:243], a[40:43], v[236:239], a[240:243]
    v_mfma_f32_16x16x32_bf16 a[244:247], a[100:103], v[236:239], a[244:247]
    v_mfma_f32_16x16x32_bf16 a[248:251], a[160:163], v[236:239], a[248:251]
    v_mfma_f32_16x16x32_bf16 a[252:255], a[220:223], v[236:239], a[252:255]
    v_mfma_f32_16x16x32_bf16 a[240:243], a[44:47], v[240:243], a[240:243]
    v_mfma_f32_16x16x32_bf16 a[244:247], a[104:107], v[240:243], a[244:247]
    v_mfma_f32_16x16x32_bf16 a[248:251], a[164:167], v[240:243], a[248:251]
    v_mfma_f32_16x16x32_bf16 a[252:255], a[224:227], v[240:243], a[252:255]
    v_mfma_f32_16x16x32_bf16 a[240:243], a[48:51], v[244:247], a[240:243]
    v_mfma_f32_16x16x32_bf16 a[244:247], a[108:111], v[244:247], a[244:247]
    v_mfma_f32_16x16x32_bf16 a[248:251], a[168:171], v[244:247], a[248:251]
    v_mfma_f32_16x16x32_bf16 a[252:255], a[228:231], v[244:247], a[252:255]
    v_mfma_f32_16x16x32_bf16 a[240:243], a[52:55], v[248:251], a[240:243]
    v_mfma_f32_16x16x32_bf16 a[244:247], a[112:115], v[248:251], a[244:247]
    v_mfma_f32_16x16x32_bf16 a[248:251], a[172:175], v[248:251], a[248:251]
    v_mfma_f32_16x16x32_bf16 a[252:255], a[232:235], v[248:251], a[252:255]
    v_mfma_f32_16x16x32_bf16 a[240:243], a[56:59], v[252:255], a[240:243]
    v_mfma_f32_16x16x32_bf16 a[244:247], a[116:119], v[252:255], a[244:247]
    v_mfma_f32_16x16x32_bf16 a[248:251], a[176:179], v[252:255], a[248:251]
    v_mfma_f32_16x16x32_bf16 a[252:255], a[236:239], v[252:255], a[252:255]
    v_accvgpr_read_b32 v196, a240
    v_accvgpr_read_b32 v197, a241
    v_accvgpr_read_b32 v198, a242
    v_accvgpr_read_b32 v199, a243
    v_accvgpr_read_b32 v200, a244
    v_accvgpr_read_b32 v201, a245
    v_accvgpr_read_b32 v202, a246
    v_accvgpr_read_b32 v203, a247
    v_accvgpr_read_b32 v204, a248
    v_accvgpr_read_b32 v205, a249
    v_accvgpr_read_b32 v206, a250
    v_accvgpr_read_b32 v207, a251
    v_accvgpr_read_b32 v208, a252
    v_accvgpr_read_b32 v209, a253
    v_accvgpr_read_b32 v210, a254
    v_accvgpr_read_b32 v211, a255
    v_mul_f32 v196, s30, v196
    v_mul_f32 v197, s30, v197
    v_mul_f32 v198, s30, v198
    v_mul_f32 v199, s30, v199
    v_mul_f32 v200, s30, v200
    v_mul_f32 v201, s30, v201
    v_mul_f32 v202, s30, v202
    v_mul_f32 v203, s30, v203
    v_mul_f32 v204, s30, v204
    v_mul_f32 v205, s30, v205
    v_mul_f32 v206, s30, v206
    v_mul_f32 v207, s30, v207
    v_mul_f32 v208, s30, v208
    v_mul_f32 v209, s30, v209
    v_mul_f32 v210, s30, v210
    v_mul_f32 v211, s30, v211
    v_cvt_pk_bf16_f32 v212, v196, v197
    v_cvt_pk_bf16_f32 v213, v198, v199
    v_cvt_pk_bf16_f32 v214, v200, v201
    v_cvt_pk_bf16_f32 v215, v202, v203
    v_cvt_pk_bf16_f32 v216, v204, v205
    v_cvt_pk_bf16_f32 v217, v206, v207
    v_cvt_pk_bf16_f32 v218, v208, v209
    v_cvt_pk_bf16_f32 v219, v210, v211
    global_store_dwordx4 v8, v[212:215], s[14:15]
    global_store_dwordx4 v8, v[216:219], s[14:15] offset:64
    s_branch P3_loop
FFT_done:
    s_lshl_b32 s23, s22, 7
    s_cmp_lg_u32 s3, 0
    s_cbranch_scc1 BC_22
    s_mov_b64 exec, 1
    v_mov_b32 v3, s23
    v_add_u32 v3, 8192, v3
    v_mov_b32 v2, 1
    global_atomic_add v2, v3, v2, s[18:19] sc0 sc1
    s_waitcnt vmcnt(0)
    v_mov_b32 v3, 163600
    ds_write_b32 v3, v2
    s_mov_b64 exec, -1
    s_waitcnt lgkmcnt(0)
BC_22:
    s_barrier
    v_mov_b32 v3, 163600
    ds_read_b32 v2, v3
    s_waitcnt lgkmcnt(0)
    v_readfirstlane_b32 s21, v2
    s_cmp_lt_u32 s21, 31
    s_cbranch_scc1 ROLE_CHAIN
    s_endpgm
BAIL_1:
    s_mov_b64 exec, 1
    v_mov_b32 v3, 196
    v_mov_b32 v2, 1
    global_atomic_add v3, v2, s[16:17] sc1
    s_endpgm
BAIL_2:
    s_mov_b64 exec, 1
    v_mov_b32 v3, 200
    v_mov_b32 v2, 1
    global_atomic_add v3, v2, s[16:17] sc1
    s_endpgm
BAIL_3:
    s_mov_b64 exec, 1
    v_mov_b32 v3, 204
    v_mov_b32 v2, 1
    global_atomic_add v3, v2, s[16:17] sc1
    s_endpgm
BAIL_4:
    s_mov_b64 exec, 1
    v_mov_b32 v3, 208
    v_mov_b32 v2, 1
    global_atomic_add v3, v2, s[16:17] sc1
    s_endpgm
BAIL_5:
    s_mov_b64 exec, 1
    v_mov_b32 v3, 212
    v_mov_b32 v2, 1
    global_atomic_add v3, v2, s[16:17] sc1
    s_endpgm
BAIL_6:
    s_mov_b64 exec, 1
    v_mov_b32 v3, 216
    v_mov_b32 v2, 1
    global_atomic_add v3, v2, s[16:17] sc1
    s_endpgm
BAIL_7:
    s_mov_b64 exec, 1
    v_mov_b32 v3, 220
    v_mov_b32 v2, 1
    global_atomic_add v3, v2, s[16:17] sc1
    s_endpgm
K2_end:
    s_endpgm
K2_last:
.section .rodata,"a"
.p2align 6
.amdhsa_kernel pre_kernel
  .amdhsa_next_free_vgpr 512
  .amdhsa_next_free_sgpr 96
  .amdhsa_accum_offset 256
  .amdhsa_group_segment_fixed_size 0
  .amdhsa_kernarg_size 104
  .amdhsa_user_sgpr_count 2
  .amdhsa_user_sgpr_kernarg_segment_ptr 1
  .amdhsa_system_sgpr_workgroup_id_x 1
.end_amdhsa_kernel

.p2align 6
.amdhsa_kernel main_kernel
  .amdhsa_next_free_vgpr 512
  .amdhsa_next_free_sgpr 100
  .amdhsa_accum_offset 256
  .amdhsa_group_segment_fixed_size 0
  .amdhsa_kernarg_size 104
  .amdhsa_user_sgpr_count 2
  .amdhsa_user_sgpr_kernarg_segment_ptr 1
  .amdhsa_system_sgpr_workgroup_id_x 1
.end_amdhsa_kernel
```
